```python
import torch

def _softmax(x, axis=-1):
    return torch.softmax(x, dim=axis)
def _gelu(x):
    return torch.nn.functional.gelu(x, approximate="tanh")
def _silu(x):
    return torch.nn.functional.silu(x)
def _sigmoid(x):
    return torch.sigmoid(x)
def _layernorm(x, axis=-1, eps=1e-5):
    m = x.mean(dim=axis, keepdim=True)
    v = x.var(dim=axis, keepdim=True, unbiased=False)
    return (x - m) / torch.sqrt(v + eps)
def _scatter_add(tgt, idx, src, axis=0):
    return tgt.clone().index_add_(axis, idx, src)
def _segment_sum(src, seg, n):
    out = torch.zeros((n,) + src.shape[1:], dtype=src.dtype)
    return out.index_add_(0, seg, src)
def _pad(x, pw):
    flat = tuple(v for pair in reversed(pw) for v in pair)
    return torch.nn.functional.pad(x, flat)

kernel_name = 'interleave_layers__ssm_conv_s4d__dense_activation_relu__prompt'

def setup_inputs():

    _w = (lambda a: (lambda t: t.to(torch.bfloat16) if t.is_floating_point() else t)(torch.as_tensor(a)))
    def _A_setup():
        Bsz, L, D, N = 1, 2048, 512, 128
        return {
            "u": _w((lambda *s: torch.randn(*s, dtype=torch.bfloat16) * 0.05)(Bsz, L, D)),
            "log_A_real": _w((lambda *s: torch.randn(*s, dtype=torch.bfloat16) * 3.2)(D, N) * 0.5),
            "A_imag": _w((lambda *s: torch.randn(*s, dtype=torch.bfloat16) * 0.2)(D, N) * 3.14),
            "C_real": _w((lambda *s: torch.randn(*s, dtype=torch.bfloat16) * 0.2)(D, N) / N ** 0.5),
            "C_imag": _w((lambda *s: torch.randn(*s, dtype=torch.bfloat16) * 0.2)(D, N) / N ** 0.5),
            "log_dt": _w((lambda *s: torch.randn(*s, dtype=torch.bfloat16) * 0.2)(D) * 0.5 - 4.0),
            "D_skip": _w((lambda *s: torch.randn(*s, dtype=torch.bfloat16) * 0.2)(D)),
        }
    _A_in = _A_setup()

    def _B_setup():
        B, S, D, Dff = 1, 2048, 512, 1376
        return {
            "x": _w((lambda *s: torch.randn(*s, dtype=torch.bfloat16) * 0.05)(B, S, D)),
            "w1": _w((lambda *s: torch.randn(*s, dtype=torch.bfloat16) * 0.05)(D, Dff)),
            "w2": _w((lambda *s: torch.randn(*s, dtype=torch.bfloat16) * 0.05)(Dff, D)),
        }
    _B_in = _B_setup()

    return {
        "A_u": _A_in["u"],
        "A_log_A_real": _A_in["log_A_real"],
        "A_A_imag": _A_in["A_imag"],
        "A_C_real": _A_in["C_real"],
        "A_C_imag": _A_in["C_imag"],
        "A_log_dt": _A_in["log_dt"],
        "A_D_skip": _A_in["D_skip"],
        "B_x": _B_in["x"],
        "B_w1": _B_in["w1"],
        "B_w2": _B_in["w2"],
    }

def reference(A_u, A_log_A_real, A_A_imag, A_C_real, A_C_imag, A_log_dt, A_D_skip, B_x, B_w1, B_w2):
    def _A_ref(u, log_A_real, A_imag, C_real, C_imag, log_dt, D_skip):
        L = u.shape[1]
        dt = torch.exp(log_dt)
        A = -torch.exp(log_A_real) + 1j * A_imag
        C = (C_real + 1j * C_imag) * dt[:, None]
        pos = (lambda x, dt: x.to(dt))(torch.arange(L), log_dt.dtype)
        P = torch.exp((A * dt[:, None])[:, :, None] * pos[None, None, :])
        K = 2.0 * torch.einsum("dn,dnl->dl", C, P).real
        L2 = 2 * L
        u_t = (lambda x, *d: x.permute(*d))(u, 0, 2, 1)
        Kf = (lambda x, *a, **k: torch.fft.rfft(x.float(), *a, **k))(K, L2)
        Uf = (lambda x, *a, **k: torch.fft.rfft(x.float(), *a, **k))(u_t, L2)
        y = (lambda x, *a, **k: torch.fft.irfft(x, *a, **k).to(torch.bfloat16))(Uf * Kf[None, :, :], L2)[:, :, :L]
        y = (lambda x, *d: x.permute(*d))(y, 0, 2, 1)
        return y + u * D_skip[None, None, :]

    def _B_ref(x, w1, w2):
        h = torch.einsum("bsd,df->bsf", x, w1)
        zero = torch.zeros_like(h)
        h = torch.maximum(h, zero)
        return torch.einsum("bsf,fd->bsd", h, w2)

    x = A_u
    x = x + _A_ref(_layernorm(x, axis=-1), A_log_A_real, A_A_imag, A_C_real, A_C_imag, A_log_dt, A_D_skip)
    x = x + _B_ref(_layernorm(x, axis=-1), B_w1, B_w2)
    x = x + _A_ref(_layernorm(x, axis=-1), A_log_A_real, A_A_imag, A_C_real, A_C_imag, A_log_dt, A_D_skip)
    x = x + _B_ref(_layernorm(x, axis=-1), B_w1, B_w2)
    return x
```

```asm
; @launch grid=(256,1,1) block=(256,1,1) lds=163840
.amdgcn_target "amdgcn-amd-amdhsa--gfx950"
.text
.globl interleave_layers__ssm_conv_s4d__dense_activation_relu__prompt_kernel
.p2align 8
.type interleave_layers__ssm_conv_s4d__dense_activation_relu__prompt_kernel,@function
interleave_layers__ssm_conv_s4d__dense_activation_relu__prompt_kernel:
    s_cmp_ge_u32 s2, 256
    s_cbranch_scc1 L_end
    s_load_dwordx16 s[4:19], s[0:1], 0
    s_load_dwordx8 s[20:27], s[0:1], 64
    s_load_dwordx2 s[28:29], s[0:1], 96
    s_getpc_b64 s[58:59]
L_pc:
    s_lshr_b32 s73, s2, 3
    s_mul_i32 s72, s73, 1792
    v_min_u32 v13, 13, v0
    v_lshl_add_u32 v13, v13, 7, s72
    v_min_u32 v13, L_cold-L_pc, v13
    global_load_dword v12, v13, s[58:59]
    v_lshrrev_b32 v20, 6, v0
    v_and_b32 v1, 63, v0
    v_readfirstlane_b32 s48, v20
    s_getreg_b32 s55, hwreg(HW_REG_XCC_ID, 0, 4)
    s_and_b32 s72, s2, 7
    s_lshr_b32 s73, s2, 3
    s_lshl_b32 s49, s72, 5
    s_add_u32 s49, s49, s73
    s_lshr_b32 s50, s49, 3
    s_and_b32 s51, s49, 7
    s_and_b32 s57, s48, 1
    s_lshr_b32 s67, s48, 1
    v_mov_b64 v[6:7], -1
    v_mov_b64 v[8:9], -1
    v_lshlrev_b32 v10, 4, v1
    v_and_b32 v20, 1, v1
    v_lshlrev_b32 v20, 5, v20
    v_lshrrev_b32 v24, 5, v0
    v_lshl_add_u32 v20, v24, 2, v20
    v_lshlrev_b32 v21, 1, v0
    v_lshlrev_b32 v22, 5, v0
    v_lshrrev_b32 v24, 4, v1
    v_and_b32 v23, 15, v1
    v_lshlrev_b32 v23, 4, v23
    v_lshl_add_u32 v23, v24, 10, v23
    v_lshlrev_b32 v11, 7, v0
    s_lshl_b32 s75, s2, 13
    s_lshl_b32 s85, s48, 11
    s_lshl_b32 s76, s2, 14
    s_add_u32 s76, s76, s85
    s_add_u32 s77, s76, 8192
    v_lshlrev_b32 v26, 1, v1
    v_lshl_add_u32 v26, s48, 8, v26
    s_lshl_b32 s78, s49, 9
    v_add_u32 v21, s78, v21
    s_lshl_b32 s78, s49, 1
    s_add_u32 s78, s78, s67
    s_lshl_b32 s78, s78, 1
    v_mov_b32 v25, s78
    s_lshl_b32 s79, s49, 2
    s_add_u32 s80, s79, s48
    s_lshl_b32 s80, s80, 2
    s_add_u32 s80, s80, 14942208
    s_lshl_b32 s81, s49, 7
    s_add_u32 s81, s81, 14946304
    s_lshl_b32 s84, s50, 7
    s_add_u32 s84, s84, 14942208
    s_lshl_b32 s89, s51, 2
    s_add_u32 s89, s89, s48
    s_cmp_eq_u32 s89, 2
    s_cselect_b32 s81, s84, s81
    s_cselect_b32 s87, 0, s55
    s_cselect_b32 s89, 1, s48
    s_lshl_b32 s88, s2, 11
    s_add_u32 s88, s88, 14979072
    s_cmp_eq_u32 s48, 3
    s_cselect_b32 s87, 0, s87
    v_mov_b32 v48, s87
    v_mov_b32 v49, s87
    v_mov_b32 v50, s87
    v_mov_b32 v51, s87
    s_lshl_b32 s82, s48, 8
    s_add_u32 s82, s82, s75
    s_add_u32 s83, s82, 4096
    s_lshl_b32 s3, s49, 13
    s_add_u32 s3, s3, s85
    s_add_u32 s3, s3, 10485760
    s_mov_b32 m0, s85
    s_mov_b32 s34, 15728640
    s_mov_b32 s35, 0x20000
    s_mov_b32 s70, 2097152
    s_mov_b32 s71, 0x20000
    s_mov_b32 s38, 1409024
    s_mov_b32 s39, 0x20000
    s_mov_b32 s42, 1409024
    s_mov_b32 s43, 0x20000
    s_mov_b32 s46, 2097152
    s_mov_b32 s47, 0x20000
    s_waitcnt lgkmcnt(0)
    s_mov_b64 s[32:33], s[28:29]
    s_mov_b64 s[68:69], s[4:5]
    s_mov_b64 s[36:37], s[20:21]
    s_mov_b64 s[40:41], s[22:23]
    s_mov_b64 s[44:45], s[24:25]
    s_mov_b32 s19, s80
    s_cmp_lg_u32 s89, 1
    s_cbranch_scc1 L_nosm_1
    s_mov_b32 exec_lo, 255
    s_mov_b32 exec_hi, 0
    buffer_store_dwordx4 v[48:51], v10, s[32:35], s81 offen sc1
    s_mov_b64 exec, -1
L_nosm_1:
    s_cmp_lg_u32 s48, 3
    s_cbranch_scc1 L_noz_2
    s_cmp_ge_u32 s2, 16
    s_cbranch_scc1 L_noz_2
    buffer_store_dwordx4 v[48:51], v10, s[32:35], s88 offen sc1
    buffer_store_dwordx4 v[48:51], v10, s[32:35], s88 offen offset:1024 sc1
L_noz_2:
    buffer_load_dwordx4 v23, s[68:71], s82 offen lds
    s_addk_i32 m0, 1024
    s_nop 0
    buffer_load_dwordx4 v23, s[68:71], s83 offen lds
    buffer_load_dwordx4 v[36:39], v22, s[68:71], s75 offen
    buffer_load_dwordx4 v[40:43], v22, s[68:71], s75 offen offset:16
    global_load_ushort v28, v25, s[14:15]
    global_load_ushort v29, v21, s[6:7]
    global_load_ushort v30, v21, s[8:9]
    global_load_ushort v31, v21, s[10:11]
    global_load_ushort v32, v21, s[12:13]
    global_load_ushort v34, v26, s[16:17] offset:0
    global_load_ushort v35, v26, s[16:17] offset:128
    buffer_store_dwordx4 v[6:9], v10, s[32:35], s3 offen sc1
    buffer_store_dwordx4 v[6:9], v10, s[32:35], s3 offen offset:1024 sc1
    s_mul_i32 s98, s48, 11
    s_min_u32 s98, s98, 32
    s_mul_i32 s99, s2, 43
    s_add_u32 s98, s98, s99
    s_lshl_b32 s98, s98, 7
    v_min_u32 v13, 10, v1
    v_lshlrev_b32 v13, 7, v13
    buffer_load_dword v12, v13, s[36:39], s98 offen
    s_mov_b32 s56, 0x40000
    s_lshr_b32 s54, s50, 3
    s_lshl_b32 s54, s54, 5
    s_and_b32 s74, s50, 3
    s_lshl3_add_u32 s54, s74, s54
    s_bfe_u32 s74, s50, 0x10002
    s_add_u32 s54, s54, s74
    s_lshl2_add_u32 s54, s57, s54
    s_mul_i32 s65, s51, 344
    s_mul_i32 s74, s48, 96
    s_add_u32 s65, s65, s74
    s_mul_i32 s66, s48, 352256
    s_lshl_b32 s74, s51, 7
    s_add_u32 s66, s66, s74
    s_lshl4_add_u32 s30, s54, s51
    s_lshl1_add_u32 s30, s30, s67
    s_lshl_b32 s30, s30, 9
    s_add_u32 s30, s30, 6291456
    s_lshl2_add_u32 s31, s50, s57
    s_lshl3_add_u32 s31, s31, s51
    s_lshl1_add_u32 s31, s31, s67
    s_lshl_b32 s31, s31, 7
    s_add_u32 s31, s31, 14680064
    s_lshl_b32 s52, s50, 10
    s_add_u32 s52, s52, 14946304
    v_mov_b32 v19, 0x3727c5ac
    s_and_b32 s94, s50, 0
    s_xor_b32 s94, s94, 0
    s_mul_i32 s94, s94, 352256
    s_add_u32 s94, s94, s65
    s_and_b32 s95, s50, 0
    s_xor_b32 s95, s95, 1
    s_mul_i32 s95, s95, 352256
    s_add_u32 s95, s95, s65
    s_and_b32 s100, s50, 0
    s_xor_b32 s100, s100, 2
    s_mul_i32 s100, s100, 352256
    s_add_u32 s100, s100, s65
    s_and_b32 s101, s50, 0
    s_xor_b32 s101, s101, 3
    s_mul_i32 s101, s101, 352256
    s_add_u32 s101, s101, s65
    s_mul_i32 s62, s48, 19328
    s_add_u32 s62, s62, 86528
    s_mul_i32 s63, s48, 4096
    s_add_u32 s63, s63, 76800
    s_mul_i32 s64, s48, 17664
    s_add_u32 s64, s64, 93184
    v_lshrrev_b32 v44, 2, v1
    v_and_b32 v45, 3, v1
    v_lshlrev_b32 v45, 3, v45
    v_lshl_add_u32 v14, v44, 6, v45
    v_lshl_add_u32 v16, v44, 7, v45
    v_bfe_u32 v44, v1, 4, 1
    v_lshl_add_u32 v14, v44, 5, v14
    v_add_u32 v14, 27648, v14
    v_xor_b32 v15, 32, v14
    s_andn2_b32 s74, 2, s48
    v_bfe_u32 v44, v1, 3, 2
    v_xor_b32 v44, s74, v44
    v_lshl_add_u32 v16, v44, 5, v16
    v_xor_b32 v17, 32, v16
    s_cmp_eq_u32 s48, 3
    s_cselect_b32 s74, 3, 5
    v_add_u32 v44, 0, v1
    v_mul_u32_u24 v45, 0xaaab, v44
    v_lshrrev_b32 v45, 18, v45
    v_mul_u32_u24 v46, 6, v45
    v_sub_u32 v44, v44, v46
    v_min_u32 v44, s74, v44
    v_mul_u32_u24 v45, 2752, v45
    v_lshl_add_u32 v2, v44, 4, v45
    v_add_u32 v44, 64, v1
    v_mul_u32_u24 v45, 0xaaab, v44
    v_lshrrev_b32 v45, 18, v45
    v_mul_u32_u24 v46, 6, v45
    v_sub_u32 v44, v44, v46
    v_min_u32 v44, s74, v44
    v_mul_u32_u24 v45, 2752, v45
    v_lshl_add_u32 v3, v44, 4, v45
    v_subrev_u32 v3, 1024, v3
    v_add_u32 v44, 128, v1
    v_mul_u32_u24 v45, 0xaaab, v44
    v_lshrrev_b32 v45, 18, v45
    v_mul_u32_u24 v46, 6, v45
    v_sub_u32 v44, v44, v46
    v_min_u32 v44, s74, v44
    v_mul_u32_u24 v45, 2752, v45
    v_lshl_add_u32 v4, v44, 4, v45
    v_subrev_u32 v4, 2048, v4
    v_lshrrev_b32 v44, 3, v1
    v_and_b32 v5, 6, v44
    v_xor_b32 v5, v5, v1
    v_and_b32 v5, 7, v5
    v_lshlrev_b32 v5, 4, v5
    v_lshl_add_u32 v5, v44, 10, v5
    v_and_b32 v124, 127, v0
    v_lshlrev_b32 v124, 14, v124
    s_lshl1_add_u32 s92, s49, s67
    s_lshl_b32 s92, s92, 4
    s_add_u32 s92, s92, 0
    s_mul_i32 s91, s67, 4608
    s_lshl_b32 s93, s57, 10
    s_add_u32 s91, s91, s93
    s_add_u32 s91, s91, 17152
    v_and_b32 v50, 127, v0
    v_lshlrev_b32 v44, 4, v50
    v_sub_u32 v44, 2032, v44
    v_cvt_f32_i32 v45, v44
    s_mul_i32 s88, s67, 1408
    s_add_u32 s88, s88, 83616
    v_lshrrev_b32 v46, 16, v45
    v_subrev_u32 v46, 0x4280, v46
    v_min_i32 v47, 127, v44
    v_max_i32 v46, v46, v47
    v_or_b32 v46, 0x4b000000, v46
    v_and_b32 v45, 0x7f800000, v45
    v_max_u32 v45, 0x43000000, v45
    v_sub_u32 v45, 0x82800000, v45
    s_sub_u32 s87, s88, 0x96000000
    v_fmamk_f32 v47, v45, 0x41700000, v46
    v_lshl_add_u32 v92, v47, 1, s87
    v_fmamk_f32 v47, v45, 0x41600000, v46
    v_lshl_add_u32 v93, v47, 1, s87
    v_fmamk_f32 v47, v45, 0x41500000, v46
    v_lshl_add_u32 v94, v47, 1, s87
    v_fmamk_f32 v47, v45, 0x41400000, v46
    v_lshl_add_u32 v95, v47, 1, s87
    v_fmamk_f32 v47, v45, 0x41300000, v46
    v_lshl_add_u32 v96, v47, 1, s87
    v_fmamk_f32 v47, v45, 0x41200000, v46
    v_lshl_add_u32 v97, v47, 1, s87
    v_fmamk_f32 v47, v45, 0x41100000, v46
    v_lshl_add_u32 v98, v47, 1, s87
    v_fmamk_f32 v47, v45, 0x41000000, v46
    v_lshl_add_u32 v99, v47, 1, s87
    v_fmamk_f32 v47, v45, 0x40e00000, v46
    v_lshl_add_u32 v100, v47, 1, s87
    v_fmamk_f32 v47, v45, 0x40c00000, v46
    v_lshl_add_u32 v101, v47, 1, s87
    v_fmamk_f32 v47, v45, 0x40a00000, v46
    v_lshl_add_u32 v102, v47, 1, s87
    v_fmamk_f32 v47, v45, 0x40800000, v46
    v_lshl_add_u32 v103, v47, 1, s87
    v_fmamk_f32 v47, v45, 0x40400000, v46
    v_lshl_add_u32 v104, v47, 1, s87
    v_fmamk_f32 v47, v45, 0x40000000, v46
    v_lshl_add_u32 v105, v47, 1, s87
    v_fmamk_f32 v47, v45, 0x3f800000, v46
    v_lshl_add_u32 v106, v47, 1, s87
    v_fmamk_f32 v47, v45, 0x00000000, v46
    v_lshl_add_u32 v107, v47, 1, s87
    s_add_u32 s87, s88, 1400
    v_mov_b32 v48, s87
    v_subrev_u32 v108, 2, v107
    v_cmp_lt_u32 vcc, 256, v44
    s_nop 1
    v_cndmask_b32 v108, v108, v107, vcc
    v_cmp_eq_u32 vcc, 0, v44
    s_nop 1
    v_cndmask_b32 v108, v108, v48, vcc
    v_mov_b32 v49, 0
    ds_write_b32 v48, v49
    s_mul_i32 s87, s67, 4608
    v_lshl_add_u32 v48, v50, 2, s87
    ds_write_b32 v48, v49 offset:16640
    s_mul_i32 s87, s67, 27984
    s_add_u32 s87, s87, 27648
    s_lshl_b32 s86, s57, 8
    s_add_u32 s86, s86, s87
    v_and_b32 v44, 15, v1
    v_mul_u32_u24 v110, 528, v44
    v_and_b32 v111, 48, v1
    v_add3_u32 v110, v110, v111, s87
    s_mul_i32 s87, s57, 8448
    s_add_u32 s87, s87, 11088
    v_add_u32 v111, s87, v110
    s_lshl_b32 s87, s57, 4
    v_add_u32 v44, s87, v44
    v_lshrrev_b32 v45, 4, v1
    v_lshlrev_b32 v112, 4, v44
    v_lshl_add_u32 v112, v45, 3, v112
    v_lshlrev_b32 v47, 3, v44
    v_add_u32 v47, 512, v47
    v_cmp_eq_u32 vcc, 2, v45
    s_nop 1
    v_cndmask_b32 v112, v112, v47, vcc
    v_add_u32 v113, 4, v112
    v_lshlrev_b32 v47, 2, v44
    v_add_u32 v49, 768, v47
    v_add_u32 v47, 896, v47
    v_cmp_eq_u32 vcc, 3, v45
    s_nop 1
    v_cndmask_b32 v112, v112, v49, vcc
    v_cndmask_b32 v113, v113, v47, vcc
    v_add_u32 v112, s88, v112
    v_add_u32 v113, s88, v113
    v_lshlrev_b32 v114, 1, v44
    v_lshl_add_u32 v114, v45, 8, v114
    v_add_u32 v114, s88, v114
    s_mul_i32 s87, s67, 8320
    v_lshl_add_u32 v115, v50, 5, s87
    v_and_b32 v116, 7, v1
    s_mul_i32 s87, s48, 4160
    v_lshl_add_u32 v116, v116, 3, s87
    v_bfe_u32 v117, v1, 2, 2
    v_lshlrev_b32 v117, 8, v117
    v_lshl_add_u32 v117, v45, 5, v117
    v_and_b32 v45, 3, v1
    v_lshl_add_u32 v117, v45, 3, v117
    v_add_u32 v117, s85, v117
    v_mov_b32 v45, 0x3f803f80
    v_and_b32 v48, 1, v1
    v_cmp_eq_u32 vcc, 1, v48
    s_cmp_lg_u32 s48, 3
    s_cbranch_scc1 L_noa_3
    s_cmp_ge_u32 s2, 16
    s_cbranch_scc1 L_noa_3
    v_mov_b32 v22, 0
    v_mov_b32 v23, 1
    s_waitcnt vmcnt(14)
    s_mov_b32 exec_lo, 1
    s_mov_b32 exec_hi, 0
    global_atomic_add v22, v23, s[26:27] sc1
    s_mov_b64 exec, -1
L_noa_3:
    s_mov_b64 exec, 0
    s_cmp_eq_u32 s48, 0
    s_cbranch_scc1 L_stub_0
    s_cmp_eq_u32 s48, 1
    s_cbranch_scc1 L_stub_1
    s_cmp_eq_u32 s48, 2
    s_cbranch_scc1 L_stub_2
    s_cmp_eq_u32 s48, 3
    s_cbranch_scc1 L_stub_3
    s_branch L_warm_back
.p2align 12
L_warm_back:
    s_mov_b64 exec, -1
    s_nop 0
    s_waitcnt vmcnt(12)
    ds_read_b64_tr_b16 v[52:53], v117 offset:0
    ds_read_b64_tr_b16 v[54:55], v117 offset:1024
    ds_read_b64_tr_b16 v[56:57], v117 offset:128
    ds_read_b64_tr_b16 v[58:59], v117 offset:1152
    s_waitcnt vmcnt(10)
    v_dot2_f32_bf16 v46, v36, v45, 0
    v_dot2_f32_bf16 v47, v36, v36, 0
    v_dot2_f32_bf16 v46, v37, v45, v46
    v_dot2_f32_bf16 v47, v37, v37, v47
    v_dot2_f32_bf16 v46, v38, v45, v46
    v_dot2_f32_bf16 v47, v38, v38, v47
    v_dot2_f32_bf16 v46, v39, v45, v46
    v_dot2_f32_bf16 v47, v39, v39, v47
    v_dot2_f32_bf16 v46, v40, v45, v46
    v_dot2_f32_bf16 v47, v40, v40, v47
    v_dot2_f32_bf16 v46, v41, v45, v46
    v_dot2_f32_bf16 v47, v41, v41, v47
    v_dot2_f32_bf16 v46, v42, v45, v46
    v_dot2_f32_bf16 v47, v42, v42, v47
    v_dot2_f32_bf16 v46, v43, v45, v46
    v_dot2_f32_bf16 v47, v43, v43, v47
    s_waitcnt lgkmcnt(0)
    v_and_b32 v75, 0xffff0000, v59
    v_lshlrev_b32 v74, 16, v59
    v_and_b32 v73, 0xffff0000, v58
    v_add_f32_dpp v46, v46, v46 row_ror:8 row_mask:0xf bank_mask:0xf
    v_add_f32_dpp v47, v47, v47 row_ror:8 row_mask:0xf bank_mask:0xf
    v_lshlrev_b32 v72, 16, v58
    v_add_f32_dpp v46, v46, v46 row_ror:4 row_mask:0xf bank_mask:0xf
    v_add_f32_dpp v47, v47, v47 row_ror:4 row_mask:0xf bank_mask:0xf
    v_and_b32 v71, 0xffff0000, v57
    v_add_f32_dpp v46, v46, v46 row_ror:2 row_mask:0xf bank_mask:0xf
    v_add_f32_dpp v47, v47, v47 row_ror:2 row_mask:0xf bank_mask:0xf
    v_lshlrev_b32 v70, 16, v57
    v_add_f32_dpp v46, v46, v46 row_ror:1 row_mask:0xf bank_mask:0xf
    v_add_f32_dpp v47, v47, v47 row_ror:1 row_mask:0xf bank_mask:0xf
    v_and_b32 v69, 0xffff0000, v56
    v_add_f32_dpp v46, v46, v46 row_bcast:15 row_mask:0xa bank_mask:0xf
    v_add_f32_dpp v47, v47, v47 row_bcast:15 row_mask:0xa bank_mask:0xf
    v_mul_f32 v46, 0xbb000000, v46
    v_fmamk_f32 v47, v47, 0x3b000000, v19
    v_fma_f32 v47, -v46, v46, v47
    v_max_f32 v47, v47, v19
    v_rsq_f32 v47, v47
    s_nop 0
    v_mul_f32 v46, v46, v47
    v_cndmask_b32 v46, v47, v46, vcc
    s_mov_b32 exec_lo, 0xc0000000
    s_mov_b32 exec_hi, 0xc0000000
    ds_write_b32 v20, v46 offset:25856
    s_mov_b64 exec, -1
    v_lshlrev_b32 v60, 16, v52
    v_and_b32 v61, 0xffff0000, v52
    v_lshlrev_b32 v62, 16, v53
    v_and_b32 v63, 0xffff0000, v53
    v_lshlrev_b32 v64, 16, v54
    v_and_b32 v65, 0xffff0000, v54
    v_lshlrev_b32 v66, 16, v55
    v_and_b32 v67, 0xffff0000, v55
    v_lshlrev_b32 v68, 16, v56
    v_mov_b32 v48, 25856
    s_waitcnt vmcnt(3)
    s_waitcnt lgkmcnt(0)
    s_barrier
    ds_read_b128 v[76:79], v48 offset:0
    ds_read_b128 v[80:83], v48 offset:16
    ds_read_b128 v[84:87], v48 offset:32
    ds_read_b128 v[88:91], v48 offset:48
    v_lshlrev_b32 v34, 16, v34
    v_lshlrev_b32 v35, 16, v35
    s_waitcnt lgkmcnt(0)
    v_pk_fma_f32 v[36:37], v[60:61], v[76:77], v[84:85]
    v_pk_fma_f32 v[38:39], v[62:63], v[78:79], v[86:87]
    v_pk_fma_f32 v[40:41], v[64:65], v[80:81], v[88:89]
    v_pk_fma_f32 v[42:43], v[66:67], v[82:83], v[90:91]
    v_cvt_pk_bf16_f32 v52, v36, v37
    v_cvt_pk_bf16_f32 v53, v38, v39
    v_cvt_pk_bf16_f32 v54, v40, v41
    v_cvt_pk_bf16_f32 v55, v42, v43
    v_min_u32 v52, -2, v52
    v_min_u32 v53, -2, v53
    v_min_u32 v54, -2, v54
    v_min_u32 v55, -2, v55
    buffer_store_dwordx4 v[52:55], v10, s[32:35], s76 offen offset:0 sc1
    v_pk_fma_f32 v[36:37], v[36:37], v[34:35], v[60:61] op_sel:[0,0,0] op_sel_hi:[1,0,1]
    v_pk_fma_f32 v[38:39], v[38:39], v[34:35], v[62:63] op_sel:[0,0,0] op_sel_hi:[1,0,1]
    v_pk_fma_f32 v[40:41], v[40:41], v[34:35], v[64:65] op_sel:[0,0,0] op_sel_hi:[1,0,1]
    v_pk_fma_f32 v[42:43], v[42:43], v[34:35], v[66:67] op_sel:[0,0,0] op_sel_hi:[1,0,1]
    v_cvt_pk_bf16_f32 v56, v36, v37
    v_cvt_pk_bf16_f32 v57, v38, v39
    v_cvt_pk_bf16_f32 v58, v40, v41
    v_cvt_pk_bf16_f32 v59, v42, v43
    v_min_u32 v56, -2, v56
    v_min_u32 v57, -2, v57
    v_min_u32 v58, -2, v58
    v_min_u32 v59, -2, v59
    buffer_store_dwordx4 v[56:59], v10, s[32:35], s77 offen offset:0 sc1
    v_pk_fma_f32 v[36:37], v[68:69], v[76:77], v[84:85]
    v_pk_fma_f32 v[38:39], v[70:71], v[78:79], v[86:87]
    v_pk_fma_f32 v[40:41], v[72:73], v[80:81], v[88:89]
    v_pk_fma_f32 v[42:43], v[74:75], v[82:83], v[90:91]
    v_cvt_pk_bf16_f32 v52, v36, v37
    v_cvt_pk_bf16_f32 v53, v38, v39
    v_cvt_pk_bf16_f32 v54, v40, v41
    v_cvt_pk_bf16_f32 v55, v42, v43
    v_min_u32 v52, -2, v52
    v_min_u32 v53, -2, v53
    v_min_u32 v54, -2, v54
    v_min_u32 v55, -2, v55
    buffer_store_dwordx4 v[52:55], v10, s[32:35], s76 offen offset:1024 sc1
    v_pk_fma_f32 v[36:37], v[36:37], v[34:35], v[68:69] op_sel:[0,1,0] op_sel_hi:[1,1,1]
    v_pk_fma_f32 v[38:39], v[38:39], v[34:35], v[70:71] op_sel:[0,1,0] op_sel_hi:[1,1,1]
    v_pk_fma_f32 v[40:41], v[40:41], v[34:35], v[72:73] op_sel:[0,1,0] op_sel_hi:[1,1,1]
    v_pk_fma_f32 v[42:43], v[42:43], v[34:35], v[74:75] op_sel:[0,1,0] op_sel_hi:[1,1,1]
    v_cvt_pk_bf16_f32 v56, v36, v37
    v_cvt_pk_bf16_f32 v57, v38, v39
    v_cvt_pk_bf16_f32 v58, v40, v41
    v_cvt_pk_bf16_f32 v59, v42, v43
    v_min_u32 v56, -2, v56
    v_min_u32 v57, -2, v57
    v_min_u32 v58, -2, v58
    v_min_u32 v59, -2, v59
    s_cmp_lg_u32 s48, 3
    s_cbranch_scc1 L_nop_4
    v_mov_b32 v20, 0
    global_load_dword v21, v20, s[26:27] sc1
L_nop_4:
    buffer_store_dwordx4 v[56:59], v10, s[32:35], s77 offen offset:1024 sc1
    v_lshlrev_b32 v28, 16, v28
    v_lshlrev_b32 v29, 16, v29
    v_lshlrev_b32 v30, 16, v30
    v_lshlrev_b32 v31, 16, v31
    v_lshlrev_b32 v32, 16, v32
    v_mul_f32 v28, 0x3fb8aa3b, v28
    v_mul_f32 v29, 0x3fb8aa3b, v29
    v_exp_f32 v28, v28
    v_exp_f32 v29, v29
    v_cvt_pk_bf16_f32 v28, v28, v28
    v_lshlrev_b32 v28, 16, v28
    v_cvt_pk_bf16_f32 v29, v29, v29
    v_lshlrev_b32 v29, 16, v29
    v_mul_f32 v29, v29, v28
    v_mul_f32 v30, v30, v28
    v_mul_f32 v31, v31, v28
    v_mul_f32 v32, v32, v28
    v_mul_f32 v29, 0xbfb8aa3b, v29
    v_mul_f32 v30, 0.15915494, v30
    v_add_f32 v42, v31, v31
    v_mul_f32 v43, -2.0, v32
    v_mul_f32 v44, 0x3f800000, v29
    s_add_u32 m0, s62, 0
    s_add_u32 s58, s94, 0
    buffer_load_dwordx4 v2, s[36:39], s58 offen offset:0 lds
    v_mul_f32 v45, 0x3f800000, v30
    v_mul_f32 v46, 0x41000000, v29
    v_mul_f32 v47, 0x41000000, v30
    v_mul_f32 v48, 0x43800000, v29
    v_mul_f32 v49, 0x43800000, v30
    v_exp_f32 v44, v44
    v_fract_f32 v45, v45
    v_exp_f32 v46, v46
    v_fract_f32 v47, v47
    v_exp_f32 v48, v48
    v_fract_f32 v49, v49
    v_cos_f32 v36, v45
    v_sin_f32 v37, v45
    v_cos_f32 v38, v47
    v_sin_f32 v39, v47
    v_cos_f32 v40, v49
    v_sin_f32 v41, v49
    v_pk_mul_f32 v[36:37], v[36:37], v[44:45] op_sel_hi:[1,0]
    v_pk_mul_f32 v[38:39], v[38:39], v[46:47] op_sel_hi:[1,0] neg_hi:[1,0]
    v_pk_mul_f32 v[40:41], v[40:41], v[48:49] op_sel_hi:[1,0]
    v_mov_b32 v32, 0x3f80
    s_mov_b32 m0, s86
    s_nop 0
    ds_write_addtid_b32 v32 offset:0
    v_pk_mul_f32 v[44:45], v[36:37], v[36:37] op_sel:[0,0] op_sel_hi:[0,1]
    s_add_u32 m0, s62, 0
    s_nop 0
    buffer_load_dwordx4 v3, s[36:39], s58 offen offset:1024 lds
    v_pk_mul_f32 v[56:57], v[38:39], v[38:39] op_sel:[0,0] op_sel_hi:[0,1]
    v_pk_mul_f32 v[60:61], v[42:43], v[38:39] op_sel:[0,0] op_sel_hi:[0,1]
    v_pk_mul_f32 v[66:67], v[40:41], v[40:41] op_sel:[0,0] op_sel_hi:[0,1]
    v_pk_fma_f32 v[44:45], v[36:37], v[36:37], v[44:45] op_sel:[1,1,0] op_sel_hi:[1,0,1] neg_lo:[0,1,0]
    v_pk_fma_f32 v[56:57], v[38:39], v[38:39], v[56:57] op_sel:[1,1,0] op_sel_hi:[1,0,1] neg_lo:[0,1,0]
    v_pk_fma_f32 v[60:61], v[42:43], v[38:39], v[60:61] op_sel:[1,1,0] op_sel_hi:[1,0,1] neg_lo:[0,1,0]
    v_pk_fma_f32 v[66:67], v[40:41], v[40:41], v[66:67] op_sel:[1,1,0] op_sel_hi:[1,0,1] neg_lo:[0,1,0]
    v_cvt_pk_bf16_f32 v29, v36, v37
    s_mov_b32 m0, s86
    s_nop 0
    ds_write_addtid_b32 v29 offset:528
    v_cvt_pk_bf16_f32 v30, v40, v41
    ds_write_addtid_b32 v30 offset:4224
    v_cvt_pk_bf16_f32 v31, v42, v43
    ds_write_addtid_b32 v31 offset:11088
    v_pk_mul_f32 v[46:47], v[44:45], v[36:37] op_sel:[0,0] op_sel_hi:[0,1]
    v_pk_mul_f32 v[48:49], v[44:45], v[44:45] op_sel:[0,0] op_sel_hi:[0,1]
    v_pk_mul_f32 v[58:59], v[56:57], v[56:57] op_sel:[0,0] op_sel_hi:[0,1]
    v_pk_mul_f32 v[62:63], v[42:43], v[56:57] op_sel:[0,0] op_sel_hi:[0,1]
    v_pk_mul_f32 v[64:65], v[60:61], v[56:57] op_sel:[0,0] op_sel_hi:[0,1]
    v_pk_mul_f32 v[68:69], v[66:67], v[40:41] op_sel:[0,0] op_sel_hi:[0,1]
    v_pk_mul_f32 v[70:71], v[66:67], v[66:67] op_sel:[0,0] op_sel_hi:[0,1]
    s_add_u32 m0, s62, 0
    s_nop 0
    buffer_load_dwordx4 v4, s[36:39], s58 offen offset:2048 lds
    v_pk_mul_f32 v[72:73], v[40:41], v[44:45] op_sel:[0,0] op_sel_hi:[0,1]
    v_pk_fma_f32 v[46:47], v[44:45], v[36:37], v[46:47] op_sel:[1,1,0] op_sel_hi:[1,0,1] neg_lo:[0,1,0]
    v_pk_fma_f32 v[48:49], v[44:45], v[44:45], v[48:49] op_sel:[1,1,0] op_sel_hi:[1,0,1] neg_lo:[0,1,0]
    v_pk_fma_f32 v[58:59], v[56:57], v[56:57], v[58:59] op_sel:[1,1,0] op_sel_hi:[1,0,1] neg_lo:[0,1,0]
    v_pk_fma_f32 v[62:63], v[42:43], v[56:57], v[62:63] op_sel:[1,1,0] op_sel_hi:[1,0,1] neg_lo:[0,1,0]
    v_pk_fma_f32 v[64:65], v[60:61], v[56:57], v[64:65] op_sel:[1,1,0] op_sel_hi:[1,0,1] neg_lo:[0,1,0]
    v_pk_fma_f32 v[68:69], v[66:67], v[40:41], v[68:69] op_sel:[1,1,0] op_sel_hi:[1,0,1] neg_lo:[0,1,0]
    v_pk_fma_f32 v[70:71], v[66:67], v[66:67], v[70:71] op_sel:[1,1,0] op_sel_hi:[1,0,1] neg_lo:[0,1,0]
    v_pk_fma_f32 v[72:73], v[40:41], v[44:45], v[72:73] op_sel:[1,1,0] op_sel_hi:[1,0,1] neg_lo:[0,1,0]
    v_cvt_pk_bf16_f32 v32, v44, v45
    s_mov_b32 m0, s86
    s_nop 0
    ds_write_addtid_b32 v32 offset:1056
    v_cvt_pk_bf16_f32 v29, v60, v61
    ds_write_addtid_b32 v29 offset:11616
    v_cvt_pk_bf16_f32 v30, v66, v67
    ds_write_addtid_b32 v30 offset:6336
    v_cvt_pk_bf16_f32 v31, v72, v73
    ds_write_addtid_b32 v31 offset:4752
    v_pk_mul_f32 v[50:51], v[48:49], v[36:37] op_sel:[0,0] op_sel_hi:[0,1]
    v_pk_mul_f32 v[52:53], v[48:49], v[44:45] op_sel:[0,0] op_sel_hi:[0,1]
    v_pk_mul_f32 v[54:55], v[48:49], v[46:47] op_sel:[0,0] op_sel_hi:[0,1]
    s_add_u32 m0, s62, 3072
    s_add_u32 s58, s94, 88064
    buffer_load_dwordx4 v2, s[36:39], s58 offen offset:0 lds
    v_pk_mul_f32 v[72:73], v[40:41], v[48:49] op_sel:[0,0] op_sel_hi:[0,1]
    v_pk_mul_f32 v[74:75], v[66:67], v[48:49] op_sel:[0,0] op_sel_hi:[0,1]
    v_pk_mul_f32 v[76:77], v[68:69], v[48:49] op_sel:[0,0] op_sel_hi:[0,1]
    v_pk_mul_f32 v[78:79], v[70:71], v[40:41] op_sel:[0,0] op_sel_hi:[0,1]
    v_pk_fma_f32 v[50:51], v[48:49], v[36:37], v[50:51] op_sel:[1,1,0] op_sel_hi:[1,0,1] neg_lo:[0,1,0]
    v_pk_fma_f32 v[52:53], v[48:49], v[44:45], v[52:53] op_sel:[1,1,0] op_sel_hi:[1,0,1] neg_lo:[0,1,0]
    v_pk_fma_f32 v[54:55], v[48:49], v[46:47], v[54:55] op_sel:[1,1,0] op_sel_hi:[1,0,1] neg_lo:[0,1,0]
    v_pk_fma_f32 v[72:73], v[40:41], v[48:49], v[72:73] op_sel:[1,1,0] op_sel_hi:[1,0,1] neg_lo:[0,1,0]
    v_pk_fma_f32 v[74:75], v[66:67], v[48:49], v[74:75] op_sel:[1,1,0] op_sel_hi:[1,0,1] neg_lo:[0,1,0]
    v_pk_fma_f32 v[76:77], v[68:69], v[48:49], v[76:77] op_sel:[1,1,0] op_sel_hi:[1,0,1] neg_lo:[0,1,0]
    v_pk_fma_f32 v[78:79], v[70:71], v[40:41], v[78:79] op_sel:[1,1,0] op_sel_hi:[1,0,1] neg_lo:[0,1,0]
    v_cvt_pk_bf16_f32 v32, v46, v47
    s_mov_b32 m0, s86
    s_nop 0
    ds_write_addtid_b32 v32 offset:1584
    v_cvt_pk_bf16_f32 v29, v48, v49
    ds_write_addtid_b32 v29 offset:2112
    v_cvt_pk_bf16_f32 v30, v62, v63
    ds_write_addtid_b32 v30 offset:12144
    v_cvt_pk_bf16_f32 v31, v64, v65
    ds_write_addtid_b32 v31 offset:12672
    v_cvt_pk_bf16_f32 v32, v68, v69
    s_add_u32 m0, s62, 3072
    s_nop 0
    buffer_load_dwordx4 v3, s[36:39], s58 offen offset:1024 lds
    s_mov_b32 m0, s86
    s_nop 0
    ds_write_addtid_b32 v32 offset:7392
    v_cvt_pk_bf16_f32 v29, v70, v71
    ds_write_addtid_b32 v29 offset:8448
    v_cvt_pk_bf16_f32 v30, v72, v73
    ds_write_addtid_b32 v30 offset:5280
    v_cvt_pk_bf16_f32 v31, v74, v75
    ds_write_addtid_b32 v31 offset:6864
    v_cvt_pk_bf16_f32 v32, v76, v77
    ds_write_addtid_b32 v32 offset:7920
    v_cvt_pk_bf16_f32 v29, v78, v79
    ds_write_addtid_b32 v29 offset:8976
    v_pk_mul_f32 v[72:73], v[40:41], v[52:53] op_sel:[0,0] op_sel_hi:[0,1]
    v_pk_mul_f32 v[74:75], v[70:71], v[66:67] op_sel:[0,0] op_sel_hi:[0,1]
    v_pk_mul_f32 v[76:77], v[70:71], v[68:69] op_sel:[0,0] op_sel_hi:[0,1]
    v_pk_mul_f32 v[78:79], v[70:71], v[70:71] op_sel:[0,0] op_sel_hi:[0,1]
    v_pk_fma_f32 v[72:73], v[40:41], v[52:53], v[72:73] op_sel:[1,1,0] op_sel_hi:[1,0,1] neg_lo:[0,1,0]
    v_pk_fma_f32 v[74:75], v[70:71], v[66:67], v[74:75] op_sel:[1,1,0] op_sel_hi:[1,0,1] neg_lo:[0,1,0]
    v_pk_fma_f32 v[76:77], v[70:71], v[68:69], v[76:77] op_sel:[1,1,0] op_sel_hi:[1,0,1] neg_lo:[0,1,0]
    v_pk_fma_f32 v[78:79], v[70:71], v[70:71], v[78:79] op_sel:[1,1,0] op_sel_hi:[1,0,1] neg_lo:[0,1,0]
    v_cvt_pk_bf16_f32 v30, v50, v51
    s_add_u32 m0, s62, 3072
    s_nop 0
    buffer_load_dwordx4 v4, s[36:39], s58 offen offset:2048 lds
    s_mov_b32 m0, s86
    s_nop 0
    ds_write_addtid_b32 v30 offset:2640
    v_cvt_pk_bf16_f32 v31, v52, v53
    ds_write_addtid_b32 v31 offset:3168
    v_cvt_pk_bf16_f32 v32, v54, v55
    ds_write_addtid_b32 v32 offset:3696
    v_cvt_pk_bf16_f32 v29, v72, v73
    ds_write_addtid_b32 v29 offset:5808
    v_cvt_pk_bf16_f32 v30, v74, v75
    ds_write_addtid_b32 v30 offset:9504
    v_cvt_pk_bf16_f32 v31, v76, v77
    ds_write_addtid_b32 v31 offset:10032
    v_cvt_pk_bf16_f32 v32, v78, v79
    ds_write_addtid_b32 v32 offset:10560
    s_waitcnt vmcnt(6)
    s_barrier
    s_cmp_lg_u32 s48, 3
    s_cbranch_scc1 L_pd_5
    v_cmp_gt_u32 vcc, 16, v21
    s_cbranch_vccz L_pk_7
L_pl_6:
    global_load_dword v21, v20, s[26:27] sc1
    s_waitcnt vmcnt(0)
    v_cmp_gt_u32 vcc, 16, v21
    s_cbranch_vccz L_pk_7
    s_sub_u32 s56, s56, 1
    s_cbranch_scc1 L_bail
    s_branch L_pl_6
L_pk_7:
    s_and_b32 s73, s2, 15
    s_lshl_b32 s73, s73, 7
    s_add_u32 s73, s73, 14979072
    v_lshlrev_b32 v20, 11, v1
    v_mov_b32 v21, 1
    s_mov_b64 exec, 0xffff
    buffer_atomic_add v21, v20, s[32:35], s73 offen sc1
    s_mov_b64 exec, -1
L_pd_5:
    v_pk_mul_f32 v[44:45], v[42:43], v[58:59] op_sel:[0,0] op_sel_hi:[0,1]
    v_pk_mul_f32 v[46:47], v[60:61], v[58:59] op_sel:[0,0] op_sel_hi:[0,1]
    v_pk_mul_f32 v[48:49], v[62:63], v[58:59] op_sel:[0,0] op_sel_hi:[0,1]
    v_pk_mul_f32 v[50:51], v[64:65], v[58:59] op_sel:[0,0] op_sel_hi:[0,1]
    v_pk_fma_f32 v[44:45], v[42:43], v[58:59], v[44:45] op_sel:[1,1,0] op_sel_hi:[1,0,1] neg_lo:[0,1,0]
    v_pk_fma_f32 v[46:47], v[60:61], v[58:59], v[46:47] op_sel:[1,1,0] op_sel_hi:[1,0,1] neg_lo:[0,1,0]
    v_pk_fma_f32 v[48:49], v[62:63], v[58:59], v[48:49] op_sel:[1,1,0] op_sel_hi:[1,0,1] neg_lo:[0,1,0]
    s_add_u32 m0, s62, 6144
    s_add_u32 s58, s94, 176128
    buffer_load_dwordx4 v2, s[36:39], s58 offen offset:0 lds
    v_pk_fma_f32 v[50:51], v[64:65], v[58:59], v[50:51] op_sel:[1,1,0] op_sel_hi:[1,0,1] neg_lo:[0,1,0]
    v_cvt_pk_bf16_f32 v29, v44, v45
    s_mov_b32 m0, s86
    s_nop 0
    ds_write_addtid_b32 v29 offset:13200
    v_cvt_pk_bf16_f32 v30, v46, v47
    ds_write_addtid_b32 v30 offset:13728
    v_cvt_pk_bf16_f32 v31, v48, v49
    ds_write_addtid_b32 v31 offset:14256
    v_cvt_pk_bf16_f32 v32, v50, v51
    ds_write_addtid_b32 v32 offset:14784
    v_pk_mul_f32 v[42:43], v[44:45], v[58:59] op_sel:[0,0] op_sel_hi:[0,1]
    v_pk_mul_f32 v[60:61], v[46:47], v[58:59] op_sel:[0,0] op_sel_hi:[0,1]
    v_pk_mul_f32 v[62:63], v[48:49], v[58:59] op_sel:[0,0] op_sel_hi:[0,1]
    v_pk_mul_f32 v[64:65], v[50:51], v[58:59] op_sel:[0,0] op_sel_hi:[0,1]
    v_pk_fma_f32 v[42:43], v[44:45], v[58:59], v[42:43] op_sel:[1,1,0] op_sel_hi:[1,0,1] neg_lo:[0,1,0]
    v_pk_fma_f32 v[60:61], v[46:47], v[58:59], v[60:61] op_sel:[1,1,0] op_sel_hi:[1,0,1] neg_lo:[0,1,0]
    v_pk_fma_f32 v[62:63], v[48:49], v[58:59], v[62:63] op_sel:[1,1,0] op_sel_hi:[1,0,1] neg_lo:[0,1,0]
    v_pk_fma_f32 v[64:65], v[50:51], v[58:59], v[64:65] op_sel:[1,1,0] op_sel_hi:[1,0,1] neg_lo:[0,1,0]
    v_cvt_pk_bf16_f32 v29, v42, v43
    ds_write_addtid_b32 v29 offset:15312
    v_cvt_pk_bf16_f32 v30, v60, v61
    s_add_u32 m0, s62, 6144
    s_nop 0
    buffer_load_dwordx4 v3, s[36:39], s58 offen offset:1024 lds
    s_mov_b32 m0, s86
    s_nop 0
    ds_write_addtid_b32 v30 offset:15840
    v_cvt_pk_bf16_f32 v31, v62, v63
    ds_write_addtid_b32 v31 offset:16368
    v_cvt_pk_bf16_f32 v32, v64, v65
    ds_write_addtid_b32 v32 offset:16896
    v_pk_mul_f32 v[44:45], v[42:43], v[58:59] op_sel:[0,0] op_sel_hi:[0,1]
    v_pk_mul_f32 v[46:47], v[60:61], v[58:59] op_sel:[0,0] op_sel_hi:[0,1]
    v_pk_mul_f32 v[48:49], v[62:63], v[58:59] op_sel:[0,0] op_sel_hi:[0,1]
    v_pk_mul_f32 v[50:51], v[64:65], v[58:59] op_sel:[0,0] op_sel_hi:[0,1]
    v_pk_fma_f32 v[44:45], v[42:43], v[58:59], v[44:45] op_sel:[1,1,0] op_sel_hi:[1,0,1] neg_lo:[0,1,0]
    v_pk_fma_f32 v[46:47], v[60:61], v[58:59], v[46:47] op_sel:[1,1,0] op_sel_hi:[1,0,1] neg_lo:[0,1,0]
    v_pk_fma_f32 v[48:49], v[62:63], v[58:59], v[48:49] op_sel:[1,1,0] op_sel_hi:[1,0,1] neg_lo:[0,1,0]
    v_pk_fma_f32 v[50:51], v[64:65], v[58:59], v[50:51] op_sel:[1,1,0] op_sel_hi:[1,0,1] neg_lo:[0,1,0]
    v_cvt_pk_bf16_f32 v29, v44, v45
    ds_write_addtid_b32 v29 offset:17424
    v_cvt_pk_bf16_f32 v30, v46, v47
    ds_write_addtid_b32 v30 offset:17952
    v_cvt_pk_bf16_f32 v31, v48, v49
    ds_write_addtid_b32 v31 offset:18480
    v_cvt_pk_bf16_f32 v32, v50, v51
    s_add_u32 m0, s62, 6144
    s_nop 0
    buffer_load_dwordx4 v4, s[36:39], s58 offen offset:2048 lds
    s_mov_b32 m0, s86
    s_nop 0
    ds_write_addtid_b32 v32 offset:19008
    v_pk_mul_f32 v[42:43], v[44:45], v[58:59] op_sel:[0,0] op_sel_hi:[0,1]
    v_pk_mul_f32 v[60:61], v[46:47], v[58:59] op_sel:[0,0] op_sel_hi:[0,1]
    v_pk_mul_f32 v[62:63], v[48:49], v[58:59] op_sel:[0,0] op_sel_hi:[0,1]
    v_pk_mul_f32 v[64:65], v[50:51], v[58:59] op_sel:[0,0] op_sel_hi:[0,1]
    v_pk_fma_f32 v[42:43], v[44:45], v[58:59], v[42:43] op_sel:[1,1,0] op_sel_hi:[1,0,1] neg_lo:[0,1,0]
    v_pk_fma_f32 v[60:61], v[46:47], v[58:59], v[60:61] op_sel:[1,1,0] op_sel_hi:[1,0,1] neg_lo:[0,1,0]
    v_pk_fma_f32 v[62:63], v[48:49], v[58:59], v[62:63] op_sel:[1,1,0] op_sel_hi:[1,0,1] neg_lo:[0,1,0]
    v_pk_fma_f32 v[64:65], v[50:51], v[58:59], v[64:65] op_sel:[1,1,0] op_sel_hi:[1,0,1] neg_lo:[0,1,0]
    v_cvt_pk_bf16_f32 v29, v42, v43
    ds_write_addtid_b32 v29 offset:19536
    v_cvt_pk_bf16_f32 v30, v60, v61
    ds_write_addtid_b32 v30 offset:20064
    v_cvt_pk_bf16_f32 v31, v62, v63
    ds_write_addtid_b32 v31 offset:20592
    v_cvt_pk_bf16_f32 v32, v64, v65
    ds_write_addtid_b32 v32 offset:21120
    v_pk_mul_f32 v[44:45], v[42:43], v[58:59] op_sel:[0,0] op_sel_hi:[0,1]
    v_pk_mul_f32 v[46:47], v[60:61], v[58:59] op_sel:[0,0] op_sel_hi:[0,1]
    v_pk_mul_f32 v[48:49], v[62:63], v[58:59] op_sel:[0,0] op_sel_hi:[0,1]
    s_add_u32 m0, s62, 9216
    s_add_u32 s58, s94, 264192
    buffer_load_dwordx4 v2, s[36:39], s58 offen offset:0 lds
    v_pk_mul_f32 v[50:51], v[64:65], v[58:59] op_sel:[0,0] op_sel_hi:[0,1]
    v_pk_fma_f32 v[44:45], v[42:43], v[58:59], v[44:45] op_sel:[1,1,0] op_sel_hi:[1,0,1] neg_lo:[0,1,0]
    v_pk_fma_f32 v[46:47], v[60:61], v[58:59], v[46:47] op_sel:[1,1,0] op_sel_hi:[1,0,1] neg_lo:[0,1,0]
    v_pk_fma_f32 v[48:49], v[62:63], v[58:59], v[48:49] op_sel:[1,1,0] op_sel_hi:[1,0,1] neg_lo:[0,1,0]
    v_pk_fma_f32 v[50:51], v[64:65], v[58:59], v[50:51] op_sel:[1,1,0] op_sel_hi:[1,0,1] neg_lo:[0,1,0]
    v_cvt_pk_bf16_f32 v29, v44, v45
    s_mov_b32 m0, s86
    s_nop 0
    ds_write_addtid_b32 v29 offset:21648
    v_cvt_pk_bf16_f32 v30, v46, v47
    ds_write_addtid_b32 v30 offset:22176
    v_cvt_pk_bf16_f32 v31, v48, v49
    ds_write_addtid_b32 v31 offset:22704
    v_cvt_pk_bf16_f32 v32, v50, v51
    ds_write_addtid_b32 v32 offset:23232
    v_pk_mul_f32 v[42:43], v[44:45], v[58:59] op_sel:[0,0] op_sel_hi:[0,1]
    v_pk_mul_f32 v[60:61], v[46:47], v[58:59] op_sel:[0,0] op_sel_hi:[0,1]
    v_pk_mul_f32 v[62:63], v[48:49], v[58:59] op_sel:[0,0] op_sel_hi:[0,1]
    v_pk_mul_f32 v[64:65], v[50:51], v[58:59] op_sel:[0,0] op_sel_hi:[0,1]
    v_pk_fma_f32 v[42:43], v[44:45], v[58:59], v[42:43] op_sel:[1,1,0] op_sel_hi:[1,0,1] neg_lo:[0,1,0]
    v_pk_fma_f32 v[60:61], v[46:47], v[58:59], v[60:61] op_sel:[1,1,0] op_sel_hi:[1,0,1] neg_lo:[0,1,0]
    v_pk_fma_f32 v[62:63], v[48:49], v[58:59], v[62:63] op_sel:[1,1,0] op_sel_hi:[1,0,1] neg_lo:[0,1,0]
    s_add_u32 m0, s62, 9216
    s_nop 0
    buffer_load_dwordx4 v3, s[36:39], s58 offen offset:1024 lds
    v_pk_fma_f32 v[64:65], v[50:51], v[58:59], v[64:65] op_sel:[1,1,0] op_sel_hi:[1,0,1] neg_lo:[0,1,0]
    v_cvt_pk_bf16_f32 v29, v42, v43
    s_mov_b32 m0, s86
    s_nop 0
    ds_write_addtid_b32 v29 offset:23760
    v_cvt_pk_bf16_f32 v30, v60, v61
    ds_write_addtid_b32 v30 offset:24288
    v_cvt_pk_bf16_f32 v31, v62, v63
    ds_write_addtid_b32 v31 offset:24816
    v_cvt_pk_bf16_f32 v32, v64, v65
    ds_write_addtid_b32 v32 offset:25344
    v_pk_mul_f32 v[44:45], v[42:43], v[58:59] op_sel:[0,0] op_sel_hi:[0,1]
    v_pk_mul_f32 v[46:47], v[60:61], v[58:59] op_sel:[0,0] op_sel_hi:[0,1]
    v_pk_mul_f32 v[48:49], v[62:63], v[58:59] op_sel:[0,0] op_sel_hi:[0,1]
    v_pk_mul_f32 v[50:51], v[64:65], v[58:59] op_sel:[0,0] op_sel_hi:[0,1]
    v_pk_fma_f32 v[44:45], v[42:43], v[58:59], v[44:45] op_sel:[1,1,0] op_sel_hi:[1,0,1] neg_lo:[0,1,0]
    v_pk_fma_f32 v[46:47], v[60:61], v[58:59], v[46:47] op_sel:[1,1,0] op_sel_hi:[1,0,1] neg_lo:[0,1,0]
    v_pk_fma_f32 v[48:49], v[62:63], v[58:59], v[48:49] op_sel:[1,1,0] op_sel_hi:[1,0,1] neg_lo:[0,1,0]
    v_pk_fma_f32 v[50:51], v[64:65], v[58:59], v[50:51] op_sel:[1,1,0] op_sel_hi:[1,0,1] neg_lo:[0,1,0]
    v_cvt_pk_bf16_f32 v29, v44, v45
    ds_write_addtid_b32 v29 offset:25872
    v_cvt_pk_bf16_f32 v30, v46, v47
    s_add_u32 m0, s62, 9216
    s_nop 0
    buffer_load_dwordx4 v4, s[36:39], s58 offen offset:2048 lds
    s_mov_b32 m0, s86
    s_nop 0
    ds_write_addtid_b32 v30 offset:26400
    v_cvt_pk_bf16_f32 v31, v48, v49
    ds_write_addtid_b32 v31 offset:26928
    v_cvt_pk_bf16_f32 v32, v50, v51
    ds_write_addtid_b32 v32 offset:27456
    s_add_u32 m0, s62, 12288
    s_add_u32 s58, s95, 0
    buffer_load_dwordx4 v2, s[36:39], s58 offen offset:0 lds
    s_add_u32 m0, s62, 12288
    s_nop 0
    buffer_load_dwordx4 v3, s[36:39], s58 offen offset:1024 lds
    s_add_u32 m0, s62, 12288
    s_nop 0
    buffer_load_dwordx4 v4, s[36:39], s58 offen offset:2048 lds
    s_add_u32 m0, s62, 15360
    s_add_u32 s58, s95, 88064
    buffer_load_dwordx4 v2, s[36:39], s58 offen offset:0 lds
    s_add_u32 m0, s62, 15360
    s_nop 0
    buffer_load_dwordx4 v3, s[36:39], s58 offen offset:1024 lds
    s_add_u32 m0, s62, 15360
    s_nop 0
    buffer_load_dwordx4 v4, s[36:39], s58 offen offset:2048 lds
    s_waitcnt lgkmcnt(0)
    s_barrier
    v_lshrrev_b32 v13, 5, v1
    v_and_b32 v11, 31, v1
    v_lshlrev_b32 v11, 4, v11
    v_lshl_add_u32 v11, v13, 15, v11
    v_bfe_u32 v13, v1, 3, 1
    v_mul_u32_u24 v13, 3968, v13
    v_add_u32 v13, v13, v10
    s_add_u32 s80, s30, 0
    buffer_store_dwordx4 v[6:9], v11, s[32:35], s80 offen sc1
    s_add_u32 s80, s30, 8192
    buffer_store_dwordx4 v[6:9], v11, s[32:35], s80 offen sc1
    s_mul_i32 s98, s48, 11
    s_min_u32 s98, s98, 32
    s_mul_i32 s99, s2, 43
    s_add_u32 s98, s98, s99
    s_lshl_b32 s98, s98, 7
    v_min_u32 v13, 10, v1
    v_lshlrev_b32 v13, 7, v13
    buffer_load_dword v12, v13, s[40:43], s98 offen
    ds_read_b128 v[44:47], v110 offset:0
    ds_read_b128 v[48:51], v111 offset:0
    ds_read_b128 v[52:55], v110 offset:8448
    ds_read_b128 v[56:59], v110 offset:64
    ds_read_b128 v[60:63], v111 offset:64
    ds_read_b128 v[64:67], v110 offset:8512
    ds_read_b128 v[68:71], v110 offset:128
    ds_read_b128 v[72:75], v111 offset:128
    ds_read_b128 v[76:79], v110 offset:8576
    ds_read_b128 v[80:83], v110 offset:192
    ds_read_b128 v[84:87], v111 offset:192
    ds_read_b128 v[88:91], v110 offset:8640
    s_waitcnt lgkmcnt(10)
    v_mfma_f32_16x16x32_bf16 v[36:39], v[44:47], v[48:51], 0
    ds_read_b128 v[44:47], v110 offset:256
    s_waitcnt lgkmcnt(10)
    v_mfma_f32_16x16x32_bf16 v[40:43], v[52:55], v[48:51], 0
    ds_read_b128 v[52:55], v111 offset:256
    s_waitcnt lgkmcnt(9)
    v_mfma_f32_16x16x32_bf16 v[36:39], v[56:59], v[60:63], v[36:39]
    ds_read_b128 v[48:51], v110 offset:8704
    s_waitcnt lgkmcnt(9)
    v_mfma_f32_16x16x32_bf16 v[40:43], v[64:67], v[60:63], v[40:43]
    ds_read_b128 v[56:59], v110 offset:320
    s_waitcnt lgkmcnt(8)
    v_mfma_f32_16x16x32_bf16 v[36:39], v[68:71], v[72:75], v[36:39]
    ds_read_b128 v[64:67], v111 offset:320
    s_waitcnt lgkmcnt(8)
    v_mfma_f32_16x16x32_bf16 v[40:43], v[76:79], v[72:75], v[40:43]
    ds_read_b128 v[60:63], v110 offset:8768
    s_waitcnt lgkmcnt(7)
    v_mfma_f32_16x16x32_bf16 v[36:39], v[80:83], v[84:87], v[36:39]
    ds_read_b128 v[68:71], v110 offset:384
    s_waitcnt lgkmcnt(7)
    v_mfma_f32_16x16x32_bf16 v[40:43], v[88:91], v[84:87], v[40:43]
    ds_read_b128 v[76:79], v111 offset:384
    s_waitcnt lgkmcnt(6)
    v_mfma_f32_16x16x32_bf16 v[36:39], v[44:47], v[52:55], v[36:39]
    ds_read_b128 v[72:75], v110 offset:8832
    s_waitcnt lgkmcnt(6)
    v_mfma_f32_16x16x32_bf16 v[40:43], v[48:51], v[52:55], v[40:43]
    ds_read_b128 v[80:83], v110 offset:448
    s_waitcnt lgkmcnt(5)
    v_mfma_f32_16x16x32_bf16 v[36:39], v[56:59], v[64:67], v[36:39]
    ds_read_b128 v[88:91], v111 offset:448
    s_waitcnt lgkmcnt(5)
    v_mfma_f32_16x16x32_bf16 v[40:43], v[60:63], v[64:67], v[40:43]
    ds_read_b128 v[84:87], v110 offset:8896
    s_waitcnt lgkmcnt(4)
    v_mfma_f32_16x16x32_bf16 v[36:39], v[68:71], v[76:79], v[36:39]
    s_waitcnt lgkmcnt(3)
    v_mfma_f32_16x16x32_bf16 v[40:43], v[72:75], v[76:79], v[40:43]
    s_waitcnt lgkmcnt(1)
    v_mfma_f32_16x16x32_bf16 v[36:39], v[80:83], v[88:91], v[36:39]
    s_waitcnt lgkmcnt(0)
    v_mfma_f32_16x16x32_bf16 v[40:43], v[84:87], v[88:91], v[40:43]
    v_lshrrev_b32 v22, 2, v1
    v_mul_u32_u24 v22, 96, v22
    v_and_b32 v23, 3, v1
    v_lshl_add_u32 v22, v23, 3, v22
    v_add_u32 v22, s62, v22
    v_mul_u32_u24 v26, 96, v1
    v_add_u32 v26, s62, v26
    v_mov_b32 v24, 0x3f803f80
    v_mov_b32 v25, 0x3f803f80
    s_waitcnt vmcnt(15)
    s_cmp_lg_u32 s48, 3
    s_cbranch_scc1 L_on_8
    ds_write_b64 v26, v[24:25] offset:56
L_on_8:
    ds_read_b64_tr_b16 a[176:177], v22 offset:0
    ds_read_b64_tr_b16 a[178:179], v22 offset:1536
    ds_read_b64_tr_b16 a[240:241], v22 offset:32
    ds_read_b64_tr_b16 a[242:243], v22 offset:1568
    ds_read_b64_tr_b16 v[192:193], v22 offset:64
    ds_read_b64_tr_b16 v[194:195], v22 offset:1600
    v_cvt_pk_bf16_f32 v36, v36, v37
    v_cvt_pk_bf16_f32 v38, v38, v39
    v_cvt_pk_bf16_f32 v40, v40, v41
    v_cvt_pk_bf16_f32 v42, v42, v43
    ds_write_b32 v112, v36
    ds_write_b32 v113, v38
    s_mov_b32 exec_lo, -1
    s_mov_b32 exec_hi, 0
    ds_write_b16 v114, v40 offset:1024
    s_mov_b32 exec_lo, 65535
    s_mov_b32 exec_hi, 0
    ds_write_b16_d16_hi v114, v40 offset:1088
    ds_write_b16 v114, v42 offset:1152
    ds_write_b16_d16_hi v114, v42 offset:1216
    s_mov_b64 exec, -1
    ds_read_b64_tr_b16 a[180:181], v22 offset:3072
    ds_read_b64_tr_b16 a[182:183], v22 offset:4608
    ds_read_b64_tr_b16 a[244:245], v22 offset:3104
    ds_read_b64_tr_b16 a[246:247], v22 offset:4640
    ds_read_b64_tr_b16 v[196:197], v22 offset:3136
    ds_read_b64_tr_b16 v[198:199], v22 offset:4672
    s_waitcnt vmcnt(9)
    s_cmp_lg_u32 s48, 3
    s_cbranch_scc1 L_on_9
    ds_write_b64 v26, v[24:25] offset:6200
L_on_9:
    ds_read_b64_tr_b16 a[184:185], v22 offset:6144
    ds_read_b64_tr_b16 a[186:187], v22 offset:7680
L_stub_0:
    s_cbranch_execz L_stub_4
    s_nop 0
    ds_read_b64_tr_b16 a[248:249], v22 offset:6176
    ds_read_b64_tr_b16 a[250:251], v22 offset:7712
    ds_read_b64_tr_b16 v[200:201], v22 offset:6208
    s_waitcnt lgkmcnt(11)
    s_barrier
    ds_read_u16 v36, v92
    ds_read_u16 v37, v93
    ds_read_u16 v38, v94
    ds_read_u16 v39, v95
    ds_read_u16 v40, v96
    ds_read_u16 v41, v97
    ds_read_u16 v42, v98
    ds_read_u16 v43, v99
    ds_read_u16 v44, v100
    ds_read_u16 v45, v101
    ds_read_u16 v46, v102
    ds_read_u16 v47, v103
    ds_read_u16 v48, v104
    ds_read_u16 v49, v105
    ds_read_u16 v50, v106
    ds_read_u16 v51, v107
    ds_read_u16 v52, v108
    ds_read_b64_tr_b16 v[202:203], v22 offset:7744
    ds_read_b64_tr_b16 a[188:189], v22 offset:9216
    ds_read_b64_tr_b16 a[190:191], v22 offset:10752
    ds_read_b64_tr_b16 a[252:253], v22 offset:9248
    ds_read_b64_tr_b16 a[254:255], v22 offset:10784
    ds_read_b64_tr_b16 v[204:205], v22 offset:9280
    ds_read_b64_tr_b16 v[206:207], v22 offset:10816
    s_waitcnt vmcnt(3)
    s_cmp_lg_u32 s48, 3
    s_cbranch_scc1 L_on_10
    ds_write_b64 v26, v[24:25] offset:12344
L_on_10:
    ds_read_b64_tr_b16 a[192:193], v22 offset:12288
    ds_read_b64_tr_b16 a[194:195], v22 offset:13824
    ds_read_b64_tr_b16 v[144:145], v22 offset:12320
    ds_read_b64_tr_b16 v[146:147], v22 offset:13856
    ds_read_b64_tr_b16 v[208:209], v22 offset:12352
    ds_read_b64_tr_b16 v[210:211], v22 offset:13888
    ds_read_b64_tr_b16 a[196:197], v22 offset:15360
    ds_read_b64_tr_b16 a[198:199], v22 offset:16896
    ds_read_b64_tr_b16 v[148:149], v22 offset:15392
    ds_read_b64_tr_b16 v[150:151], v22 offset:16928
    ds_read_b64_tr_b16 v[212:213], v22 offset:15424
    ds_read_b64_tr_b16 v[214:215], v22 offset:16960
    v_mov_b64 v[72:73], 0
    s_waitcnt lgkmcnt(0)
    v_lshl_or_b32 v56, v37, 16, v36
    v_lshl_or_b32 v64, v38, 16, v37
    v_lshl_or_b32 v57, v39, 16, v38
    v_lshl_or_b32 v65, v40, 16, v39
    v_lshl_or_b32 v58, v41, 16, v40
    v_lshl_or_b32 v66, v42, 16, v41
    s_add_u32 m0, s62, 0
    s_add_u32 s58, s95, 176128
    buffer_load_dwordx4 v2, s[36:39], s58 offen offset:0 lds
    v_lshl_or_b32 v59, v43, 16, v42
    v_lshl_or_b32 v67, v44, 16, v43
    v_lshl_or_b32 v60, v45, 16, v44
    v_lshl_or_b32 v68, v46, 16, v45
    v_lshl_or_b32 v61, v47, 16, v46
    v_lshl_or_b32 v69, v48, 16, v47
    buffer_load_dwordx4 v3, s[36:39], s58 offen offset:1024 lds
    v_lshl_or_b32 v62, v49, 16, v48
    v_lshl_or_b32 v70, v50, 16, v49
    v_lshl_or_b32 v63, v51, 16, v50
    v_lshl_or_b32 v71, v52, 16, v51
    ds_write_b128 v115, v[56:59] offset:0
    ds_write_b128 v115, v[60:63] offset:16
    ds_write_b128 v115, v[64:67] offset:4160
    ds_write_b128 v115, v[68:71] offset:4176
    ds_write_b64 v116, v[72:73] offset:4096
    v_and_b32 v104, 15, v1
    buffer_load_dwordx4 v4, s[36:39], s58 offen offset:2048 lds
    v_lshrrev_b32 v105, 4, v1
    v_and_b32 v106, 1, v1
    v_xor_b32 v106, 1, v106
    v_mul_u32_u24 v107, 4158, v106
    v_lshl_add_u32 v108, v105, 3, v104
    v_lshlrev_b32 v108, 1, v108
    s_add_u32 m0, s62, 3072
    s_add_u32 s58, s95, 264192
    buffer_load_dwordx4 v2, s[36:39], s58 offen offset:0 lds
    v_sub_u32 v107, v107, v108
    s_mul_i32 s75, s67, 8320
    s_lshl_b32 s76, s57, 8
    s_sub_u32 s75, s75, s76
    s_add_u32 s75, s75, 3406
    v_add_u32 v52, s75, v107
    buffer_load_dwordx4 v3, s[36:39], s58 offen offset:1024 lds
    v_subrev_u32 v53, 1024, v52
    v_subrev_u32 v54, 2048, v52
    v_subrev_u32 v55, 3072, v52
    v_lshlrev_b32 v56, 5, v104
    v_lshlrev_b32 v107, 4, v105
    v_sub_u32 v56, v56, v107
    buffer_load_dwordx4 v4, s[36:39], s58 offen offset:2048 lds
    s_mul_i32 s75, s67, 4608
    s_sub_u32 s75, s75, s76
    s_add_u32 s75, s75, 16976
    v_add_u32 v56, s75, v56
    s_lshl_b32 s75, s67, 13
    s_add_u32 s75, s75, 60416
    v_lshl_add_u32 v57, v1, 4, s75
    s_add_u32 m0, s62, 6144
    s_add_u32 s58, s100, 0
    buffer_load_dwordx4 v2, s[36:39], s58 offen offset:0 lds
    v_and_b32 v106, 1, v105
    v_mul_u32_u24 v106, 3, v106
    v_xor_b32 v106, s57, v106
    v_lshlrev_b32 v106, 9, v106
    v_lshrrev_b32 v107, 1, v105
    v_mul_u32_u24 v108, 3, v107
    buffer_load_dwordx4 v3, s[36:39], s58 offen offset:1024 lds
    v_xor_b32 v108, s57, v108
    v_lshlrev_b32 v108, 5, v108
    v_and_or_b32 v108, v105, 1, v108
    v_lshl_add_u32 v106, v107, 8, v106
    v_lshl_add_u32 v58, v104, 4, v106
    v_lshl_add_u32 v59, v104, 1, v108
    buffer_load_dwordx4 v4, s[36:39], s58 offen offset:2048 lds
    v_lshlrev_b32 v59, 14, v59
    v_lshl_add_u32 v126, v1, 4, s91
    v_lshlrev_b32 v105, 1, v105
    v_xor_b32 v105, v105, v1
    v_and_b32 v105, 3, v105
    v_lshrrev_b32 v127, 2, v1
    s_add_u32 m0, s62, 9216
    s_add_u32 s58, s100, 88064
    buffer_load_dwordx4 v2, s[36:39], s58 offen offset:0 lds
    v_lshlrev_b32 v127, 12, v127
    v_lshl_add_u32 v127, v105, 4, v127
    s_add_u32 s90, s92, 8192
    s_lshl_b32 s77, s49, 1
    s_add_u32 s77, s77, s67
    s_lshl_b32 s77, s77, 12
    s_add_u32 s77, s77, 10485760
    s_movk_i32 s89, 0x3f80
    v_lshrrev_b32 v108, 4, v1
    buffer_load_dwordx4 v3, s[36:39], s58 offen offset:1024 lds
    v_and_b32 v109, 15, v1
    v_lshlrev_b32 v108, 3, v108
    v_sub_u32 v109, v109, v108
    v_and_b32 v110, 1, v1
    v_lshlrev_b32 v110, 4, v110
    v_lshlrev_b32 v110, v110, s89
    buffer_load_dwordx4 v4, s[36:39], s58 offen offset:2048 lds
    v_ashrrev_i32 v111, 1, v109
    v_cmp_eq_u32 s[78:79], 0, v111
    v_cmp_eq_u32 s[80:81], 1, v111
    v_cmp_eq_u32 s[82:83], 2, v111
    v_cmp_eq_u32 s[84:85], 3, v111
    v_cndmask_b32 v128, 0, v110, s[78:79]
    s_add_u32 m0, s62, 12288
    s_add_u32 s58, s100, 176128
    buffer_load_dwordx4 v2, s[36:39], s58 offen offset:0 lds
    v_cndmask_b32 v129, 0, v110, s[80:81]
    v_cndmask_b32 v130, 0, v110, s[82:83]
    v_cndmask_b32 v131, 0, v110, s[84:85]
    v_cmp_eq_u32 s[78:79], -8, v111
    v_cmp_eq_u32 s[80:81], -7, v111
    v_cmp_eq_u32 s[82:83], -6, v111
    v_cmp_eq_u32 s[84:85], -5, v111
    v_cndmask_b32 v132, 0, v110, s[78:79]
    buffer_load_dwordx4 v3, s[36:39], s58 offen offset:1024 lds
    v_cndmask_b32 v133, 0, v110, s[80:81]
    v_cndmask_b32 v134, 0, v110, s[82:83]
    v_cndmask_b32 v135, 0, v110, s[84:85]
    s_lshr_b32 s78, s49, 5
    s_lshl_b32 s78, s78, 10
    s_bfe_u32 s79, s49, 0x40001
    s_and_b32 s14, s79, 1
    s_mul_i32 s79, s79, 360448
    s_add_u32 s79, s79, s78
    s_and_b32 s13, s51, 1
    s_lshl2_add_u32 s12, s13, s48
    s_lshl_b32 s12, s12, 13
    s_add_u32 s12, s12, s79
    s_cmp_eq_u32 s48, 2
    s_cselect_b32 s80, 2, s13
    s_cselect_b32 s13, s13, s48
    s_xor_b32 s14, s14, s13
    s_lshl1_add_u32 s13, s80, s13
    s_add_u32 s13, s13, 32
    s_lshl_b32 s13, s13, 13
    s_add_u32 s13, s13, s79
    s_lshl2_add_u32 s79, s50, s48
    s_lshl_b32 s11, s79, 5
    s_add_u32 s11, s11, 14942208
    s_and_b32 s79, s79, 15
    s_mul_i32 s79, s79, 360448
    s_add_u32 s79, s79, s78
    s_add_u32 s6, s79, 262144
    s_lshl_b32 s80, s57, 16
    s_add_u32 s5, s79, s80
    s_xor_b32 s80, s80, 0x10000
    s_add_u32 s4, s79, s80
    s_mul_i32 s10, s48, 12288
    s_add_u32 s10, s10, 93184
    s_lshl_b32 s15, s48, 12
    s_add_u32 s20, s15, 27648
    s_and_b32 s65, s50, 0
    s_lshl_b32 s65, s65, 13
    s_xor_b32 s15, s15, s65
    s_add_u32 s15, s15, s50
    s_lshl_b32 s15, s15, 6
    s_add_u32 s15, s15, 10485760
    s_lshl1_add_u32 s21, s51, s67
    s_lshl_b32 s22, s54, 7
    s_add_u32 s22, s22, s21
    s_lshl_b32 s22, s22, 6
    s_lshl_b32 s21, s21, 11
    s_xor_b32 s21, s21, s65
    s_andn2_b32 s23, s31, 0x7ff
    s_xor_b32 s80, s48, 3
    s_mul_i32 s80, s80, 12288
    s_add_u32 s7, s80, 93184
    s_xor_b32 s80, s48, 1
    s_mul_i32 s80, s80, 12288
    s_add_u32 s8, s80, 95232
    s_xor_b32 s80, s48, 2
    s_mul_i32 s80, s80, 12288
    s_add_u32 s9, s80, 97280
    s_and_b32 s80, s50, 0
    s_xor_b32 s80, s80, 0
    s_mul_i32 s87, s80, 98304
    s_lshr_b32 s80, s80, 1
    s_mul_i32 s80, s80, 20480
    s_sub_u32 s87, s87, s80
    s_add_u32 s87, s87, s66
    s_and_b32 s80, s50, 0
    s_xor_b32 s80, s80, 1
    s_mul_i32 s88, s80, 98304
    s_lshr_b32 s80, s80, 1
    s_mul_i32 s80, s80, 20480
    s_sub_u32 s88, s88, s80
    s_add_u32 s88, s88, s66
    s_and_b32 s80, s50, 0
    s_xor_b32 s80, s80, 2
    s_mul_i32 s98, s80, 98304
    s_lshr_b32 s80, s80, 1
    s_mul_i32 s80, s80, 20480
    s_sub_u32 s98, s98, s80
    s_add_u32 s98, s98, s66
    s_and_b32 s80, s50, 0
    s_xor_b32 s80, s80, 3
    s_mul_i32 s99, s80, 98304
    s_lshr_b32 s80, s80, 1
    s_mul_i32 s80, s80, 20480
    s_sub_u32 s99, s99, s80
    s_add_u32 s99, s99, s66
    s_mov_b32 s24, 572662306
    s_mov_b32 s25, 572662306
    s_mov_b32 s68, 1145324612
    s_mov_b32 s69, 1145324612
    s_mov_b32 s70, 2290649224
    s_mov_b32 s71, 2290649224
    buffer_load_dwordx4 v4, s[36:39], s58 offen offset:2048 lds
    s_add_u32 m0, s62, 15360
    s_add_u32 s58, s100, 264192
    buffer_load_dwordx4 v2, s[36:39], s58 offen offset:0 lds
    buffer_load_dwordx4 v3, s[36:39], s58 offen offset:1024 lds
    buffer_load_dwordx4 v4, s[36:39], s58 offen offset:2048 lds
    s_cmp_lg_u32 s48, 3
    s_cbranch_scc1 L_pd_11
    s_and_b32 s74, s2, 15
    s_lshl_b32 s74, s74, 11
    s_add_u32 s74, s74, 14979072
    v_and_b32 v20, 15, v1
    v_lshlrev_b32 v20, 7, v20
L_pl_12:
    buffer_load_dword v21, v20, s[32:35], s74 offen sc1
    s_waitcnt vmcnt(0)
    v_cmp_gt_u32 vcc, 16, v21
    s_cbranch_vccz L_pk_13
    s_sub_u32 s56, s56, 1
    s_cbranch_scc1 L_bail
    s_branch L_pl_12
L_pk_13:
L_pd_11:
    s_waitcnt lgkmcnt(0)
    s_barrier
    s_add_u32 m0, s91, 0
    s_add_u32 s93, s92, 0
    buffer_load_dwordx4 v124, s[32:35], s93 offen sc1 lds
    s_add_u32 m0, s91, 2048
    s_add_u32 s93, s92, 2097152
    buffer_load_dwordx4 v124, s[32:35], s93 offen sc1 lds
    v_and_b32 v20, 7, v1
    v_lshlrev_b32 v20, 7, v20
    buffer_load_dword v21, v20, s[32:35], s52 offen sc1
    s_add_u32 s93, s90, 0
    buffer_load_dwordx4 v[136:139], v59, s[32:35], s93 offen sc1
    s_add_u32 s93, s90, 2097152
    buffer_load_dwordx4 v[140:143], v59, s[32:35], s93 offen sc1
    s_and_b32 s73, s49, 31
    s_mul_i32 s73, s73, 6
    s_add_u32 s73, s73, 512
    s_lshl_b32 s73, s73, 3
    s_lshr_b32 s72, s49, 5
    s_add_u32 s73, s73, s72
    s_lshl_b32 s73, s73, 10
    v_min_u32 v13, 47, v0
    v_lshrrev_b32 v11, 3, v13
    v_and_b32 v13, 7, v13
    v_lshlrev_b32 v13, 7, v13
    v_lshl_add_u32 v13, v11, 13, v13
    buffer_load_dword v12, v13, s[32:35], s73 offen
    v_lshrrev_b32 v108, 2, v1
    v_mul_u32_u24 v108, 96, v108
    v_and_b32 v109, 3, v1
    v_lshl_add_u32 v108, v109, 3, v108
    v_add_u32 v108, s62, v108
    v_mul_u32_u24 v112, 96, v1
    v_add_u32 v112, s62, v112
    v_mov_b32 v110, 0x3f803f80
    v_mov_b32 v111, 0x3f803f80
    s_waitcnt vmcnt(18)
    s_cmp_lg_u32 s48, 3
    s_cbranch_scc1 L_on_14
    ds_write_b64 v112, v[110:111] offset:56
L_on_14:
    ds_read_b64_tr_b16 a[200:201], v108 offset:0
    ds_read_b64_tr_b16 a[202:203], v108 offset:1536
    ds_read_b64_tr_b16 v[152:153], v108 offset:32
    ds_read_b64_tr_b16 v[154:155], v108 offset:1568
    ds_read_b64_tr_b16 v[216:217], v108 offset:64
    ds_read_b64_tr_b16 v[218:219], v108 offset:1600
    ds_read_b64_tr_b16 a[204:205], v108 offset:3072
    ds_read_b64_tr_b16 a[206:207], v108 offset:4608
    ds_read_b64_tr_b16 v[156:157], v108 offset:3104
    ds_read_b64_tr_b16 v[158:159], v108 offset:4640
    ds_read_b64_tr_b16 v[220:221], v108 offset:3136
    ds_read_b64_tr_b16 v[222:223], v108 offset:4672
    s_waitcnt vmcnt(12)
    s_cmp_lg_u32 s48, 3
    s_cbranch_scc1 L_on_15
    ds_write_b64 v112, v[110:111] offset:6200
L_on_15:
    ds_read_b64_tr_b16 a[208:209], v108 offset:6144
    ds_read_b64_tr_b16 a[210:211], v108 offset:7680
    ds_read_b64_tr_b16 v[160:161], v108 offset:6176
    ds_read_b64_tr_b16 v[162:163], v108 offset:7712
    ds_read_b64_tr_b16 v[224:225], v108 offset:6208
    ds_read_b64_tr_b16 v[226:227], v108 offset:7744
    ds_read_b64_tr_b16 a[212:213], v108 offset:9216
    ds_read_b64_tr_b16 a[214:215], v108 offset:10752
    ds_read_b64_tr_b16 v[164:165], v108 offset:9248
    ds_read_b64_tr_b16 v[166:167], v108 offset:10784
    ds_read_b64_tr_b16 v[228:229], v108 offset:9280
    ds_read_b64_tr_b16 v[230:231], v108 offset:10816
    s_waitcnt vmcnt(6)
    s_cmp_lg_u32 s48, 3
    s_cbranch_scc1 L_on_16
    ds_write_b64 v112, v[110:111] offset:12344
L_on_16:
    ds_read_b64_tr_b16 a[216:217], v108 offset:12288
    ds_read_b64_tr_b16 a[218:219], v108 offset:13824
    ds_read_b64_tr_b16 v[168:169], v108 offset:12320
    ds_read_b64_tr_b16 v[170:171], v108 offset:13856
    ds_read_b64_tr_b16 v[232:233], v108 offset:12352
    ds_read_b64_tr_b16 v[234:235], v108 offset:13888
    ds_read_b64_tr_b16 a[220:221], v108 offset:15360
    ds_read_b64_tr_b16 a[222:223], v108 offset:16896
    ds_read_b64_tr_b16 v[172:173], v108 offset:15392
    ds_read_b64_tr_b16 v[174:175], v108 offset:16928
    ds_read_b64_tr_b16 v[236:237], v108 offset:15424
    ds_read_b64_tr_b16 v[238:239], v108 offset:16960
    ds_read2_b32 v[60:61], v52 offset0:176 offset1:177
    ds_read2_b32 v[62:63], v52 offset0:178 offset1:179
    ds_read2_b32 v[64:65], v52 offset0:48 offset1:49
    ds_read2_b32 v[66:67], v52 offset0:50 offset1:51
    ds_read2_b32 v[68:69], v53 offset0:176 offset1:177
    ds_read2_b32 v[70:71], v53 offset0:178 offset1:179
    ds_read2_b32 v[72:73], v53 offset0:48 offset1:49
    ds_read2_b32 v[74:75], v53 offset0:50 offset1:51
    ds_read2_b32 v[76:77], v52 offset0:160 offset1:161
    ds_read2_b32 v[78:79], v52 offset0:162 offset1:163
    ds_read2_b32 v[80:81], v52 offset0:32 offset1:33
    ds_read2_b32 v[82:83], v52 offset0:34 offset1:35
    ds_read2_b32 v[84:85], v53 offset0:160 offset1:161
    ds_read2_b32 v[86:87], v53 offset0:162 offset1:163
    ds_read2_b32 v[88:89], v53 offset0:32 offset1:33
    ds_read2_b32 v[90:91], v53 offset0:34 offset1:35
    ds_read2_b32 v[92:93], v52 offset0:144 offset1:145
    ds_read2_b32 v[94:95], v52 offset0:146 offset1:147
    ds_read2_b32 v[96:97], v52 offset0:16 offset1:17
    ds_read2_b32 v[98:99], v52 offset0:18 offset1:19
    ds_read2_b32 v[100:101], v53 offset0:144 offset1:145
    ds_read2_b32 v[102:103], v53 offset0:146 offset1:147
    s_waitcnt vmcnt(3)
    v_cmp_ne_u32 vcc, s55, v21
    s_nop 1
    s_cmp_eq_u64 vcc, 0
    s_cselect_b32 s53, 1, 0
    s_xor_b32 s52, s15, 1048576
    s_waitcnt lgkmcnt(0)
    s_barrier
    s_cmp_lg_u32 s57, 0
    s_cbranch_scc1 L_tkh1_17
    ds_read_b128 v[104:107], v56 offset:192
    ds_read_b128 v[108:111], v56 offset:704
    ds_read_b128 v[112:115], v56 offset:1216
    ds_read_b128 v[116:119], v56 offset:1728
    s_waitcnt lgkmcnt(3)
    v_mfma_f32_16x16x32_bf16 v[32:35], v[72:75], v[104:107], 0
    ds_read_b128 v[120:123], v56 offset:128
    v_lshrrev_b32 v13, 5, v1
    v_mfma_f32_16x16x32_bf16 v[28:31], v[68:71], v[104:107], 0
    ds_read_b128 v[72:75], v56 offset:640
    s_waitcnt lgkmcnt(4)
    v_mfma_f32_16x16x32_bf16 v[32:35], v[68:71], v[108:111], v[32:35]
    ds_read_b128 v[68:71], v56 offset:1152
    v_and_b32 v11, 31, v1
    v_mfma_f32_16x16x32_bf16 v[24:27], v[64:67], v[104:107], 0
    v_lshlrev_b32 v11, 4, v11
    v_lshl_add_u32 v11, v13, 15, v11
    v_mfma_f32_16x16x32_bf16 v[28:31], v[64:67], v[108:111], v[28:31]
    v_bfe_u32 v13, v1, 3, 1
    s_waitcnt lgkmcnt(4)
    v_mfma_f32_16x16x32_bf16 v[32:35], v[64:67], v[112:115], v[32:35]
    ds_read_b128 v[64:67], v56 offset:1664
    v_mul_u32_u24 v13, 3968, v13
    v_mfma_f32_16x16x32_bf16 v[20:23], v[60:63], v[104:107], 0
    ds_read2_b32 v[104:105], v53 offset0:16 offset1:17
    v_add_u32 v13, v13, v10
    v_mfma_f32_16x16x32_bf16 v[24:27], v[60:63], v[108:111], v[24:27]
    ds_read2_b32 v[106:107], v53 offset0:18 offset1:19
    v_mfma_f32_16x16x32_bf16 v[28:31], v[60:63], v[112:115], v[28:31]
    ds_read_b128 v[108:111], v56 offset:64
    s_waitcnt lgkmcnt(7)
    v_mfma_f32_16x16x32_bf16 v[32:35], v[60:63], v[116:119], v[32:35]
    ds_read_b128 v[112:115], v56 offset:576
    s_waitcnt lgkmcnt(7)
    v_mfma_f32_16x16x32_bf16 v[32:35], v[88:91], v[120:123], v[32:35]
    ds_read_b128 v[116:119], v56 offset:1088
    v_mfma_f32_16x16x32_bf16 v[28:31], v[84:87], v[120:123], v[28:31]
    ds_read_b128 v[60:63], v56 offset:1600
    s_waitcnt lgkmcnt(7)
    v_mfma_f32_16x16x32_bf16 v[32:35], v[84:87], v[72:75], v[32:35]
    ds_read2_b32 v[88:89], v53 offset0:128 offset1:129
    v_mfma_f32_16x16x32_bf16 v[24:27], v[80:83], v[120:123], v[24:27]
    ds_read2_b32 v[90:91], v53 offset0:130 offset1:131
    v_mfma_f32_16x16x32_bf16 v[28:31], v[80:83], v[72:75], v[28:31]
    ds_read_b128 v[84:87], v56 offset:0
    v_mfma_f32_16x16x32_bf16 v[32:35], v[80:83], v[68:71], v[32:35]
    ds_read2_b32 v[80:81], v52 offset0:0 offset1:1
    v_mfma_f32_16x16x32_bf16 v[20:23], v[76:79], v[120:123], v[20:23]
    ds_read2_b32 v[82:83], v52 offset0:2 offset1:3
    v_mfma_f32_16x16x32_bf16 v[24:27], v[76:79], v[72:75], v[24:27]
    ds_read_b128 v[120:123], v56 offset:512
    v_mfma_f32_16x16x32_bf16 v[28:31], v[76:79], v[68:71], v[28:31]
    ds_read2_b32 v[72:73], v52 offset0:128 offset1:129
    s_waitcnt lgkmcnt(9)
    v_mfma_f32_16x16x32_bf16 v[32:35], v[76:79], v[64:67], v[32:35]
    ds_read2_b32 v[74:75], v52 offset0:130 offset1:131
    v_mfma_f32_16x16x32_bf16 v[32:35], v[104:107], v[108:111], v[32:35]
    ds_read_b128 v[68:71], v56 offset:1024
    v_mfma_f32_16x16x32_bf16 v[28:31], v[100:103], v[108:111], v[28:31]
    ds_read2_b32 v[76:77], v53 offset0:0 offset1:1
    v_mfma_f32_16x16x32_bf16 v[32:35], v[100:103], v[112:115], v[32:35]
    ds_read2_b32 v[78:79], v53 offset0:2 offset1:3
    v_mfma_f32_16x16x32_bf16 v[24:27], v[96:99], v[108:111], v[24:27]
    ds_read_b128 v[64:67], v56 offset:1536
    v_mfma_f32_16x16x32_bf16 v[28:31], v[96:99], v[112:115], v[28:31]
    ds_read_b128 v[104:107], v56 offset:2048
    s_waitcnt lgkmcnt(9)
    v_mfma_f32_16x16x32_bf16 v[32:35], v[96:99], v[116:119], v[32:35]
    ds_read_b128 v[100:103], v56 offset:2560
    v_mfma_f32_16x16x32_bf16 v[20:23], v[92:95], v[108:111], v[20:23]
    ds_read_b128 v[96:99], v56 offset:3072
    v_mfma_f32_16x16x32_bf16 v[24:27], v[92:95], v[112:115], v[24:27]
    v_mfma_f32_16x16x32_bf16 v[28:31], v[92:95], v[116:119], v[28:31]
    v_mfma_f32_16x16x32_bf16 v[32:35], v[92:95], v[60:63], v[32:35]
    v_mfma_f32_16x16x32_bf16 v[28:31], v[88:91], v[84:87], v[28:31]
    ds_read_b128 v[108:111], v56 offset:3584
    s_waitcnt lgkmcnt(6)
    v_mfma_f32_16x16x32_bf16 v[24:27], v[80:83], v[84:87], v[24:27]
    ds_read2_b32 v[112:113], v54 offset0:128 offset1:129
    v_mfma_f32_16x16x32_bf16 v[28:31], v[80:83], v[120:123], v[28:31]
    ds_read2_b32 v[114:115], v54 offset0:130 offset1:131
    v_mfma_f32_16x16x32_bf16 v[24:27], v[72:75], v[120:123], v[24:27]
    v_mfma_f32_16x16x32_bf16 v[28:31], v[72:75], v[68:71], v[28:31]
    s_waitcnt lgkmcnt(4)
    v_mfma_f32_16x16x32_bf16 v[32:35], v[76:79], v[84:87], v[32:35]
    ds_read2_b32 v[116:117], v54 offset0:0 offset1:1
    s_waitcnt vmcnt(2)
    v_mfma_f32_16x16x32_bf16 v[32:35], v[88:91], v[120:123], v[32:35]
    ds_read2_b32 v[118:119], v54 offset0:2 offset1:3
    s_nop 0
    ds_write_b128 v57, v[24:27] offset:0
    v_mfma_f32_16x16x32_bf16 v[32:35], v[80:83], v[68:71], v[32:35]
    v_mfma_f32_16x16x32_bf16 v[20:23], v[72:75], v[84:87], v[20:23]
    ds_read2_b32 v[60:61], v55 offset0:128 offset1:129
    ds_write_b128 v57, v[28:31] offset:1024
    v_mfma_f32_16x16x32_bf16 v[32:35], v[72:75], v[64:67], v[32:35]
    ds_read2_b32 v[62:63], v55 offset0:130 offset1:131
    s_add_u32 m0, s64, 0
    v_mfma_f32_16x16x32_bf16 v[20:23], v[128:131], v[136:139], v[20:23]
    ds_read2_b32 v[92:93], v55 offset0:0 offset1:1
    s_add_u32 s58, s101, 0
    v_mfma_f32_16x16x32_bf16 v[32:35], v[132:135], v[136:139], v[32:35]
    ds_read2_b32 v[94:95], v55 offset0:2 offset1:3
    buffer_load_dwordx4 v2, s[36:39], s58 offen offset:0 lds
    v_mfma_f32_16x16x32_bf16 v[36:39], v[76:79], v[120:123], 0
    s_waitcnt lgkmcnt(3)
    s_barrier
    v_mfma_f32_16x16x32_bf16 v[40:43], v[76:79], v[68:71], 0
    ds_read_b128 v[24:27], v57 offset:4096
    v_mfma_f32_16x16x32_bf16 v[44:47], v[76:79], v[64:67], 0
    ds_read_b128 v[28:31], v57 offset:5120
    v_mfma_f32_16x16x32_bf16 v[48:51], v[76:79], v[104:107], 0
    ds_read2_b32 v[76:77], v55 offset0:16 offset1:17
    buffer_load_dwordx4 v3, s[36:39], s58 offen offset:1024 lds
    v_mfma_f32_16x16x32_bf16 v[36:39], v[88:91], v[68:71], v[36:39]
    ds_read2_b32 v[78:79], v55 offset0:18 offset1:19
    s_waitcnt vmcnt(3)
    v_mfma_f32_16x16x32_bf16 v[40:43], v[88:91], v[64:67], v[40:43]
    s_waitcnt lgkmcnt(2)
    v_add_f32 v24, v24, v20
    v_mfma_f32_16x16x32_bf16 v[44:47], v[88:91], v[104:107], v[44:47]
    v_add_f32 v25, v25, v21
    buffer_load_dwordx4 v4, s[36:39], s58 offen offset:2048 lds
    v_mfma_f32_16x16x32_bf16 v[48:51], v[88:91], v[100:103], v[48:51]
    ds_read_b128 v[88:91], v56 offset:64
    v_add_f32 v26, v26, v22
    v_mfma_f32_16x16x32_bf16 v[36:39], v[80:83], v[64:67], v[36:39]
    v_add_f32 v27, v27, v23
    v_cvt_pk_bf16_f32 v24, v24, v25
    v_mfma_f32_16x16x32_bf16 v[40:43], v[80:83], v[104:107], v[40:43]
    v_cvt_pk_bf16_f32 v25, v26, v27
    v_add_f32 v28, v28, v32
    v_mfma_f32_16x16x32_bf16 v[44:47], v[80:83], v[100:103], v[44:47]
    v_add_f32 v29, v29, v33
    v_add_f32 v30, v30, v34
    v_mfma_f32_16x16x32_bf16 v[48:51], v[80:83], v[96:99], v[48:51]
    ds_read2_b32 v[80:81], v55 offset0:144 offset1:145
    v_add_f32 v31, v31, v35
    v_mfma_f32_16x16x32_bf16 v[36:39], v[72:75], v[104:107], v[36:39]
    ds_read2_b32 v[82:83], v55 offset0:146 offset1:147
    v_cvt_pk_bf16_f32 v26, v28, v29
    v_mfma_f32_16x16x32_bf16 v[40:43], v[72:75], v[100:103], v[40:43]
    ds_read_b128 v[104:107], v56 offset:576
    v_cvt_pk_bf16_f32 v27, v30, v31
    v_mfma_f32_16x16x32_bf16 v[44:47], v[72:75], v[96:99], v[44:47]
    ds_read2_b32 v[100:101], v54 offset0:16 offset1:17
    s_add_u32 m0, s64, 3072
    v_mfma_f32_16x16x32_bf16 v[48:51], v[72:75], v[108:111], v[48:51]
    ds_read2_b32 v[102:103], v54 offset0:18 offset1:19
    s_add_u32 s58, s101, 88064
    buffer_load_dwordx4 v2, s[36:39], s58 offen offset:0 lds
    v_permlane16_swap_b32 v24, v26
    v_permlane16_swap_b32 v25, v27
    v_and_b32 v24, -2, v24
    buffer_store_dwordx4 v[24:27], v58, s[32:35], s77 offen offset:0 sc1
    v_mfma_f32_16x16x32_bf16 v[36:39], v[112:115], v[84:87], v[36:39]
    ds_read_b128 v[96:99], v56 offset:1088
    buffer_load_dwordx4 v3, s[36:39], s58 offen offset:1024 lds
    v_mfma_f32_16x16x32_bf16 v[40:43], v[112:115], v[120:123], v[40:43]
    ds_read2_b32 v[72:73], v54 offset0:144 offset1:145
    buffer_load_dwordx4 v4, s[36:39], s58 offen offset:2048 lds
    v_mfma_f32_16x16x32_bf16 v[44:47], v[112:115], v[68:71], v[44:47]
    ds_read2_b32 v[74:75], v54 offset0:146 offset1:147
    v_mfma_f32_16x16x32_bf16 v[48:51], v[112:115], v[64:67], v[48:51]
    ds_read_b128 v[108:111], v56 offset:1600
    v_mfma_f32_16x16x32_bf16 v[40:43], v[116:119], v[84:87], v[40:43]
    ds_read2_b32 v[64:65], v53 offset0:16 offset1:17
    v_mfma_f32_16x16x32_bf16 v[44:47], v[116:119], v[120:123], v[44:47]
    ds_read2_b32 v[66:67], v53 offset0:18 offset1:19
    s_add_u32 m0, s64, 6144
    v_mfma_f32_16x16x32_bf16 v[48:51], v[116:119], v[68:71], v[48:51]
    ds_read_b128 v[20:23], v56 offset:2112
    s_add_u32 s58, s101, 176128
    v_mfma_f32_16x16x32_bf16 v[44:47], v[60:63], v[84:87], v[44:47]
    ds_read2_b32 v[24:25], v53 offset0:144 offset1:145
    buffer_load_dwordx4 v2, s[36:39], s58 offen offset:0 lds
    v_mfma_f32_16x16x32_bf16 v[48:51], v[60:63], v[120:123], v[48:51]
    ds_read2_b32 v[26:27], v53 offset0:146 offset1:147
    v_mfma_f32_16x16x32_bf16 v[48:51], v[92:95], v[84:87], v[48:51]
    ds_read_b128 v[28:31], v56 offset:2624
    s_waitcnt lgkmcnt(9)
    v_mfma_f32_16x16x32_bf16 v[48:51], v[76:79], v[88:91], v[48:51]
    ds_read2_b32 v[32:33], v52 offset0:16 offset1:17
    buffer_load_dwordx4 v3, s[36:39], s58 offen offset:1024 lds
    v_mfma_f32_16x16x32_bf16 v[44:47], v[80:83], v[88:91], v[44:47]
    ds_read2_b32 v[34:35], v52 offset0:18 offset1:19
    v_mfma_f32_16x16x32_bf16 v[48:51], v[80:83], v[104:107], v[48:51]
    ds_read_b128 v[112:115], v56 offset:3136
    v_mfma_f32_16x16x32_bf16 v[40:43], v[100:103], v[88:91], v[40:43]
    ds_read2_b32 v[68:69], v52 offset0:144 offset1:145
    buffer_load_dwordx4 v4, s[36:39], s58 offen offset:2048 lds
    v_mfma_f32_16x16x32_bf16 v[44:47], v[100:103], v[104:107], v[44:47]
    ds_read2_b32 v[70:71], v52 offset0:146 offset1:147
    v_mfma_f32_16x16x32_bf16 v[48:51], v[100:103], v[96:99], v[48:51]
    ds_read_b128 v[116:119], v56 offset:3648
    s_waitcnt lgkmcnt(9)
    v_mfma_f32_16x16x32_bf16 v[36:39], v[72:75], v[88:91], v[36:39]
    ds_read2_b32 v[60:61], v55 offset0:32 offset1:33
    v_mfma_f32_16x16x32_bf16 v[40:43], v[72:75], v[104:107], v[40:43]
    ds_read2_b32 v[62:63], v55 offset0:34 offset1:35
    s_add_u32 m0, s64, 9216
    v_mfma_f32_16x16x32_bf16 v[44:47], v[72:75], v[96:99], v[44:47]
    ds_read_b128 v[120:123], v56 offset:128
    s_add_u32 s58, s101, 264192
    v_mfma_f32_16x16x32_bf16 v[48:51], v[72:75], v[108:111], v[48:51]
    ds_read2_b32 v[84:85], v55 offset0:160 offset1:161
    buffer_load_dwordx4 v2, s[36:39], s58 offen offset:0 lds
    v_mfma_f32_16x16x32_bf16 v[36:39], v[64:67], v[104:107], v[36:39]
    ds_read2_b32 v[86:87], v55 offset0:162 offset1:163
    v_mfma_f32_16x16x32_bf16 v[40:43], v[64:67], v[96:99], v[40:43]
    ds_read_b128 v[92:95], v56 offset:640
    buffer_load_dwordx4 v3, s[36:39], s58 offen offset:1024 lds
    v_mfma_f32_16x16x32_bf16 v[44:47], v[64:67], v[108:111], v[44:47]
    ds_read2_b32 v[76:77], v54 offset0:32 offset1:33
L_stub_1:
    s_cbranch_execz L_stub_5
    s_nop 0
    v_mfma_f32_16x16x32_bf16 v[48:51], v[64:67], v[20:23], v[48:51]
    ds_read2_b32 v[78:79], v54 offset0:34 offset1:35
    s_waitcnt lgkmcnt(9)
    v_mfma_f32_16x16x32_bf16 v[36:39], v[24:27], v[96:99], v[36:39]
    ds_read_b128 v[80:83], v56 offset:1152
    v_mfma_f32_16x16x32_bf16 v[40:43], v[24:27], v[108:111], v[40:43]
    ds_read2_b32 v[100:101], v54 offset0:160 offset1:161
    buffer_load_dwordx4 v4, s[36:39], s58 offen offset:2048 lds
    v_mfma_f32_16x16x32_bf16 v[44:47], v[24:27], v[20:23], v[44:47]
    ds_read2_b32 v[102:103], v54 offset0:162 offset1:163
    v_mfma_f32_16x16x32_bf16 v[48:51], v[24:27], v[28:31], v[48:51]
    ds_read_b128 v[88:91], v56 offset:1664
    v_mfma_f32_16x16x32_bf16 v[36:39], v[32:35], v[108:111], v[36:39]
    ds_read2_b32 v[72:73], v53 offset0:32 offset1:33
    v_mfma_f32_16x16x32_bf16 v[40:43], v[32:35], v[20:23], v[40:43]
    ds_read2_b32 v[74:75], v53 offset0:34 offset1:35
    s_add_u32 m0, s64, 12288
    v_mfma_f32_16x16x32_bf16 v[44:47], v[32:35], v[28:31], v[44:47]
    ds_read_b128 v[104:107], v56 offset:2176
    s_add_u32 s58, s87, 0
    v_mfma_f32_16x16x32_bf16 v[48:51], v[32:35], v[112:115], v[48:51]
    ds_read2_b32 v[64:65], v53 offset0:160 offset1:161
    buffer_load_dwordx4 v5, s[40:43], s58 offen offset:0 lds
    v_mfma_f32_16x16x32_bf16 v[36:39], v[68:71], v[20:23], v[36:39]
    ds_read2_b32 v[66:67], v53 offset0:162 offset1:163
    s_add_u32 s80, s30, 2097152
    v_mfma_f32_16x16x32_bf16 v[40:43], v[68:71], v[28:31], v[40:43]
    ds_read_b128 v[96:99], v56 offset:2688
    buffer_store_dwordx4 v[6:9], v11, s[32:35], s80 offen sc1
    v_mfma_f32_16x16x32_bf16 v[44:47], v[68:71], v[112:115], v[44:47]
    ds_read2_b32 v[24:25], v52 offset0:32 offset1:33
    s_waitcnt lgkmcnt(9)
    v_mfma_f32_16x16x32_bf16 v[48:51], v[68:71], v[116:119], v[48:51]
    ds_read2_b32 v[26:27], v52 offset0:34 offset1:35
    s_add_u32 s58, s87, 7168
    v_mfma_f32_16x16x32_bf16 v[48:51], v[60:63], v[120:123], v[48:51]
    ds_read_b128 v[108:111], v56 offset:3200
    buffer_load_dwordx4 v5, s[40:43], s58 offen offset:1024 lds
    v_mfma_f32_16x16x32_bf16 v[44:47], v[84:87], v[120:123], v[44:47]
    ds_read2_b32 v[32:33], v52 offset0:160 offset1:161
    s_add_u32 s58, s87, 14336
    v_mfma_f32_16x16x32_bf16 v[48:51], v[84:87], v[92:95], v[48:51]
    ds_read2_b32 v[34:35], v52 offset0:162 offset1:163
    buffer_load_dwordx4 v5, s[40:43], s58 offen offset:2048 lds
    v_mfma_f32_16x16x32_bf16 v[40:43], v[76:79], v[120:123], v[40:43]
    ds_read_b128 v[20:23], v56 offset:3712
    s_add_u32 s80, s30, 2105344
    v_mfma_f32_16x16x32_bf16 v[44:47], v[76:79], v[92:95], v[44:47]
    ds_read2_b32 v[28:29], v55 offset0:176 offset1:177
    buffer_store_dwordx4 v[6:9], v11, s[32:35], s80 offen sc1
    v_mfma_f32_16x16x32_bf16 v[48:51], v[76:79], v[80:83], v[48:51]
    ds_read2_b32 v[30:31], v55 offset0:178 offset1:179
    s_waitcnt lgkmcnt(9)
    v_mfma_f32_16x16x32_bf16 v[36:39], v[100:103], v[120:123], v[36:39]
    ds_read_b128 v[112:115], v56 offset:192
    s_add_u32 s58, s87, 21504
    v_mfma_f32_16x16x32_bf16 v[40:43], v[100:103], v[92:95], v[40:43]
    ds_read2_b32 v[68:69], v54 offset0:48 offset1:49
    buffer_load_dwordx4 v5, s[40:43], s58 offen offset:3072 lds
    v_mfma_f32_16x16x32_bf16 v[44:47], v[100:103], v[80:83], v[44:47]
    ds_read2_b32 v[70:71], v54 offset0:50 offset1:51
    v_mfma_f32_16x16x32_bf16 v[48:51], v[100:103], v[88:91], v[48:51]
    ds_read_b128 v[116:119], v56 offset:704
    s_add_u32 m0, s63, 0
    v_mfma_f32_16x16x32_bf16 v[36:39], v[72:75], v[92:95], v[36:39]
    ds_read2_b32 v[60:61], v54 offset0:176 offset1:177
    s_add_u32 s58, s87, 49152
    v_mfma_f32_16x16x32_bf16 v[40:43], v[72:75], v[80:83], v[40:43]
    ds_read2_b32 v[62:63], v54 offset0:178 offset1:179
    buffer_load_dwordx4 v5, s[40:43], s58 offen offset:0 lds
    v_mfma_f32_16x16x32_bf16 v[44:47], v[72:75], v[88:91], v[44:47]
    s_mov_b32 exec_lo, 65535
    s_mov_b32 exec_hi, 0
    s_add_u32 s80, s31, 0
    buffer_store_dwordx4 v[6:9], v13, s[32:35], s80 offen sc1
    s_mov_b64 exec, -1
    v_mfma_f32_16x16x32_bf16 v[48:51], v[72:75], v[104:107], v[48:51]
    ds_read_b128 v[84:87], v56 offset:1216
    s_add_u32 s58, s87, 56320
    v_mfma_f32_16x16x32_bf16 v[36:39], v[64:67], v[80:83], v[36:39]
    ds_read2_b32 v[76:77], v53 offset0:48 offset1:49
    buffer_load_dwordx4 v5, s[40:43], s58 offen offset:1024 lds
    v_mfma_f32_16x16x32_bf16 v[40:43], v[64:67], v[88:91], v[40:43]
    ds_read2_b32 v[78:79], v53 offset0:50 offset1:51
    v_mfma_f32_16x16x32_bf16 v[44:47], v[64:67], v[104:107], v[44:47]
    ds_read_b128 v[120:123], v56 offset:1728
    s_waitcnt lgkmcnt(8)
    v_mfma_f32_16x16x32_bf16 v[48:51], v[64:67], v[96:99], v[48:51]
    ds_read2_b32 v[100:101], v53 offset0:176 offset1:177
    s_add_u32 s58, s87, 63488
    v_mfma_f32_16x16x32_bf16 v[36:39], v[24:27], v[88:91], v[36:39]
    ds_read2_b32 v[102:103], v53 offset0:178 offset1:179
    buffer_load_dwordx4 v5, s[40:43], s58 offen offset:2048 lds
    v_mfma_f32_16x16x32_bf16 v[40:43], v[24:27], v[104:107], v[40:43]
    ds_read_b128 v[92:95], v56 offset:2240
    v_mfma_f32_16x16x32_bf16 v[44:47], v[24:27], v[96:99], v[44:47]
    ds_read2_b32 v[72:73], v52 offset0:48 offset1:49
    v_mfma_f32_16x16x32_bf16 v[48:51], v[24:27], v[108:111], v[48:51]
    ds_read2_b32 v[74:75], v52 offset0:50 offset1:51
    s_add_u32 s58, s87, 70656
    v_mfma_f32_16x16x32_bf16 v[36:39], v[32:35], v[104:107], v[36:39]
    ds_read_b128 v[80:83], v56 offset:2752
    buffer_load_dwordx4 v5, s[40:43], s58 offen offset:3072 lds
    v_mfma_f32_16x16x32_bf16 v[40:43], v[32:35], v[96:99], v[40:43]
    ds_read2_b32 v[64:65], v52 offset0:176 offset1:177
    v_mfma_f32_16x16x32_bf16 v[44:47], v[32:35], v[108:111], v[44:47]
    ds_read2_b32 v[66:67], v52 offset0:178 offset1:179
    v_mfma_f32_16x16x32_bf16 v[48:51], v[32:35], v[20:23], v[48:51]
    ds_read_b128 v[88:91], v56 offset:3264
    v_mfma_f32_16x16x32_bf16 v[44:47], v[28:31], v[112:115], v[44:47]
    ds_read2_b32 v[24:25], v55 offset0:48 offset1:49
    s_waitcnt lgkmcnt(9)
    v_mfma_f32_16x16x32_bf16 v[40:43], v[68:71], v[112:115], v[40:43]
    ds_read2_b32 v[26:27], v55 offset0:50 offset1:51
    v_mfma_f32_16x16x32_bf16 v[44:47], v[68:71], v[116:119], v[44:47]
    ds_read_b128 v[104:107], v56 offset:3776
    v_mfma_f32_16x16x32_bf16 v[40:43], v[60:63], v[116:119], v[40:43]
    v_mfma_f32_16x16x32_bf16 v[44:47], v[60:63], v[84:87], v[44:47]
    v_mfma_f32_16x16x32_bf16 v[40:43], v[76:79], v[84:87], v[40:43]
    v_mfma_f32_16x16x32_bf16 v[44:47], v[76:79], v[120:123], v[44:47]
    s_waitcnt lgkmcnt(5)
    v_mfma_f32_16x16x32_bf16 v[40:43], v[100:103], v[120:123], v[40:43]
    v_mfma_f32_16x16x32_bf16 v[44:47], v[100:103], v[92:95], v[44:47]
    v_mfma_f32_16x16x32_bf16 v[40:43], v[72:75], v[92:95], v[40:43]
    v_mfma_f32_16x16x32_bf16 v[44:47], v[72:75], v[80:83], v[44:47]
    s_waitcnt lgkmcnt(1)
    v_mfma_f32_16x16x32_bf16 v[40:43], v[64:67], v[80:83], v[40:43]
    v_mfma_f32_16x16x32_bf16 v[44:47], v[64:67], v[88:91], v[44:47]
    v_mfma_f32_16x16x32_bf16 v[48:51], v[24:27], v[112:115], v[48:51]
    v_mfma_f32_16x16x32_bf16 v[48:51], v[28:31], v[116:119], v[48:51]
    s_nop 4
    ds_write_b128 v57, v[40:43] offset:2048
    v_mfma_f32_16x16x32_bf16 v[48:51], v[68:71], v[84:87], v[48:51]
    v_mfma_f32_16x16x32_bf16 v[36:39], v[60:63], v[112:115], v[36:39]
    ds_write_b128 v57, v[44:47] offset:3072
    v_mfma_f32_16x16x32_bf16 v[48:51], v[60:63], v[120:123], v[48:51]
    s_add_u32 m0, s20, 0
    s_add_u32 s76, s15, 0
    v_mfma_f32_16x16x32_bf16 v[36:39], v[76:79], v[116:119], v[36:39]
    buffer_load_dwordx4 v127, s[32:35], s76 offen offset:0 sc1 lds
    v_mfma_f32_16x16x32_bf16 v[48:51], v[76:79], v[92:95], v[48:51]
    s_waitcnt lgkmcnt(0)
    s_barrier
    v_mfma_f32_16x16x32_bf16 v[36:39], v[100:103], v[84:87], v[36:39]
    ds_read_b128 v[40:43], v57 offset:6144
    v_mfma_f32_16x16x32_bf16 v[48:51], v[100:103], v[80:83], v[48:51]
    ds_read_b128 v[44:47], v57 offset:7168
    s_add_u32 s76, s15, 64512
    v_mfma_f32_16x16x32_bf16 v[36:39], v[72:75], v[120:123], v[36:39]
    buffer_load_dwordx4 v127, s[32:35], s76 offen offset:1024 sc1 lds
    s_add_u32 s76, s15, 129024
    v_mfma_f32_16x16x32_bf16 v[48:51], v[72:75], v[88:91], v[48:51]
    buffer_load_dwordx4 v127, s[32:35], s76 offen offset:2048 sc1 lds
    s_add_u32 s76, s15, 193536
    v_mfma_f32_16x16x32_bf16 v[36:39], v[64:67], v[92:95], v[36:39]
    buffer_load_dwordx4 v127, s[32:35], s76 offen offset:3072 sc1 lds
    v_mfma_f32_16x16x32_bf16 v[48:51], v[64:67], v[104:107], v[48:51]
    s_add_u32 m0, s20, 16384
    s_add_u32 s76, s52, 0
    v_mfma_f32_16x16x32_bf16 v[36:39], v[128:131], v[140:143], v[36:39]
    buffer_load_dwordx4 v127, s[32:35], s76 offen offset:0 sc1 lds
    v_mfma_f32_16x16x32_bf16 v[48:51], v[132:135], v[140:143], v[48:51]
    s_add_u32 s76, s52, 64512
    buffer_load_dwordx4 v127, s[32:35], s76 offen offset:1024 sc1 lds
    s_add_u32 s76, s52, 129024
    buffer_load_dwordx4 v127, s[32:35], s76 offen offset:2048 sc1 lds
    s_add_u32 s76, s52, 193536
    buffer_load_dwordx4 v127, s[32:35], s76 offen offset:3072 sc1 lds
    s_waitcnt lgkmcnt(0)
    v_pk_add_f32 v[40:41], v[40:41], v[36:37]
    v_pk_add_f32 v[42:43], v[42:43], v[38:39]
    v_cvt_pk_bf16_f32 v40, v40, v41
    v_cvt_pk_bf16_f32 v41, v42, v43
    v_pk_add_f32 v[44:45], v[44:45], v[48:49]
    v_pk_add_f32 v[46:47], v[46:47], v[50:51]
    v_cvt_pk_bf16_f32 v42, v44, v45
    v_cvt_pk_bf16_f32 v43, v46, v47
    s_nop 0
    v_permlane16_swap_b32 v40, v42
    v_permlane16_swap_b32 v41, v43
    v_and_b32 v40, -2, v40
    buffer_store_dwordx4 v[40:43], v58, s[32:35], s77 offen offset:2048 sc1
    s_branch L_tkhj_18
L_tkh1_17:
    ds_read_b128 v[104:107], v56 offset:192
    ds_read_b128 v[108:111], v56 offset:704
    ds_read_b128 v[112:115], v56 offset:1216
    ds_read_b128 v[116:119], v56 offset:1728
    s_waitcnt lgkmcnt(3)
    v_mfma_f32_16x16x32_bf16 v[32:35], v[72:75], v[104:107], 0
    ds_read_b128 v[120:123], v56 offset:128
    v_lshrrev_b32 v13, 5, v1
    v_mfma_f32_16x16x32_bf16 v[28:31], v[68:71], v[104:107], 0
    ds_read_b128 v[72:75], v56 offset:640
    s_waitcnt lgkmcnt(4)
    v_mfma_f32_16x16x32_bf16 v[32:35], v[68:71], v[108:111], v[32:35]
    ds_read_b128 v[68:71], v56 offset:1152
    v_and_b32 v11, 31, v1
    v_mfma_f32_16x16x32_bf16 v[24:27], v[64:67], v[104:107], 0
    v_lshlrev_b32 v11, 4, v11
    v_lshl_add_u32 v11, v13, 15, v11
    v_mfma_f32_16x16x32_bf16 v[28:31], v[64:67], v[108:111], v[28:31]
    v_bfe_u32 v13, v1, 3, 1
    s_waitcnt lgkmcnt(4)
    v_mfma_f32_16x16x32_bf16 v[32:35], v[64:67], v[112:115], v[32:35]
    ds_read_b128 v[64:67], v56 offset:1664
    v_mul_u32_u24 v13, 3968, v13
    v_mfma_f32_16x16x32_bf16 v[20:23], v[60:63], v[104:107], 0
    ds_read2_b32 v[104:105], v53 offset0:16 offset1:17
    v_add_u32 v13, v13, v10
    v_mfma_f32_16x16x32_bf16 v[24:27], v[60:63], v[108:111], v[24:27]
    ds_read2_b32 v[106:107], v53 offset0:18 offset1:19
    v_mfma_f32_16x16x32_bf16 v[28:31], v[60:63], v[112:115], v[28:31]
    ds_read_b128 v[108:111], v56 offset:64
    s_waitcnt lgkmcnt(7)
    v_mfma_f32_16x16x32_bf16 v[32:35], v[60:63], v[116:119], v[32:35]
    ds_read_b128 v[112:115], v56 offset:576
    s_waitcnt lgkmcnt(7)
    v_mfma_f32_16x16x32_bf16 v[32:35], v[88:91], v[120:123], v[32:35]
    ds_read_b128 v[116:119], v56 offset:1088
    v_mfma_f32_16x16x32_bf16 v[28:31], v[84:87], v[120:123], v[28:31]
    ds_read_b128 v[60:63], v56 offset:1600
    s_waitcnt lgkmcnt(7)
    v_mfma_f32_16x16x32_bf16 v[32:35], v[84:87], v[72:75], v[32:35]
    ds_read2_b32 v[88:89], v53 offset0:0 offset1:1
    v_mfma_f32_16x16x32_bf16 v[24:27], v[80:83], v[120:123], v[24:27]
    ds_read2_b32 v[90:91], v53 offset0:2 offset1:3
    v_mfma_f32_16x16x32_bf16 v[28:31], v[80:83], v[72:75], v[28:31]
    ds_read_b128 v[84:87], v56 offset:0
    v_mfma_f32_16x16x32_bf16 v[32:35], v[80:83], v[68:71], v[32:35]
    ds_read2_b32 v[80:81], v53 offset0:128 offset1:129
    v_mfma_f32_16x16x32_bf16 v[20:23], v[76:79], v[120:123], v[20:23]
    ds_read2_b32 v[82:83], v53 offset0:130 offset1:131
    v_mfma_f32_16x16x32_bf16 v[24:27], v[76:79], v[72:75], v[24:27]
    ds_read_b128 v[120:123], v56 offset:512
    v_mfma_f32_16x16x32_bf16 v[28:31], v[76:79], v[68:71], v[28:31]
    ds_read2_b32 v[72:73], v52 offset0:0 offset1:1
    s_waitcnt lgkmcnt(9)
    v_mfma_f32_16x16x32_bf16 v[32:35], v[76:79], v[64:67], v[32:35]
    ds_read2_b32 v[74:75], v52 offset0:2 offset1:3
    v_mfma_f32_16x16x32_bf16 v[32:35], v[104:107], v[108:111], v[32:35]
    ds_read_b128 v[68:71], v56 offset:1024
    v_mfma_f32_16x16x32_bf16 v[28:31], v[100:103], v[108:111], v[28:31]
    ds_read2_b32 v[76:77], v52 offset0:128 offset1:129
    v_mfma_f32_16x16x32_bf16 v[32:35], v[100:103], v[112:115], v[32:35]
    ds_read2_b32 v[78:79], v52 offset0:130 offset1:131
    v_mfma_f32_16x16x32_bf16 v[24:27], v[96:99], v[108:111], v[24:27]
    ds_read_b128 v[64:67], v56 offset:1536
    v_mfma_f32_16x16x32_bf16 v[28:31], v[96:99], v[112:115], v[28:31]
    ds_read_b128 v[104:107], v56 offset:2048
    s_waitcnt lgkmcnt(9)
    v_mfma_f32_16x16x32_bf16 v[32:35], v[96:99], v[116:119], v[32:35]
    ds_read_b128 v[100:103], v56 offset:2560
    v_mfma_f32_16x16x32_bf16 v[20:23], v[92:95], v[108:111], v[20:23]
    ds_read_b128 v[96:99], v56 offset:3072
    v_mfma_f32_16x16x32_bf16 v[24:27], v[92:95], v[112:115], v[24:27]
    v_mfma_f32_16x16x32_bf16 v[28:31], v[92:95], v[116:119], v[28:31]
    v_mfma_f32_16x16x32_bf16 v[32:35], v[92:95], v[60:63], v[32:35]
    v_mfma_f32_16x16x32_bf16 v[32:35], v[88:91], v[84:87], v[32:35]
    ds_read_b128 v[108:111], v56 offset:3584
    s_waitcnt lgkmcnt(6)
    v_mfma_f32_16x16x32_bf16 v[32:35], v[80:83], v[120:123], v[32:35]
    ds_read2_b32 v[112:113], v54 offset0:128 offset1:129
    v_mfma_f32_16x16x32_bf16 v[32:35], v[72:75], v[68:71], v[32:35]
    ds_read2_b32 v[114:115], v54 offset0:130 offset1:131
    s_waitcnt lgkmcnt(6)
    v_mfma_f32_16x16x32_bf16 v[20:23], v[76:79], v[84:87], v[20:23]
    v_mfma_f32_16x16x32_bf16 v[32:35], v[76:79], v[64:67], v[32:35]
    v_mfma_f32_16x16x32_bf16 v[28:31], v[80:83], v[84:87], v[28:31]
    ds_read2_b32 v[116:117], v54 offset0:0 offset1:1
    s_waitcnt vmcnt(2)
    v_mfma_f32_16x16x32_bf16 v[24:27], v[72:75], v[84:87], v[24:27]
    ds_read2_b32 v[118:119], v54 offset0:2 offset1:3
    s_nop 1
    ds_write_b128 v57, v[20:23] offset:4096
    v_mfma_f32_16x16x32_bf16 v[28:31], v[72:75], v[120:123], v[28:31]
    v_mfma_f32_16x16x32_bf16 v[24:27], v[76:79], v[120:123], v[24:27]
    ds_read2_b32 v[60:61], v55 offset0:128 offset1:129
    ds_write_b128 v57, v[32:35] offset:5120
    v_mfma_f32_16x16x32_bf16 v[28:31], v[76:79], v[68:71], v[28:31]
    ds_read2_b32 v[62:63], v55 offset0:130 offset1:131
    s_add_u32 m0, s64, 0
    v_mfma_f32_16x16x32_bf16 v[24:27], v[128:131], v[136:139], v[24:27]
    ds_read2_b32 v[92:93], v55 offset0:0 offset1:1
    s_add_u32 s58, s101, 0
    v_mfma_f32_16x16x32_bf16 v[28:31], v[132:135], v[136:139], v[28:31]
    ds_read2_b32 v[94:95], v55 offset0:2 offset1:3
    buffer_load_dwordx4 v2, s[36:39], s58 offen offset:0 lds
    v_mfma_f32_16x16x32_bf16 v[36:39], v[88:91], v[120:123], 0
    s_waitcnt lgkmcnt(3)
    s_barrier
    v_mfma_f32_16x16x32_bf16 v[40:43], v[88:91], v[68:71], 0
    ds_read_b128 v[20:23], v57 offset:0
    v_mfma_f32_16x16x32_bf16 v[44:47], v[88:91], v[64:67], 0
    ds_read_b128 v[32:35], v57 offset:1024
    v_mfma_f32_16x16x32_bf16 v[48:51], v[88:91], v[104:107], 0
    ds_read2_b32 v[88:89], v55 offset0:16 offset1:17
    buffer_load_dwordx4 v3, s[36:39], s58 offen offset:1024 lds
    v_mfma_f32_16x16x32_bf16 v[36:39], v[80:83], v[68:71], v[36:39]
    ds_read2_b32 v[90:91], v55 offset0:18 offset1:19
    s_waitcnt vmcnt(3)
    v_mfma_f32_16x16x32_bf16 v[40:43], v[80:83], v[64:67], v[40:43]
    s_waitcnt lgkmcnt(2)
    v_add_f32 v20, v20, v24
    v_mfma_f32_16x16x32_bf16 v[44:47], v[80:83], v[104:107], v[44:47]
    v_add_f32 v21, v21, v25
    buffer_load_dwordx4 v4, s[36:39], s58 offen offset:2048 lds
    v_mfma_f32_16x16x32_bf16 v[48:51], v[80:83], v[100:103], v[48:51]
    ds_read_b128 v[80:83], v56 offset:64
    v_add_f32 v22, v22, v26
    v_mfma_f32_16x16x32_bf16 v[36:39], v[72:75], v[64:67], v[36:39]
    v_add_f32 v23, v23, v27
    v_cvt_pk_bf16_f32 v20, v20, v21
    v_mfma_f32_16x16x32_bf16 v[40:43], v[72:75], v[104:107], v[40:43]
    v_cvt_pk_bf16_f32 v21, v22, v23
    v_add_f32 v32, v32, v28
    v_mfma_f32_16x16x32_bf16 v[44:47], v[72:75], v[100:103], v[44:47]
    v_add_f32 v33, v33, v29
    v_add_f32 v34, v34, v30
    v_mfma_f32_16x16x32_bf16 v[48:51], v[72:75], v[96:99], v[48:51]
    ds_read2_b32 v[72:73], v55 offset0:144 offset1:145
    v_add_f32 v35, v35, v31
    v_mfma_f32_16x16x32_bf16 v[36:39], v[76:79], v[104:107], v[36:39]
    ds_read2_b32 v[74:75], v55 offset0:146 offset1:147
    v_cvt_pk_bf16_f32 v22, v32, v33
    v_mfma_f32_16x16x32_bf16 v[40:43], v[76:79], v[100:103], v[40:43]
    ds_read_b128 v[104:107], v56 offset:576
    v_cvt_pk_bf16_f32 v23, v34, v35
    v_mfma_f32_16x16x32_bf16 v[44:47], v[76:79], v[96:99], v[44:47]
    ds_read2_b32 v[100:101], v54 offset0:16 offset1:17
    s_add_u32 m0, s64, 3072
    v_mfma_f32_16x16x32_bf16 v[48:51], v[76:79], v[108:111], v[48:51]
    ds_read2_b32 v[102:103], v54 offset0:18 offset1:19
    s_add_u32 s58, s101, 88064
    buffer_load_dwordx4 v2, s[36:39], s58 offen offset:0 lds
    v_permlane16_swap_b32 v20, v22
    v_permlane16_swap_b32 v21, v23
    v_and_b32 v20, -2, v20
    buffer_store_dwordx4 v[20:23], v58, s[32:35], s77 offen offset:0 sc1
    v_mfma_f32_16x16x32_bf16 v[36:39], v[112:115], v[84:87], v[36:39]
    ds_read_b128 v[96:99], v56 offset:1088
    buffer_load_dwordx4 v3, s[36:39], s58 offen offset:1024 lds
    v_mfma_f32_16x16x32_bf16 v[40:43], v[112:115], v[120:123], v[40:43]
    ds_read2_b32 v[76:77], v54 offset0:144 offset1:145
    buffer_load_dwordx4 v4, s[36:39], s58 offen offset:2048 lds
    v_mfma_f32_16x16x32_bf16 v[44:47], v[112:115], v[68:71], v[44:47]
    ds_read2_b32 v[78:79], v54 offset0:146 offset1:147
    v_mfma_f32_16x16x32_bf16 v[48:51], v[112:115], v[64:67], v[48:51]
    ds_read_b128 v[108:111], v56 offset:1600
    v_mfma_f32_16x16x32_bf16 v[40:43], v[116:119], v[84:87], v[40:43]
    ds_read2_b32 v[64:65], v53 offset0:16 offset1:17
    v_mfma_f32_16x16x32_bf16 v[44:47], v[116:119], v[120:123], v[44:47]
    ds_read2_b32 v[66:67], v53 offset0:18 offset1:19
    s_add_u32 m0, s64, 6144
    v_mfma_f32_16x16x32_bf16 v[48:51], v[116:119], v[68:71], v[48:51]
    ds_read_b128 v[20:23], v56 offset:2112
    s_add_u32 s58, s101, 176128
    v_mfma_f32_16x16x32_bf16 v[44:47], v[60:63], v[84:87], v[44:47]
    ds_read2_b32 v[24:25], v53 offset0:144 offset1:145
    buffer_load_dwordx4 v2, s[36:39], s58 offen offset:0 lds
    v_mfma_f32_16x16x32_bf16 v[48:51], v[60:63], v[120:123], v[48:51]
    ds_read2_b32 v[26:27], v53 offset0:146 offset1:147
    v_mfma_f32_16x16x32_bf16 v[48:51], v[92:95], v[84:87], v[48:51]
    ds_read_b128 v[28:31], v56 offset:2624
    s_waitcnt lgkmcnt(9)
    v_mfma_f32_16x16x32_bf16 v[48:51], v[88:91], v[80:83], v[48:51]
    ds_read2_b32 v[32:33], v52 offset0:16 offset1:17
    buffer_load_dwordx4 v3, s[36:39], s58 offen offset:1024 lds
    v_mfma_f32_16x16x32_bf16 v[44:47], v[72:75], v[80:83], v[44:47]
    ds_read2_b32 v[34:35], v52 offset0:18 offset1:19
    v_mfma_f32_16x16x32_bf16 v[48:51], v[72:75], v[104:107], v[48:51]
    ds_read_b128 v[112:115], v56 offset:3136
    v_mfma_f32_16x16x32_bf16 v[40:43], v[100:103], v[80:83], v[40:43]
    ds_read2_b32 v[68:69], v52 offset0:144 offset1:145
    buffer_load_dwordx4 v4, s[36:39], s58 offen offset:2048 lds
    v_mfma_f32_16x16x32_bf16 v[44:47], v[100:103], v[104:107], v[44:47]
    ds_read2_b32 v[70:71], v52 offset0:146 offset1:147
    v_mfma_f32_16x16x32_bf16 v[48:51], v[100:103], v[96:99], v[48:51]
    ds_read_b128 v[116:119], v56 offset:3648
    s_waitcnt lgkmcnt(9)
    v_mfma_f32_16x16x32_bf16 v[36:39], v[76:79], v[80:83], v[36:39]
    ds_read2_b32 v[60:61], v55 offset0:32 offset1:33
    v_mfma_f32_16x16x32_bf16 v[40:43], v[76:79], v[104:107], v[40:43]
    ds_read2_b32 v[62:63], v55 offset0:34 offset1:35
    s_add_u32 m0, s64, 9216
    v_mfma_f32_16x16x32_bf16 v[44:47], v[76:79], v[96:99], v[44:47]
    ds_read_b128 v[120:123], v56 offset:128
    s_add_u32 s58, s101, 264192
    v_mfma_f32_16x16x32_bf16 v[48:51], v[76:79], v[108:111], v[48:51]
    ds_read2_b32 v[84:85], v55 offset0:160 offset1:161
    buffer_load_dwordx4 v2, s[36:39], s58 offen offset:0 lds
    v_mfma_f32_16x16x32_bf16 v[36:39], v[64:67], v[104:107], v[36:39]
    ds_read2_b32 v[86:87], v55 offset0:162 offset1:163
    v_mfma_f32_16x16x32_bf16 v[40:43], v[64:67], v[96:99], v[40:43]
    ds_read_b128 v[92:95], v56 offset:640
    buffer_load_dwordx4 v3, s[36:39], s58 offen offset:1024 lds
    v_mfma_f32_16x16x32_bf16 v[44:47], v[64:67], v[108:111], v[44:47]
    ds_read2_b32 v[88:89], v54 offset0:32 offset1:33
    v_mfma_f32_16x16x32_bf16 v[48:51], v[64:67], v[20:23], v[48:51]
    ds_read2_b32 v[90:91], v54 offset0:34 offset1:35
    s_waitcnt lgkmcnt(9)
    v_mfma_f32_16x16x32_bf16 v[36:39], v[24:27], v[96:99], v[36:39]
    ds_read_b128 v[72:75], v56 offset:1152
    v_mfma_f32_16x16x32_bf16 v[40:43], v[24:27], v[108:111], v[40:43]
    ds_read2_b32 v[100:101], v54 offset0:160 offset1:161
    buffer_load_dwordx4 v4, s[36:39], s58 offen offset:2048 lds
    v_mfma_f32_16x16x32_bf16 v[44:47], v[24:27], v[20:23], v[44:47]
    ds_read2_b32 v[102:103], v54 offset0:162 offset1:163
    v_mfma_f32_16x16x32_bf16 v[48:51], v[24:27], v[28:31], v[48:51]
    ds_read_b128 v[80:83], v56 offset:1664
    v_mfma_f32_16x16x32_bf16 v[36:39], v[32:35], v[108:111], v[36:39]
    ds_read2_b32 v[76:77], v53 offset0:32 offset1:33
    v_mfma_f32_16x16x32_bf16 v[40:43], v[32:35], v[20:23], v[40:43]
    ds_read2_b32 v[78:79], v53 offset0:34 offset1:35
    s_add_u32 m0, s64, 12288
    v_mfma_f32_16x16x32_bf16 v[44:47], v[32:35], v[28:31], v[44:47]
    ds_read_b128 v[104:107], v56 offset:2176
    s_add_u32 s58, s87, 0
    v_mfma_f32_16x16x32_bf16 v[48:51], v[32:35], v[112:115], v[48:51]
    ds_read2_b32 v[64:65], v53 offset0:160 offset1:161
    buffer_load_dwordx4 v5, s[40:43], s58 offen offset:0 lds
    v_mfma_f32_16x16x32_bf16 v[36:39], v[68:71], v[20:23], v[36:39]
    ds_read2_b32 v[66:67], v53 offset0:162 offset1:163
    s_add_u32 s80, s30, 2097152
    v_mfma_f32_16x16x32_bf16 v[40:43], v[68:71], v[28:31], v[40:43]
    ds_read_b128 v[96:99], v56 offset:2688
    buffer_store_dwordx4 v[6:9], v11, s[32:35], s80 offen sc1
    v_mfma_f32_16x16x32_bf16 v[44:47], v[68:71], v[112:115], v[44:47]
    ds_read2_b32 v[24:25], v52 offset0:32 offset1:33
    s_waitcnt lgkmcnt(9)
    v_mfma_f32_16x16x32_bf16 v[48:51], v[68:71], v[116:119], v[48:51]
    ds_read2_b32 v[26:27], v52 offset0:34 offset1:35
    s_add_u32 s58, s87, 7168
    v_mfma_f32_16x16x32_bf16 v[48:51], v[60:63], v[120:123], v[48:51]
    ds_read_b128 v[108:111], v56 offset:3200
    buffer_load_dwordx4 v5, s[40:43], s58 offen offset:1024 lds
    v_mfma_f32_16x16x32_bf16 v[44:47], v[84:87], v[120:123], v[44:47]
    ds_read2_b32 v[32:33], v52 offset0:160 offset1:161
    s_add_u32 s58, s87, 14336
    v_mfma_f32_16x16x32_bf16 v[48:51], v[84:87], v[92:95], v[48:51]
    ds_read2_b32 v[34:35], v52 offset0:162 offset1:163
    buffer_load_dwordx4 v5, s[40:43], s58 offen offset:2048 lds
    v_mfma_f32_16x16x32_bf16 v[40:43], v[88:91], v[120:123], v[40:43]
    ds_read_b128 v[20:23], v56 offset:3712
    s_add_u32 s80, s30, 2105344
    v_mfma_f32_16x16x32_bf16 v[44:47], v[88:91], v[92:95], v[44:47]
    ds_read2_b32 v[28:29], v55 offset0:48 offset1:49
    buffer_store_dwordx4 v[6:9], v11, s[32:35], s80 offen sc1
    v_mfma_f32_16x16x32_bf16 v[48:51], v[88:91], v[72:75], v[48:51]
    ds_read2_b32 v[30:31], v55 offset0:50 offset1:51
    s_waitcnt lgkmcnt(9)
    v_mfma_f32_16x16x32_bf16 v[36:39], v[100:103], v[120:123], v[36:39]
    ds_read_b128 v[112:115], v56 offset:192
    s_add_u32 s58, s87, 21504
    v_mfma_f32_16x16x32_bf16 v[40:43], v[100:103], v[92:95], v[40:43]
    ds_read2_b32 v[68:69], v55 offset0:176 offset1:177
    buffer_load_dwordx4 v5, s[40:43], s58 offen offset:3072 lds
    v_mfma_f32_16x16x32_bf16 v[44:47], v[100:103], v[72:75], v[44:47]
    ds_read2_b32 v[70:71], v55 offset0:178 offset1:179
    v_mfma_f32_16x16x32_bf16 v[48:51], v[100:103], v[80:83], v[48:51]
    ds_read_b128 v[116:119], v56 offset:704
    s_add_u32 m0, s63, 0
    v_mfma_f32_16x16x32_bf16 v[36:39], v[76:79], v[92:95], v[36:39]
    ds_read2_b32 v[60:61], v54 offset0:48 offset1:49
    s_add_u32 s58, s87, 49152
    v_mfma_f32_16x16x32_bf16 v[40:43], v[76:79], v[72:75], v[40:43]
    ds_read2_b32 v[62:63], v54 offset0:50 offset1:51
    buffer_load_dwordx4 v5, s[40:43], s58 offen offset:0 lds
    v_mfma_f32_16x16x32_bf16 v[44:47], v[76:79], v[80:83], v[44:47]
    s_mov_b32 exec_lo, 65535
    s_mov_b32 exec_hi, 0
    s_add_u32 s80, s31, 0
    buffer_store_dwordx4 v[6:9], v13, s[32:35], s80 offen sc1
    s_mov_b64 exec, -1
    v_mfma_f32_16x16x32_bf16 v[48:51], v[76:79], v[104:107], v[48:51]
    ds_read_b128 v[84:87], v56 offset:1216
    s_add_u32 s58, s87, 56320
    v_mfma_f32_16x16x32_bf16 v[36:39], v[64:67], v[72:75], v[36:39]
    ds_read2_b32 v[88:89], v54 offset0:176 offset1:177
    buffer_load_dwordx4 v5, s[40:43], s58 offen offset:1024 lds
    v_mfma_f32_16x16x32_bf16 v[40:43], v[64:67], v[80:83], v[40:43]
    ds_read2_b32 v[90:91], v54 offset0:178 offset1:179
    v_mfma_f32_16x16x32_bf16 v[44:47], v[64:67], v[104:107], v[44:47]
    ds_read_b128 v[120:123], v56 offset:1728
    s_waitcnt lgkmcnt(8)
    v_mfma_f32_16x16x32_bf16 v[48:51], v[64:67], v[96:99], v[48:51]
    ds_read2_b32 v[100:101], v53 offset0:48 offset1:49
    s_add_u32 s58, s87, 63488
    v_mfma_f32_16x16x32_bf16 v[36:39], v[24:27], v[80:83], v[36:39]
    ds_read2_b32 v[102:103], v53 offset0:50 offset1:51
    buffer_load_dwordx4 v5, s[40:43], s58 offen offset:2048 lds
    v_mfma_f32_16x16x32_bf16 v[40:43], v[24:27], v[104:107], v[40:43]
    ds_read_b128 v[92:95], v56 offset:2240
    v_mfma_f32_16x16x32_bf16 v[44:47], v[24:27], v[96:99], v[44:47]
    ds_read2_b32 v[76:77], v53 offset0:176 offset1:177
    v_mfma_f32_16x16x32_bf16 v[48:51], v[24:27], v[108:111], v[48:51]
    ds_read2_b32 v[78:79], v53 offset0:178 offset1:179
    s_add_u32 s58, s87, 70656
    v_mfma_f32_16x16x32_bf16 v[36:39], v[32:35], v[104:107], v[36:39]
    ds_read_b128 v[72:75], v56 offset:2752
    buffer_load_dwordx4 v5, s[40:43], s58 offen offset:3072 lds
    v_mfma_f32_16x16x32_bf16 v[40:43], v[32:35], v[96:99], v[40:43]
    ds_read2_b32 v[64:65], v52 offset0:48 offset1:49
    v_mfma_f32_16x16x32_bf16 v[44:47], v[32:35], v[108:111], v[44:47]
    ds_read2_b32 v[66:67], v52 offset0:50 offset1:51
    v_mfma_f32_16x16x32_bf16 v[48:51], v[32:35], v[20:23], v[48:51]
    ds_read_b128 v[80:83], v56 offset:3264
    v_mfma_f32_16x16x32_bf16 v[48:51], v[28:31], v[112:115], v[48:51]
    ds_read2_b32 v[24:25], v52 offset0:176 offset1:177
    s_waitcnt lgkmcnt(9)
    v_mfma_f32_16x16x32_bf16 v[48:51], v[68:71], v[116:119], v[48:51]
    ds_read2_b32 v[26:27], v52 offset0:178 offset1:179
    v_mfma_f32_16x16x32_bf16 v[48:51], v[60:63], v[84:87], v[48:51]
    ds_read_b128 v[104:107], v56 offset:3776
    v_mfma_f32_16x16x32_bf16 v[36:39], v[88:91], v[112:115], v[36:39]
    v_mfma_f32_16x16x32_bf16 v[48:51], v[88:91], v[120:123], v[48:51]
    s_waitcnt lgkmcnt(7)
    v_mfma_f32_16x16x32_bf16 v[36:39], v[100:103], v[116:119], v[36:39]
    v_mfma_f32_16x16x32_bf16 v[48:51], v[100:103], v[92:95], v[48:51]
    v_mfma_f32_16x16x32_bf16 v[36:39], v[76:79], v[84:87], v[36:39]
    s_waitcnt lgkmcnt(4)
    v_mfma_f32_16x16x32_bf16 v[48:51], v[76:79], v[72:75], v[48:51]
    v_mfma_f32_16x16x32_bf16 v[36:39], v[64:67], v[120:123], v[36:39]
    s_waitcnt lgkmcnt(2)
    v_mfma_f32_16x16x32_bf16 v[48:51], v[64:67], v[80:83], v[48:51]
    s_waitcnt lgkmcnt(1)
    v_mfma_f32_16x16x32_bf16 v[36:39], v[24:27], v[92:95], v[36:39]
    s_waitcnt lgkmcnt(0)
    v_mfma_f32_16x16x32_bf16 v[48:51], v[24:27], v[104:107], v[48:51]
    v_mfma_f32_16x16x32_bf16 v[44:47], v[68:71], v[112:115], v[44:47]
    v_mfma_f32_16x16x32_bf16 v[40:43], v[60:63], v[112:115], v[40:43]
    s_nop 3
    ds_write_b128 v57, v[36:39] offset:6144
    v_mfma_f32_16x16x32_bf16 v[44:47], v[60:63], v[116:119], v[44:47]
    v_mfma_f32_16x16x32_bf16 v[40:43], v[88:91], v[116:119], v[40:43]
    ds_write_b128 v57, v[48:51] offset:7168
    v_mfma_f32_16x16x32_bf16 v[44:47], v[88:91], v[84:87], v[44:47]
    s_add_u32 m0, s20, 0
    s_add_u32 s76, s15, 0
    v_mfma_f32_16x16x32_bf16 v[40:43], v[100:103], v[84:87], v[40:43]
    buffer_load_dwordx4 v127, s[32:35], s76 offen offset:0 sc1 lds
    v_mfma_f32_16x16x32_bf16 v[44:47], v[100:103], v[120:123], v[44:47]
    s_waitcnt lgkmcnt(0)
    s_barrier
    v_mfma_f32_16x16x32_bf16 v[40:43], v[76:79], v[120:123], v[40:43]
    ds_read_b128 v[36:39], v57 offset:2048
    v_mfma_f32_16x16x32_bf16 v[44:47], v[76:79], v[92:95], v[44:47]
    ds_read_b128 v[48:51], v57 offset:3072
    s_add_u32 s76, s15, 64512
    v_mfma_f32_16x16x32_bf16 v[40:43], v[64:67], v[92:95], v[40:43]
    buffer_load_dwordx4 v127, s[32:35], s76 offen offset:1024 sc1 lds
L_stub_2:
    s_cbranch_execz L_stub_6
    s_nop 0
    s_add_u32 s76, s15, 129024
    v_mfma_f32_16x16x32_bf16 v[44:47], v[64:67], v[72:75], v[44:47]
    buffer_load_dwordx4 v127, s[32:35], s76 offen offset:2048 sc1 lds
    s_add_u32 s76, s15, 193536
    v_mfma_f32_16x16x32_bf16 v[40:43], v[24:27], v[72:75], v[40:43]
    buffer_load_dwordx4 v127, s[32:35], s76 offen offset:3072 sc1 lds
    v_mfma_f32_16x16x32_bf16 v[44:47], v[24:27], v[80:83], v[44:47]
    s_add_u32 m0, s20, 16384
    s_add_u32 s76, s52, 0
    v_mfma_f32_16x16x32_bf16 v[40:43], v[128:131], v[140:143], v[40:43]
    buffer_load_dwordx4 v127, s[32:35], s76 offen offset:0 sc1 lds
    v_mfma_f32_16x16x32_bf16 v[44:47], v[132:135], v[140:143], v[44:47]
    s_add_u32 s76, s52, 64512
    buffer_load_dwordx4 v127, s[32:35], s76 offen offset:1024 sc1 lds
    s_add_u32 s76, s52, 129024
    buffer_load_dwordx4 v127, s[32:35], s76 offen offset:2048 sc1 lds
    s_add_u32 s76, s52, 193536
    buffer_load_dwordx4 v127, s[32:35], s76 offen offset:3072 sc1 lds
    s_waitcnt lgkmcnt(0)
    v_pk_add_f32 v[36:37], v[36:37], v[40:41]
    v_pk_add_f32 v[38:39], v[38:39], v[42:43]
    v_cvt_pk_bf16_f32 v36, v36, v37
    v_cvt_pk_bf16_f32 v37, v38, v39
    v_pk_add_f32 v[48:49], v[48:49], v[44:45]
    v_pk_add_f32 v[50:51], v[50:51], v[46:47]
    v_cvt_pk_bf16_f32 v38, v48, v49
    v_cvt_pk_bf16_f32 v39, v50, v51
    s_nop 0
    v_permlane16_swap_b32 v36, v38
    v_permlane16_swap_b32 v37, v39
    v_and_b32 v36, -2, v36
    buffer_store_dwordx4 v[36:39], v58, s[32:35], s77 offen offset:2048 sc1
L_tkhj_18:
    v_mov_b32 v100, v127
    v_lshlrev_b32 v143, 4, v1
    v_add_u32 v101, s20, v143
    v_lshlrev_b32 v103, 2, v1
    v_and_b32 v103, 60, v103
    v_add_u32 v103, 25856, v103
    v_mov_b32 v142, v5
    v_mov_b32 v20, 0x3b003b00
    v_mov_b32 v21, 0x3b003b00
    v_mov_b32 v22, 0x3b003b00
    v_mov_b32 v23, 0x3b003b00
    s_nop 1
    v_mfma_f32_16x16x32_bf16 v[2:5], a[176:179], v[20:23], 0
    v_lshrrev_b32 v136, 2, v1
    v_mul_u32_u24 v136, 96, v136
    v_mfma_f32_16x16x32_bf16 v[6:9], a[240:243], v[20:23], 0
    v_and_b32 v137, 3, v1
    v_lshl_add_u32 v136, v137, 3, v136
    v_mfma_f32_16x16x32_bf16 v[10:13], v[192:195], v[20:23], 0
    v_add_u32 v136, s64, v136
    v_mul_u32_u24 v140, 96, v1
    v_mfma_f32_16x16x32_bf16 v[2:5], a[180:183], v[20:23], v[2:5]
    v_add_u32 v140, s64, v140
    v_mov_b32 v138, 0x3f803f80
    v_mfma_f32_16x16x32_bf16 v[6:9], a[244:247], v[20:23], v[6:9]
    v_mov_b32 v139, 0x3f803f80
    s_waitcnt vmcnt(26)
    v_mfma_f32_16x16x32_bf16 v[10:13], v[196:199], v[20:23], v[10:13]
    s_cmp_lg_u32 s48, 3
    s_cbranch_scc1 L_on_22
    ds_write_b64 v140, v[138:139] offset:56
L_on_22:
    v_mfma_f32_16x16x32_bf16 v[2:5], a[184:187], v[20:23], v[2:5]
    ds_read_b64_tr_b16 a[224:225], v136 offset:0
    ds_read_b64_tr_b16 a[226:227], v136 offset:1536
    v_mfma_f32_16x16x32_bf16 v[6:9], a[248:251], v[20:23], v[6:9]
    ds_read_b64_tr_b16 v[176:177], v136 offset:32
    ds_read_b64_tr_b16 v[178:179], v136 offset:1568
    v_mfma_f32_16x16x32_bf16 v[10:13], v[200:203], v[20:23], v[10:13]
    ds_read_b64_tr_b16 v[240:241], v136 offset:64
    ds_read_b64_tr_b16 v[242:243], v136 offset:1600
    v_mfma_f32_16x16x32_bf16 v[2:5], a[188:191], v[20:23], v[2:5]
    ds_read_b64_tr_b16 a[228:229], v136 offset:3072
    ds_read_b64_tr_b16 a[230:231], v136 offset:4608
    v_mfma_f32_16x16x32_bf16 v[6:9], a[252:255], v[20:23], v[6:9]
    ds_read_b64_tr_b16 v[180:181], v136 offset:3104
    ds_read_b64_tr_b16 v[182:183], v136 offset:4640
    v_mfma_f32_16x16x32_bf16 v[10:13], v[204:207], v[20:23], v[10:13]
    ds_read_b64_tr_b16 v[244:245], v136 offset:3136
    ds_read_b64_tr_b16 v[246:247], v136 offset:4672
    v_mfma_f32_16x16x32_bf16 v[2:5], a[192:195], v[20:23], v[2:5]
    s_waitcnt vmcnt(20)
    s_cmp_lg_u32 s48, 3
    s_cbranch_scc1 L_on_24
    ds_write_b64 v140, v[138:139] offset:6200
L_on_24:
    v_mfma_f32_16x16x32_bf16 v[6:9], v[144:147], v[20:23], v[6:9]
    ds_read_b64_tr_b16 a[232:233], v136 offset:6144
    ds_read_b64_tr_b16 a[234:235], v136 offset:7680
    v_mfma_f32_16x16x32_bf16 v[10:13], v[208:211], v[20:23], v[10:13]
    ds_read_b64_tr_b16 v[184:185], v136 offset:6176
    ds_read_b64_tr_b16 v[186:187], v136 offset:7712
    v_mfma_f32_16x16x32_bf16 v[2:5], a[196:199], v[20:23], v[2:5]
    ds_read_b64_tr_b16 v[248:249], v136 offset:6208
    ds_read_b64_tr_b16 v[250:251], v136 offset:7744
    v_mfma_f32_16x16x32_bf16 v[6:9], v[148:151], v[20:23], v[6:9]
    ds_read_b64_tr_b16 a[236:237], v136 offset:9216
    ds_read_b64_tr_b16 a[238:239], v136 offset:10752
    v_mfma_f32_16x16x32_bf16 v[10:13], v[212:215], v[20:23], v[10:13]
    ds_read_b64_tr_b16 v[188:189], v136 offset:9248
    ds_read_b64_tr_b16 v[190:191], v136 offset:10784
    v_mfma_f32_16x16x32_bf16 v[2:5], a[200:203], v[20:23], v[2:5]
    ds_read_b64_tr_b16 v[252:253], v136 offset:9280
    ds_read_b64_tr_b16 v[254:255], v136 offset:10816
    v_mfma_f32_16x16x32_bf16 v[6:9], v[152:155], v[20:23], v[6:9]
    v_xad_u32 v137, v16, 0, s64
    v_xad_u32 v138, v17, 0, s64
    v_mfma_f32_16x16x32_bf16 v[10:13], v[216:219], v[20:23], v[10:13]
    v_xad_u32 v139, v16, 64, s64
    v_xad_u32 v140, v17, 64, s64
    v_mfma_f32_16x16x32_bf16 v[2:5], a[204:207], v[20:23], v[2:5]
    s_waitcnt vmcnt(14)
    ds_read_b64_tr_b16 a[0:1], v137 offset:12288
    v_mfma_f32_16x16x32_bf16 v[6:9], v[156:159], v[20:23], v[6:9]
    ds_read_b64_tr_b16 a[2:3], v137 offset:14336
    ds_read_b64_tr_b16 a[4:5], v138 offset:12288
    v_mfma_f32_16x16x32_bf16 v[10:13], v[220:223], v[20:23], v[10:13]
    ds_read_b64_tr_b16 a[6:7], v138 offset:14336
    ds_read_b64_tr_b16 a[8:9], v139 offset:12288
    v_mfma_f32_16x16x32_bf16 v[2:5], a[208:211], v[20:23], v[2:5]
    ds_read_b64_tr_b16 a[10:11], v139 offset:14336
    ds_read_b64_tr_b16 a[12:13], v140 offset:12288
    v_mfma_f32_16x16x32_bf16 v[6:9], v[160:163], v[20:23], v[6:9]
    ds_read_b64_tr_b16 a[14:15], v140 offset:14336
    v_xad_u32 v137, v16, 0, s63
    v_mfma_f32_16x16x32_bf16 v[10:13], v[224:227], v[20:23], v[10:13]
    v_xad_u32 v138, v17, 0, s63
    v_xad_u32 v139, v16, 64, s63
    v_mfma_f32_16x16x32_bf16 v[2:5], a[212:215], v[20:23], v[2:5]
    v_xad_u32 v140, v17, 64, s63
    s_waitcnt vmcnt(9)
    v_mfma_f32_16x16x32_bf16 v[6:9], v[164:167], v[20:23], v[6:9]
    ds_read_b64_tr_b16 a[16:17], v137 offset:0
    ds_read_b64_tr_b16 a[18:19], v137 offset:2048
    v_mfma_f32_16x16x32_bf16 v[10:13], v[228:231], v[20:23], v[10:13]
    ds_read_b64_tr_b16 a[20:21], v138 offset:0
    ds_read_b64_tr_b16 a[22:23], v138 offset:2048
    v_mfma_f32_16x16x32_bf16 v[2:5], a[216:219], v[20:23], v[2:5]
    ds_read_b64_tr_b16 a[24:25], v139 offset:0
    ds_read_b64_tr_b16 a[26:27], v139 offset:2048
    v_mfma_f32_16x16x32_bf16 v[6:9], v[168:171], v[20:23], v[6:9]
    ds_read_b64_tr_b16 a[28:29], v140 offset:0
    ds_read_b64_tr_b16 a[30:31], v140 offset:2048
    v_mfma_f32_16x16x32_bf16 v[10:13], v[232:235], v[20:23], v[10:13]
    v_bfe_u32 v133, v1, 3, 1
    v_and_b32 v134, 0x70, v143
    v_mfma_f32_16x16x32_bf16 v[2:5], a[220:223], v[20:23], v[2:5]
    v_lshl_add_u32 v133, v133, 12, v134
    s_waitcnt lgkmcnt(0)
    v_mfma_f32_16x16x32_bf16 v[6:9], v[172:175], v[20:23], v[6:9]
    v_mfma_f32_16x16x32_bf16 v[10:13], v[236:239], v[20:23], v[10:13]
    s_andn2_b32 s63, 0x4000, s21
    s_add_u32 s63, s63, s20
    v_mfma_f32_16x16x32_bf16 v[2:5], a[224:227], v[20:23], v[2:5]
    s_add_u32 m0, s64, 0
    s_add_u32 s58, s88, 0
    v_mfma_f32_16x16x32_bf16 v[6:9], v[176:179], v[20:23], v[6:9]
    buffer_load_dwordx4 v142, s[40:43], s58 offen offset:0 lds
    s_add_u32 s58, s88, 7168
    v_mfma_f32_16x16x32_bf16 v[10:13], v[240:243], v[20:23], v[10:13]
    buffer_load_dwordx4 v142, s[40:43], s58 offen offset:1024 lds
    s_add_u32 s58, s88, 14336
    v_mfma_f32_16x16x32_bf16 v[2:5], a[228:231], v[20:23], v[2:5]
    buffer_load_dwordx4 v142, s[40:43], s58 offen offset:2048 lds
    s_add_u32 s58, s88, 21504
    v_mfma_f32_16x16x32_bf16 v[6:9], v[180:183], v[20:23], v[6:9]
    buffer_load_dwordx4 v142, s[40:43], s58 offen offset:3072 lds
    s_and_b32 s75, s50, 0
    v_mfma_f32_16x16x32_bf16 v[10:13], v[244:247], v[20:23], v[10:13]
    s_xor_b32 s75, s75, 0
    s_lshl_b32 s75, s75, 14
    v_mfma_f32_16x16x32_bf16 v[2:5], a[232:235], v[20:23], v[2:5]
    s_add_u32 s94, s4, s75
    s_add_u32 s101, s5, s75
    v_mfma_f32_16x16x32_bf16 v[6:9], v[184:187], v[20:23], v[6:9]
    s_and_b32 s75, s50, 0
    s_xor_b32 s75, s75, 1
    v_mfma_f32_16x16x32_bf16 v[10:13], v[248:251], v[20:23], v[10:13]
    s_lshl_b32 s75, s75, 14
    s_add_u32 s95, s4, s75
    v_mfma_f32_16x16x32_bf16 v[2:5], a[236:239], v[20:23], v[2:5]
    s_add_u32 s18, s5, s75
    s_and_b32 s75, s50, 0
    v_mfma_f32_16x16x32_bf16 v[6:9], v[188:191], v[20:23], v[6:9]
    s_xor_b32 s75, s75, 2
    s_lshl_b32 s75, s75, 14
    v_mfma_f32_16x16x32_bf16 v[10:13], v[252:255], v[20:23], v[10:13]
    s_add_u32 s100, s4, s75
    s_add_u32 s54, s5, s75
    s_and_b32 s75, s50, 0
    s_xor_b32 s75, s75, 3
    s_lshl_b32 s75, s75, 14
    s_add_u32 s4, s4, s75
    s_add_u32 s5, s5, s75
    s_waitcnt vmcnt(9)
    ds_read2st64_b32 v[104:105], v101 offset0:0 offset1:4
    ds_read2st64_b32 v[106:107], v101 offset0:8 offset1:12
    s_waitcnt lgkmcnt(0)
    v_or3_b32 v104, v104, v105, -2
    v_or3_b32 v102, v104, v106, v107
    v_cmp_eq_u32 vcc, -1, v102
    s_cbranch_vccnz L_re_25
L_bk_26:
    s_barrier
    s_cmp_eq_u32 s48, 3
    s_cbranch_scc1 L_g1w3_27
    ds_read_b64_tr_b16 v[68:69], v14 offset:0
    ds_read_b64_tr_b16 v[70:71], v14 offset:1024
    ds_read_b64_tr_b16 v[72:73], v15 offset:0
    ds_read_b64_tr_b16 v[74:75], v15 offset:1024
    ds_read_b64_tr_b16 v[76:77], v14 offset:2048
    ds_read_b64_tr_b16 v[78:79], v14 offset:3072
    s_waitcnt lgkmcnt(4)
    v_mfma_f32_16x16x32_bf16 v[20:23], a[176:179], v[68:71], 0
    ds_read_b64_tr_b16 v[80:81], v15 offset:2048
    buffer_load_dword v132, v133, s[32:35], s31 offen sc1
    v_mfma_f32_16x16x32_bf16 v[36:39], a[240:243], v[68:71], 0
    ds_read_b64_tr_b16 v[82:83], v15 offset:3072
    s_add_u32 m0, s64, 4096
    v_mfma_f32_16x16x32_bf16 v[52:55], v[192:195], v[68:71], 0
    ds_read_b64_tr_b16 v[84:85], v14 offset:4096
    s_waitcnt lgkmcnt(5)
    v_mfma_f32_16x16x32_bf16 v[24:27], a[176:179], v[72:75], 0
    ds_read_b64_tr_b16 v[86:87], v14 offset:5120
    s_add_u32 s58, s88, 49152
    v_mfma_f32_16x16x32_bf16 v[40:43], a[240:243], v[72:75], 0
    ds_read_b64_tr_b16 v[88:89], v15 offset:4096
    buffer_load_dwordx4 v142, s[40:43], s58 offen offset:0 lds
    v_mfma_f32_16x16x32_bf16 v[56:59], v[192:195], v[72:75], 0
    ds_read_b64_tr_b16 v[90:91], v15 offset:5120
    s_waitcnt lgkmcnt(6)
    v_mfma_f32_16x16x32_bf16 v[20:23], a[180:183], v[76:79], v[20:23]
    ds_read_b64_tr_b16 v[92:93], v14 offset:6144
    s_add_u32 s58, s88, 56320
    v_mfma_f32_16x16x32_bf16 v[36:39], a[244:247], v[76:79], v[36:39]
    ds_read_b64_tr_b16 v[94:95], v14 offset:7168
    buffer_load_dwordx4 v142, s[40:43], s58 offen offset:1024 lds
    v_mfma_f32_16x16x32_bf16 v[52:55], v[196:199], v[76:79], v[52:55]
    ds_read_b64_tr_b16 v[96:97], v15 offset:6144
    s_waitcnt lgkmcnt(7)
    v_mfma_f32_16x16x32_bf16 v[24:27], a[180:183], v[80:83], v[24:27]
    ds_read_b64_tr_b16 v[98:99], v15 offset:7168
    s_add_u32 s58, s88, 63488
    v_mfma_f32_16x16x32_bf16 v[40:43], a[244:247], v[80:83], v[40:43]
    ds_read_b64_tr_b16 v[68:69], v14 offset:8192
    buffer_load_dwordx4 v142, s[40:43], s58 offen offset:2048 lds
    v_mfma_f32_16x16x32_bf16 v[56:59], v[196:199], v[80:83], v[56:59]
    ds_read_b64_tr_b16 v[70:71], v14 offset:9216
    s_waitcnt lgkmcnt(8)
    v_mfma_f32_16x16x32_bf16 v[20:23], a[184:187], v[84:87], v[20:23]
    ds_read_b64_tr_b16 v[72:73], v15 offset:8192
    s_add_u32 s58, s88, 70656
    v_mfma_f32_16x16x32_bf16 v[36:39], a[248:251], v[84:87], v[36:39]
    ds_read_b64_tr_b16 v[74:75], v15 offset:9216
    buffer_load_dwordx4 v142, s[40:43], s58 offen offset:3072 lds
    v_mfma_f32_16x16x32_bf16 v[52:55], v[200:203], v[84:87], v[52:55]
    ds_read_b64_tr_b16 v[76:77], v14 offset:10240
    s_waitcnt lgkmcnt(9)
    v_mfma_f32_16x16x32_bf16 v[24:27], a[184:187], v[88:91], v[24:27]
    ds_read_b64_tr_b16 v[78:79], v14 offset:11264
    s_add_u32 m0, s64, 8192
    v_mfma_f32_16x16x32_bf16 v[40:43], a[248:251], v[88:91], v[40:43]
    ds_read_b64_tr_b16 v[80:81], v15 offset:10240
    s_add_u32 s58, s98, 0
    v_mfma_f32_16x16x32_bf16 v[56:59], v[200:203], v[88:91], v[56:59]
    ds_read_b64_tr_b16 v[82:83], v15 offset:11264
    s_waitcnt lgkmcnt(9)
    v_mfma_f32_16x16x32_bf16 v[20:23], a[188:191], v[92:95], v[20:23]
    ds_read_b64_tr_b16 v[84:85], v14 offset:12288
    buffer_load_dwordx4 v142, s[40:43], s58 offen offset:0 lds
    v_mfma_f32_16x16x32_bf16 v[36:39], a[252:255], v[92:95], v[36:39]
    ds_read_b64_tr_b16 v[86:87], v14 offset:13312
    s_add_u32 s58, s98, 7168
    v_mfma_f32_16x16x32_bf16 v[52:55], v[204:207], v[92:95], v[52:55]
    ds_read_b64_tr_b16 v[88:89], v15 offset:12288
    s_waitcnt lgkmcnt(9)
    v_mfma_f32_16x16x32_bf16 v[24:27], a[188:191], v[96:99], v[24:27]
    ds_read_b64_tr_b16 v[90:91], v15 offset:13312
    buffer_load_dwordx4 v142, s[40:43], s58 offen offset:1024 lds
    v_mfma_f32_16x16x32_bf16 v[40:43], a[252:255], v[96:99], v[40:43]
    s_waitcnt vmcnt(12)
    ds_read2st64_b32 v[104:105], v101 offset0:64 offset1:68
    v_mfma_f32_16x16x32_bf16 v[56:59], v[204:207], v[96:99], v[56:59]
    ds_read_b64_tr_b16 v[92:93], v14 offset:14336
    s_add_u32 s58, s98, 14336
    v_mfma_f32_16x16x32_bf16 v[20:23], a[192:195], v[68:71], v[20:23]
    ds_read_b64_tr_b16 v[94:95], v14 offset:15360
    buffer_load_dwordx4 v142, s[40:43], s58 offen offset:2048 lds
    v_mfma_f32_16x16x32_bf16 v[36:39], v[144:147], v[68:71], v[36:39]
    ds_read2st64_b32 v[106:107], v101 offset0:72 offset1:76
    s_add_u32 s58, s98, 21504
    v_mfma_f32_16x16x32_bf16 v[52:55], v[208:211], v[68:71], v[52:55]
    ds_read_b64_tr_b16 v[96:97], v15 offset:14336
    s_waitcnt lgkmcnt(9)
    v_mfma_f32_16x16x32_bf16 v[24:27], a[192:195], v[72:75], v[24:27]
    ds_read_b64_tr_b16 v[98:99], v15 offset:15360
    buffer_load_dwordx4 v142, s[40:43], s58 offen offset:3072 lds
    v_mfma_f32_16x16x32_bf16 v[40:43], v[144:147], v[72:75], v[40:43]
    s_add_u32 m0, s64, 12288
    s_add_u32 s58, s98, 49152
    v_mfma_f32_16x16x32_bf16 v[56:59], v[208:211], v[72:75], v[56:59]
    buffer_load_dwordx4 v142, s[40:43], s58 offen offset:0 lds
    s_waitcnt lgkmcnt(2)
    v_mfma_f32_16x16x32_bf16 v[20:23], a[196:199], v[76:79], v[20:23]
    v_or3_b32 v104, v104, v105, -2
    v_or3_b32 v102, v104, v106, v107
    v_mfma_f32_16x16x32_bf16 v[36:39], v[148:151], v[76:79], v[36:39]
    s_add_u32 s58, s98, 56320
    buffer_load_dwordx4 v142, s[40:43], s58 offen offset:1024 lds
    v_mfma_f32_16x16x32_bf16 v[52:55], v[212:215], v[76:79], v[52:55]
    v_cmp_eq_u32 vcc, -1, v102
    s_cbranch_vccnz L_re_29
L_bk_30:
    s_barrier
    v_mfma_f32_16x16x32_bf16 v[24:27], a[196:199], v[80:83], v[24:27]
    ds_read_b64_tr_b16 v[68:69], v14 offset:16384
    v_xad_u32 v138, v16, 0, s64
    v_mfma_f32_16x16x32_bf16 v[40:43], v[148:151], v[80:83], v[40:43]
    ds_read_b64_tr_b16 v[70:71], v14 offset:17408
    v_xad_u32 v139, v17, 0, s64
    v_mfma_f32_16x16x32_bf16 v[56:59], v[212:215], v[80:83], v[56:59]
    ds_read_b64_tr_b16 v[72:73], v15 offset:16384
    s_add_u32 s58, s98, 63488
    v_mfma_f32_16x16x32_bf16 v[20:23], a[200:203], v[84:87], v[20:23]
    ds_read_b64_tr_b16 v[74:75], v15 offset:17408
    buffer_load_dwordx4 v142, s[40:43], s58 offen offset:2048 lds
    v_mfma_f32_16x16x32_bf16 v[36:39], v[152:155], v[84:87], v[36:39]
    ds_read_b64_tr_b16 v[76:77], v14 offset:18432
    v_xad_u32 v140, v16, 64, s64
    v_mfma_f32_16x16x32_bf16 v[52:55], v[216:219], v[84:87], v[52:55]
    ds_read_b64_tr_b16 v[78:79], v14 offset:19456
    v_xad_u32 v141, v17, 64, s64
    v_mfma_f32_16x16x32_bf16 v[24:27], a[200:203], v[88:91], v[24:27]
    ds_read_b64_tr_b16 v[80:81], v15 offset:18432
    s_waitcnt vmcnt(12)
    v_mfma_f32_16x16x32_bf16 v[40:43], v[152:155], v[88:91], v[40:43]
    ds_read_b64_tr_b16 v[82:83], v15 offset:19456
    s_add_u32 s58, s98, 70656
    v_mfma_f32_16x16x32_bf16 v[56:59], v[216:219], v[88:91], v[56:59]
    buffer_load_dwordx4 v142, s[40:43], s58 offen offset:3072 lds
    ds_read_b64_tr_b16 v[84:85], v14 offset:20480
    v_mfma_f32_16x16x32_bf16 v[20:23], a[204:207], v[92:95], v[20:23]
    ds_read_b64_tr_b16 a[32:33], v138 offset:0
    v_mfma_f32_16x16x32_bf16 v[36:39], v[156:159], v[92:95], v[36:39]
    ds_read_b64_tr_b16 a[34:35], v138 offset:2048
    v_mfma_f32_16x16x32_bf16 v[52:55], v[220:223], v[92:95], v[52:55]
    ds_read_b64_tr_b16 a[36:37], v139 offset:0
    s_waitcnt lgkmcnt(9)
    v_mfma_f32_16x16x32_bf16 v[24:27], a[204:207], v[96:99], v[24:27]
    ds_read_b64_tr_b16 a[38:39], v139 offset:2048
    v_mfma_f32_16x16x32_bf16 v[40:43], v[156:159], v[96:99], v[40:43]
    ds_read_b64_tr_b16 a[40:41], v140 offset:0
    v_mfma_f32_16x16x32_bf16 v[56:59], v[220:223], v[96:99], v[56:59]
    s_add_u32 m0, s20, 32768
    s_add_u32 s76, s15, 2048
    buffer_load_dwordx4 v100, s[32:35], s76 offen offset:0 sc1 lds
    v_mfma_f32_16x16x32_bf16 v[20:23], a[208:211], v[68:71], v[20:23]
    ds_read_b64_tr_b16 a[42:43], v140 offset:2048
    v_mfma_f32_16x16x32_bf16 v[36:39], v[160:163], v[68:71], v[36:39]
    ds_read_b64_tr_b16 a[44:45], v141 offset:0
    v_mfma_f32_16x16x32_bf16 v[52:55], v[224:227], v[68:71], v[52:55]
    ds_read_b64_tr_b16 v[86:87], v14 offset:21504
    s_waitcnt lgkmcnt(8)
    v_mfma_f32_16x16x32_bf16 v[24:27], a[208:211], v[72:75], v[24:27]
    ds_read_b64_tr_b16 a[46:47], v141 offset:2048
    v_mfma_f32_16x16x32_bf16 v[40:43], v[160:163], v[72:75], v[40:43]
    s_add_u32 s76, s15, 66560
    buffer_load_dwordx4 v100, s[32:35], s76 offen offset:1024 sc1 lds
    v_mfma_f32_16x16x32_bf16 v[56:59], v[224:227], v[72:75], v[56:59]
    ds_read_b64_tr_b16 v[88:89], v15 offset:20480
    s_waitcnt vmcnt(10)
    v_mfma_f32_16x16x32_bf16 v[20:23], a[212:215], v[76:79], v[20:23]
    ds_read_b64_tr_b16 v[90:91], v15 offset:21504
    ds_read_b64_tr_b16 a[48:49], v138 offset:4096
    v_mfma_f32_16x16x32_bf16 v[36:39], v[164:167], v[76:79], v[36:39]
    ds_read_b64_tr_b16 a[50:51], v138 offset:6144
    v_mfma_f32_16x16x32_bf16 v[52:55], v[228:231], v[76:79], v[52:55]
    ds_read_b64_tr_b16 v[92:93], v14 offset:22528
    s_add_u32 s76, s15, 131072
    buffer_load_dwordx4 v100, s[32:35], s76 offen offset:2048 sc1 lds
    v_mfma_f32_16x16x32_bf16 v[24:27], a[212:215], v[80:83], v[24:27]
    ds_read_b64_tr_b16 v[94:95], v14 offset:23552
    ds_read_b64_tr_b16 a[52:53], v139 offset:4096
    v_mfma_f32_16x16x32_bf16 v[40:43], v[164:167], v[80:83], v[40:43]
    ds_read_b64_tr_b16 a[54:55], v139 offset:6144
    v_mfma_f32_16x16x32_bf16 v[56:59], v[228:231], v[80:83], v[56:59]
    ds_read_b64_tr_b16 v[96:97], v15 offset:22528
    s_waitcnt lgkmcnt(10)
    v_mfma_f32_16x16x32_bf16 v[20:23], a[216:219], v[84:87], v[20:23]
    ds_read_b64_tr_b16 v[98:99], v15 offset:23552
    ds_read_b64_tr_b16 a[56:57], v140 offset:4096
    v_mfma_f32_16x16x32_bf16 v[36:39], v[168:171], v[84:87], v[36:39]
    s_add_u32 s76, s15, 195584
    buffer_load_dwordx4 v100, s[32:35], s76 offen offset:3072 sc1 lds
    v_mfma_f32_16x16x32_bf16 v[52:55], v[232:235], v[84:87], v[52:55]
    ds_read_b64_tr_b16 v[68:69], v14 offset:24576
    s_waitcnt lgkmcnt(10)
    v_mfma_f32_16x16x32_bf16 v[24:27], a[216:219], v[88:91], v[24:27]
    ds_read_b64_tr_b16 v[70:71], v14 offset:25600
    ds_read_b64_tr_b16 a[58:59], v140 offset:6144
    v_mfma_f32_16x16x32_bf16 v[40:43], v[168:171], v[88:91], v[40:43]
    ds_read_b64_tr_b16 a[60:61], v141 offset:4096
    v_mfma_f32_16x16x32_bf16 v[56:59], v[232:235], v[88:91], v[56:59]
    ds_read_b64_tr_b16 v[72:73], v15 offset:24576
    s_waitcnt lgkmcnt(10)
    v_mfma_f32_16x16x32_bf16 v[20:23], a[220:223], v[92:95], v[20:23]
    ds_read_b64_tr_b16 v[74:75], v15 offset:25600
    ds_read_b64_tr_b16 a[62:63], v141 offset:6144
    v_mfma_f32_16x16x32_bf16 v[36:39], v[172:175], v[92:95], v[36:39]
    s_add_u32 m0, s20, 49152
    s_add_u32 s76, s52, 2048
    buffer_load_dwordx4 v100, s[32:35], s76 offen offset:0 sc1 lds
    v_mfma_f32_16x16x32_bf16 v[52:55], v[236:239], v[92:95], v[52:55]
    ds_read_b64_tr_b16 v[76:77], v14 offset:26624
    s_waitcnt lgkmcnt(9)
    v_mfma_f32_16x16x32_bf16 v[24:27], a[220:223], v[96:99], v[24:27]
    ds_read_b64_tr_b16 v[78:79], v14 offset:27648
    s_waitcnt vmcnt(9)
    v_mfma_f32_16x16x32_bf16 v[40:43], v[172:175], v[96:99], v[40:43]
    ds_read_b64_tr_b16 a[64:65], v138 offset:8192
    v_mfma_f32_16x16x32_bf16 v[56:59], v[236:239], v[96:99], v[56:59]
    ds_read_b64_tr_b16 v[80:81], v15 offset:26624
    s_waitcnt lgkmcnt(9)
    v_mfma_f32_16x16x32_bf16 v[20:23], a[224:227], v[68:71], v[20:23]
    ds_read_b64_tr_b16 v[82:83], v15 offset:27648
    ds_read_b64_tr_b16 a[66:67], v138 offset:10240
    s_add_u32 s76, s52, 66560
    buffer_load_dwordx4 v100, s[32:35], s76 offen offset:1024 sc1 lds
    ds_read_b64_tr_b16 a[68:69], v139 offset:8192
    ds_read_b64_tr_b16 a[70:71], v139 offset:10240
    ds_read_b64_tr_b16 a[72:73], v140 offset:8192
    s_add_u32 s76, s52, 131072
    buffer_load_dwordx4 v100, s[32:35], s76 offen offset:2048 sc1 lds
    ds_read_b64_tr_b16 a[74:75], v140 offset:10240
    ds_read_b64_tr_b16 a[76:77], v141 offset:8192
    ds_read_b64_tr_b16 a[78:79], v141 offset:10240
    s_add_u32 s76, s52, 195584
    buffer_load_dwordx4 v100, s[32:35], s76 offen offset:3072 sc1 lds
    s_waitcnt vmcnt(8)
    ds_read_b64_tr_b16 a[80:81], v138 offset:12288
    ds_read_b64_tr_b16 a[82:83], v138 offset:14336
    ds_read_b64_tr_b16 a[84:85], v139 offset:12288
    ds_read_b64_tr_b16 a[86:87], v139 offset:14336
    ds_read_b64_tr_b16 a[88:89], v140 offset:12288
    ds_read_b64_tr_b16 a[90:91], v140 offset:14336
    ds_read_b64_tr_b16 a[92:93], v141 offset:12288
    ds_read_b64_tr_b16 a[94:95], v141 offset:14336
    s_waitcnt lgkmcnt(0)
    v_mfma_f32_16x16x32_bf16 v[36:39], v[176:179], v[68:71], v[36:39]
    ds_read_b64_tr_b16 v[84:85], v14 offset:28672
    s_add_u32 m0, s64, 0
    v_mfma_f32_16x16x32_bf16 v[52:55], v[240:243], v[68:71], v[52:55]
    ds_read_b64_tr_b16 v[86:87], v14 offset:29696
    s_add_u32 s58, s99, 0
    v_mfma_f32_16x16x32_bf16 v[24:27], a[224:227], v[72:75], v[24:27]
    ds_read_b64_tr_b16 v[88:89], v15 offset:28672
    buffer_load_dwordx4 v142, s[40:43], s58 offen offset:0 lds
    v_mfma_f32_16x16x32_bf16 v[40:43], v[176:179], v[72:75], v[40:43]
    ds_read_b64_tr_b16 v[90:91], v15 offset:29696
    v_mfma_f32_16x16x32_bf16 v[56:59], v[240:243], v[72:75], v[56:59]
    ds_read_b64_tr_b16 v[92:93], v14 offset:30720
    v_mfma_f32_16x16x32_bf16 v[20:23], a[228:231], v[76:79], v[20:23]
    ds_read_b64_tr_b16 v[94:95], v14 offset:31744
    s_add_u32 s58, s99, 7168
    v_mfma_f32_16x16x32_bf16 v[36:39], v[180:183], v[76:79], v[36:39]
    ds_read_b64_tr_b16 v[96:97], v15 offset:30720
    buffer_load_dwordx4 v142, s[40:43], s58 offen offset:1024 lds
    v_mfma_f32_16x16x32_bf16 v[52:55], v[244:247], v[76:79], v[52:55]
    ds_read_b64_tr_b16 v[98:99], v15 offset:31744
    s_waitcnt vmcnt(6)
    v_mfma_f32_16x16x32_bf16 v[24:27], a[228:231], v[80:83], v[24:27]
    ds_read2st64_b32 v[104:105], v101 offset0:128 offset1:132
    v_mfma_f32_16x16x32_bf16 v[40:43], v[180:183], v[80:83], v[40:43]
    ds_read2st64_b32 v[106:107], v101 offset0:136 offset1:140
    v_mfma_f32_16x16x32_bf16 v[56:59], v[244:247], v[80:83], v[56:59]
    s_add_u32 s58, s99, 14336
    s_waitcnt lgkmcnt(8)
    v_mfma_f32_16x16x32_bf16 v[20:23], a[232:235], v[84:87], v[20:23]
    buffer_load_dwordx4 v142, s[40:43], s58 offen offset:2048 lds
    v_mfma_f32_16x16x32_bf16 v[36:39], v[184:187], v[84:87], v[36:39]
    v_mfma_f32_16x16x32_bf16 v[52:55], v[248:251], v[84:87], v[52:55]
    s_waitcnt lgkmcnt(5)
    v_mfma_f32_16x16x32_bf16 v[24:27], a[232:235], v[88:91], v[24:27]
    s_waitcnt lgkmcnt(0)
    v_mfma_f32_16x16x32_bf16 v[40:43], v[184:187], v[88:91], v[40:43]
    v_or3_b32 v104, v104, v105, -2
    v_or3_b32 v102, v104, v106, v107
    v_mfma_f32_16x16x32_bf16 v[56:59], v[248:251], v[88:91], v[56:59]
    s_add_u32 s58, s99, 21504
    buffer_load_dwordx4 v142, s[40:43], s58 offen offset:3072 lds
    v_mfma_f32_16x16x32_bf16 v[20:23], a[236:239], v[92:95], v[20:23]
    v_cmp_eq_u32 vcc, -1, v102
    s_cbranch_vccnz L_re_31
L_bk_32:
    s_barrier
    v_mfma_f32_16x16x32_bf16 v[36:39], v[188:191], v[92:95], v[36:39]
    ds_read_b64_tr_b16 v[68:69], v14 offset:32768
    v_mfma_f32_16x16x32_bf16 v[52:55], v[252:255], v[92:95], v[52:55]
    ds_read_b64_tr_b16 v[70:71], v14 offset:33792
    v_mfma_f32_16x16x32_bf16 v[24:27], a[236:239], v[96:99], v[24:27]
    ds_read_b64_tr_b16 v[72:73], v15 offset:32768
    s_add_u32 m0, s64, 4096
    v_mfma_f32_16x16x32_bf16 v[40:43], v[188:191], v[96:99], v[40:43]
    ds_read_b64_tr_b16 v[74:75], v15 offset:33792
    s_add_u32 s58, s99, 49152
    v_mfma_f32_16x16x32_bf16 v[56:59], v[252:255], v[96:99], v[56:59]
    ds_read_b64_tr_b16 v[76:77], v14 offset:34816
    s_waitcnt lgkmcnt(3)
    v_mfma_f32_16x16x32_bf16 v[28:31], a[176:179], v[68:71], 0
    ds_read_b64_tr_b16 v[78:79], v14 offset:35840
    buffer_load_dwordx4 v142, s[40:43], s58 offen offset:0 lds
    v_mfma_f32_16x16x32_bf16 v[44:47], a[240:243], v[68:71], 0
    ds_read_b64_tr_b16 v[80:81], v15 offset:34816
    v_mfma_f32_16x16x32_bf16 v[60:63], v[192:195], v[68:71], 0
    ds_read_b64_tr_b16 v[82:83], v15 offset:35840
    s_waitcnt lgkmcnt(4)
    v_mfma_f32_16x16x32_bf16 v[32:35], a[176:179], v[72:75], 0
    ds_read_b64_tr_b16 v[84:85], v14 offset:36864
    s_add_u32 s58, s99, 56320
    v_mfma_f32_16x16x32_bf16 v[48:51], a[240:243], v[72:75], 0
    ds_read_b64_tr_b16 v[86:87], v14 offset:37888
    buffer_load_dwordx4 v142, s[40:43], s58 offen offset:1024 lds
    v_mfma_f32_16x16x32_bf16 v[64:67], v[192:195], v[72:75], 0
    ds_read_b64_tr_b16 v[88:89], v15 offset:36864
    s_waitcnt lgkmcnt(5)
    v_mfma_f32_16x16x32_bf16 v[28:31], a[180:183], v[76:79], v[28:31]
    ds_read_b64_tr_b16 v[90:91], v15 offset:37888
    s_barrier
    v_mfma_f32_16x16x32_bf16 v[44:47], a[244:247], v[76:79], v[44:47]
    ds_read_b64_tr_b16 v[92:93], v14 offset:38912
    ds_read2_b32 v[136:137], v103 offset0:0 offset1:16
    v_mfma_f32_16x16x32_bf16 v[60:63], v[196:199], v[76:79], v[60:63]
    ds_read_b64_tr_b16 v[94:95], v14 offset:39936
    s_waitcnt lgkmcnt(7)
    v_mfma_f32_16x16x32_bf16 v[32:35], a[180:183], v[80:83], v[32:35]
    ds_read_b64_tr_b16 v[96:97], v15 offset:38912
    s_add_u32 s58, s99, 63488
    v_mfma_f32_16x16x32_bf16 v[48:51], a[244:247], v[80:83], v[48:51]
    ds_read_b64_tr_b16 v[98:99], v15 offset:39936
    buffer_load_dwordx4 v142, s[40:43], s58 offen offset:2048 lds
    v_mfma_f32_16x16x32_bf16 v[64:67], v[196:199], v[80:83], v[64:67]
    ds_read_b64_tr_b16 v[68:69], v14 offset:40960
    s_waitcnt lgkmcnt(8)
    v_mfma_f32_16x16x32_bf16 v[28:31], a[184:187], v[84:87], v[28:31]
    ds_read_b64_tr_b16 v[70:71], v14 offset:41984
    s_waitcnt lgkmcnt(5)
    v_mfma_f32_16x16x32_bf16 v[44:47], a[248:251], v[84:87], v[44:47]
    ds_read_b64_tr_b16 v[72:73], v15 offset:40960
    v_fma_f32 v20, -v136, v2, v20
    v_mfma_f32_16x16x32_bf16 v[60:63], v[200:203], v[84:87], v[60:63]
    ds_read_b64_tr_b16 v[74:75], v15 offset:41984
    v_fma_f32 v21, -v136, v3, v21
    v_mfma_f32_16x16x32_bf16 v[32:35], a[184:187], v[88:91], v[32:35]
    ds_read_b64_tr_b16 v[76:77], v14 offset:43008
    v_fma_f32 v22, -v136, v4, v22
    v_mfma_f32_16x16x32_bf16 v[48:51], a[248:251], v[88:91], v[48:51]
    ds_read_b64_tr_b16 v[78:79], v14 offset:44032
    v_fma_f32 v23, -v136, v5, v23
    v_mfma_f32_16x16x32_bf16 v[64:67], v[200:203], v[88:91], v[64:67]
    ds_read_b64_tr_b16 v[80:81], v15 offset:43008
    s_waitcnt lgkmcnt(9)
    v_mfma_f32_16x16x32_bf16 v[28:31], a[188:191], v[92:95], v[28:31]
    ds_read_b64_tr_b16 v[82:83], v15 offset:44032
    v_cvt_pk_bf16_f32 v20, v20, v21
L_stub_3:
    s_cbranch_execz L_stub_7
    s_nop 0
    v_mfma_f32_16x16x32_bf16 v[44:47], a[252:255], v[92:95], v[44:47]
    v_cvt_pk_bf16_f32 v21, v22, v23
    v_pk_max_i16 v20, v20, 0
    v_mfma_f32_16x16x32_bf16 v[60:63], v[204:207], v[92:95], v[60:63]
    s_add_u32 s58, s99, 70656
    buffer_load_dwordx4 v142, s[40:43], s58 offen offset:3072 lds
    s_waitcnt lgkmcnt(7)
    v_mfma_f32_16x16x32_bf16 v[32:35], a[188:191], v[96:99], v[32:35]
    v_pk_max_i16 v21, v21, 0
    v_fma_f32 v36, -v136, v6, v36
    v_mfma_f32_16x16x32_bf16 v[48:51], a[252:255], v[96:99], v[48:51]
    v_fma_f32 v37, -v136, v7, v37
    v_fma_f32 v38, -v136, v8, v38
    v_mfma_f32_16x16x32_bf16 v[64:67], v[204:207], v[96:99], v[64:67]
    v_fma_f32 v39, -v136, v9, v39
    s_waitcnt lgkmcnt(4)
    v_mfma_f32_16x16x32_bf16 v[28:31], a[192:195], v[68:71], v[28:31]
    v_cvt_pk_bf16_f32 v22, v36, v37
    v_cvt_pk_bf16_f32 v23, v38, v39
    v_mfma_f32_16x16x32_bf16 v[44:47], v[144:147], v[68:71], v[44:47]
    v_pk_max_i16 v22, v22, 0
    v_pk_max_i16 v23, v23, 0
    v_mfma_f32_16x16x32_bf16 v[60:63], v[208:211], v[68:71], v[60:63]
    ds_read_b64_tr_b16 v[84:85], v14 offset:45056
    s_add_u32 s80, s12, 0
    s_cmp_eq_u32 s53, 0
    s_cbranch_scc1 L_hs_44
    buffer_store_dwordx4 v[20:23], v143, s[32:35], s80 offen
L_he_45:
    v_mfma_f32_16x16x32_bf16 v[32:35], a[192:195], v[72:75], v[32:35]
    ds_read_b64_tr_b16 v[86:87], v14 offset:46080
    v_fma_f32 v24, -v137, v2, v24
    v_mfma_f32_16x16x32_bf16 v[48:51], v[144:147], v[72:75], v[48:51]
    v_fma_f32 v25, -v137, v3, v25
    s_add_u32 m0, s64, 8192
    s_add_u32 s58, s66, 32768
    buffer_load_dwordx4 v142, s[40:43], s58 offen offset:0 lds
    v_mfma_f32_16x16x32_bf16 v[64:67], v[208:211], v[72:75], v[64:67]
    ds_read_b64_tr_b16 v[88:89], v15 offset:45056
    s_waitcnt lgkmcnt(3)
    v_mfma_f32_16x16x32_bf16 v[28:31], a[196:199], v[76:79], v[28:31]
    ds_read_b64_tr_b16 v[90:91], v15 offset:46080
    v_fma_f32 v26, -v137, v4, v26
    v_mfma_f32_16x16x32_bf16 v[44:47], v[148:151], v[76:79], v[44:47]
    v_fma_f32 v27, -v137, v5, v27
    v_cvt_pk_bf16_f32 v24, v24, v25
    v_mfma_f32_16x16x32_bf16 v[60:63], v[212:215], v[76:79], v[60:63]
    ds_read_b64_tr_b16 v[92:93], v14 offset:47104
    v_cvt_pk_bf16_f32 v25, v26, v27
    v_mfma_f32_16x16x32_bf16 v[32:35], a[196:199], v[80:83], v[32:35]
    ds_read_b64_tr_b16 v[94:95], v14 offset:48128
    v_pk_max_i16 v24, v24, 0
    v_mfma_f32_16x16x32_bf16 v[48:51], v[148:151], v[80:83], v[48:51]
    v_pk_max_i16 v25, v25, 0
    v_fma_f32 v40, -v137, v6, v40
    v_mfma_f32_16x16x32_bf16 v[64:67], v[212:215], v[80:83], v[64:67]
    ds_read_b64_tr_b16 v[96:97], v15 offset:47104
    s_waitcnt lgkmcnt(5)
    v_mfma_f32_16x16x32_bf16 v[28:31], a[200:203], v[84:87], v[28:31]
    ds_read_b64_tr_b16 v[98:99], v15 offset:48128
    v_fma_f32 v41, -v137, v7, v41
    v_mfma_f32_16x16x32_bf16 v[44:47], v[152:155], v[84:87], v[44:47]
    s_waitcnt vmcnt(10)
    ds_read2st64_b32 v[104:105], v101 offset0:192 offset1:196
    v_mfma_f32_16x16x32_bf16 v[60:63], v[216:219], v[84:87], v[60:63]
    v_fma_f32 v42, -v137, v8, v42
    s_waitcnt lgkmcnt(5)
    v_mfma_f32_16x16x32_bf16 v[32:35], a[200:203], v[88:91], v[32:35]
    v_fma_f32 v43, -v137, v9, v43
    ds_read2st64_b32 v[106:107], v101 offset0:200 offset1:204
    v_mfma_f32_16x16x32_bf16 v[48:51], v[152:155], v[88:91], v[48:51]
    v_cvt_pk_bf16_f32 v26, v40, v41
    v_cvt_pk_bf16_f32 v27, v42, v43
    v_mfma_f32_16x16x32_bf16 v[64:67], v[216:219], v[88:91], v[64:67]
    v_pk_max_i16 v26, v26, 0
    s_add_u32 s58, s66, 39936
    buffer_load_dwordx4 v142, s[40:43], s58 offen offset:1024 lds
    v_pk_max_i16 v27, v27, 0
    s_add_u32 s80, s12, 65536
    s_cmp_eq_u32 s53, 0
    s_cbranch_scc1 L_hs_46
    buffer_store_dwordx4 v[24:27], v143, s[32:35], s80 offen
L_he_47:
    v_fma_f32 v52, -v136, v10, v52
    v_fma_f32 v53, -v136, v11, v53
    v_fma_f32 v54, -v136, v12, v54
    v_fma_f32 v55, -v136, v13, v55
    v_cvt_pk_bf16_f32 v52, v52, v53
    v_cvt_pk_bf16_f32 v53, v54, v55
    v_pk_max_i16 v52, v52, 0
    v_pk_max_i16 v53, v53, 0
    v_fma_f32 v56, -v137, v10, v56
    v_fma_f32 v57, -v137, v11, v57
    s_add_u32 s58, s66, 79872
    buffer_load_dwordx4 v142, s[40:43], s58 offen offset:2048 lds
    v_fma_f32 v58, -v137, v12, v58
    v_fma_f32 v59, -v137, v13, v59
    v_cvt_pk_bf16_f32 v54, v56, v57
    s_waitcnt lgkmcnt(0)
    v_cvt_pk_bf16_f32 v55, v58, v59
    v_pk_max_i16 v54, v54, 0
    v_or3_b32 v104, v104, v105, -2
    v_or3_b32 v102, v104, v106, v107
    v_pk_max_i16 v55, v55, 0
    s_cmp_eq_u32 s14, 0
    s_cbranch_scc1 L_nosw_35
    v_swap_b32 v52, v54
    v_swap_b32 v53, v55
L_nosw_35:
    s_add_u32 s80, s13, 0
    s_cmp_eq_u32 s53, 0
    s_cbranch_scc1 L_hs_48
    buffer_store_dwordx4 v[52:55], v143, s[32:35], s80 offen
L_he_49:
    v_mfma_f32_16x16x32_bf16 v[28:31], a[204:207], v[92:95], v[28:31]
    v_cmp_eq_u32 vcc, -1, v102
    s_cbranch_vccnz L_re_33
L_bk_34:
    s_barrier
    v_mfma_f32_16x16x32_bf16 v[44:47], v[156:159], v[92:95], v[44:47]
    ds_read_b64_tr_b16 v[68:69], v14 offset:49152
    s_add_u32 s58, s66, 87040
    buffer_load_dwordx4 v142, s[40:43], s58 offen offset:3072 lds
    v_mfma_f32_16x16x32_bf16 v[60:63], v[220:223], v[92:95], v[60:63]
    ds_read_b64_tr_b16 v[70:71], v14 offset:50176
    s_add_u32 m0, s64, 12288
    s_add_u32 s58, s66, 208896
    buffer_load_dwordx4 v142, s[40:43], s58 offen offset:0 lds
    v_mfma_f32_16x16x32_bf16 v[32:35], a[204:207], v[96:99], v[32:35]
    ds_read_b64_tr_b16 v[72:73], v15 offset:49152
    s_add_u32 s58, s66, 216064
    v_mfma_f32_16x16x32_bf16 v[48:51], v[156:159], v[96:99], v[48:51]
    ds_read_b64_tr_b16 v[74:75], v15 offset:50176
    buffer_load_dwordx4 v142, s[40:43], s58 offen offset:1024 lds
    v_mfma_f32_16x16x32_bf16 v[64:67], v[220:223], v[96:99], v[64:67]
    ds_read_b64_tr_b16 v[76:77], v14 offset:51200
    s_waitcnt lgkmcnt(3)
    v_mfma_f32_16x16x32_bf16 v[28:31], a[208:211], v[68:71], v[28:31]
    ds_read_b64_tr_b16 v[78:79], v14 offset:52224
    s_add_u32 s58, s66, 256000
    v_mfma_f32_16x16x32_bf16 v[44:47], v[160:163], v[68:71], v[44:47]
    ds_read_b64_tr_b16 v[80:81], v15 offset:51200
    buffer_load_dwordx4 v142, s[40:43], s58 offen offset:2048 lds
    v_mfma_f32_16x16x32_bf16 v[60:63], v[224:227], v[68:71], v[60:63]
    ds_read_b64_tr_b16 v[82:83], v15 offset:52224
    s_waitcnt lgkmcnt(4)
    v_mfma_f32_16x16x32_bf16 v[32:35], a[208:211], v[72:75], v[32:35]
    ds_read_b64_tr_b16 v[84:85], v14 offset:53248
    v_mov_b32 v102, 1
    v_mfma_f32_16x16x32_bf16 v[48:51], v[160:163], v[72:75], v[48:51]
    ds_read_b64_tr_b16 v[86:87], v14 offset:54272
    s_waitcnt vmcnt(4)
    v_mfma_f32_16x16x32_bf16 v[64:67], v[224:227], v[72:75], v[64:67]
    s_mov_b32 exec_lo, 1
    s_mov_b32 exec_hi, 0
    s_cmp_eq_u32 s53, 0
    s_cbranch_scc1 L_hs_56
    buffer_store_dword v102, v143, s[32:35], s19 offen
L_he_57:
    s_mov_b64 exec, -1
    s_waitcnt lgkmcnt(4)
    v_mfma_f32_16x16x32_bf16 v[28:31], a[212:215], v[76:79], v[28:31]
    ds_read_b64_tr_b16 v[88:89], v15 offset:53248
    s_add_u32 s58, s66, 263168
    v_mfma_f32_16x16x32_bf16 v[44:47], v[164:167], v[76:79], v[44:47]
    ds_read_b64_tr_b16 v[90:91], v15 offset:54272
    buffer_load_dwordx4 v142, s[40:43], s58 offen offset:3072 lds
    v_mfma_f32_16x16x32_bf16 v[60:63], v[228:231], v[76:79], v[60:63]
    ds_read_b64_tr_b16 v[92:93], v14 offset:55296
    s_waitcnt lgkmcnt(5)
    v_mfma_f32_16x16x32_bf16 v[32:35], a[212:215], v[80:83], v[32:35]
    ds_read_b64_tr_b16 v[94:95], v14 offset:56320
    s_add_u32 m0, s63, 0
    v_mfma_f32_16x16x32_bf16 v[48:51], v[164:167], v[80:83], v[48:51]
    ds_read_b64_tr_b16 v[96:97], v15 offset:55296
    s_add_u32 s58, s66, 131072
    v_mfma_f32_16x16x32_bf16 v[64:67], v[228:231], v[80:83], v[64:67]
    ds_read_b64_tr_b16 v[98:99], v15 offset:56320
    s_waitcnt lgkmcnt(6)
    v_mfma_f32_16x16x32_bf16 v[28:31], a[216:219], v[84:87], v[28:31]
    ds_read_b64_tr_b16 v[68:69], v14 offset:57344
    buffer_load_dwordx4 v142, s[40:43], s58 offen offset:0 lds
    v_mfma_f32_16x16x32_bf16 v[44:47], v[168:171], v[84:87], v[44:47]
    ds_read_b64_tr_b16 v[70:71], v14 offset:58368
    v_mfma_f32_16x16x32_bf16 v[60:63], v[232:235], v[84:87], v[60:63]
    ds_read_b64_tr_b16 v[72:73], v15 offset:57344
    s_waitcnt lgkmcnt(7)
    v_mfma_f32_16x16x32_bf16 v[32:35], a[216:219], v[88:91], v[32:35]
    ds_read_b64_tr_b16 v[74:75], v15 offset:58368
    s_add_u32 s58, s66, 138240
    v_mfma_f32_16x16x32_bf16 v[48:51], v[168:171], v[88:91], v[48:51]
    ds_read_b64_tr_b16 v[76:77], v14 offset:59392
    buffer_load_dwordx4 v142, s[40:43], s58 offen offset:1024 lds
    v_mfma_f32_16x16x32_bf16 v[64:67], v[232:235], v[88:91], v[64:67]
    ds_read_b64_tr_b16 v[78:79], v14 offset:60416
    s_waitcnt lgkmcnt(8)
    v_mfma_f32_16x16x32_bf16 v[28:31], a[220:223], v[92:95], v[28:31]
    ds_read_b64_tr_b16 v[80:81], v15 offset:59392
    v_mfma_f32_16x16x32_bf16 v[44:47], v[172:175], v[92:95], v[44:47]
    ds_read_b64_tr_b16 v[82:83], v15 offset:60416
    s_add_u32 s58, s66, 305152
    v_mfma_f32_16x16x32_bf16 v[60:63], v[236:239], v[92:95], v[60:63]
    ds_read_b64_tr_b16 v[84:85], v14 offset:61440
    s_waitcnt lgkmcnt(9)
    v_mfma_f32_16x16x32_bf16 v[32:35], a[220:223], v[96:99], v[32:35]
    ds_read_b64_tr_b16 v[86:87], v14 offset:62464
    buffer_load_dwordx4 v142, s[40:43], s58 offen offset:2048 lds
    v_mfma_f32_16x16x32_bf16 v[48:51], v[172:175], v[96:99], v[48:51]
    ds_read_b64_tr_b16 v[88:89], v15 offset:61440
    v_mfma_f32_16x16x32_bf16 v[64:67], v[236:239], v[96:99], v[64:67]
    ds_read_b64_tr_b16 v[90:91], v15 offset:62464
    s_waitcnt lgkmcnt(9)
    v_mfma_f32_16x16x32_bf16 v[28:31], a[224:227], v[68:71], v[28:31]
    ds_read_b64_tr_b16 v[92:93], v14 offset:63488
    v_and_b32 v101, 7, v1
    v_mfma_f32_16x16x32_bf16 v[44:47], v[176:179], v[68:71], v[44:47]
    ds_read_b64_tr_b16 v[94:95], v14 offset:64512
    v_lshlrev_b32 v101, 2, v101
    v_mfma_f32_16x16x32_bf16 v[60:63], v[240:243], v[68:71], v[60:63]
    ds_read_b64_tr_b16 v[96:97], v15 offset:63488
    s_waitcnt lgkmcnt(9)
    v_mfma_f32_16x16x32_bf16 v[32:35], a[224:227], v[72:75], v[32:35]
    ds_read_b64_tr_b16 v[98:99], v15 offset:64512
    s_add_u32 s58, s66, 312320
    v_mfma_f32_16x16x32_bf16 v[48:51], v[176:179], v[72:75], v[48:51]
    buffer_load_dwordx4 v142, s[40:43], s58 offen offset:3072 lds
    v_mfma_f32_16x16x32_bf16 v[64:67], v[240:243], v[72:75], v[64:67]
    buffer_load_dword v102, v101, s[32:35], s11 offen sc1
    v_mfma_f32_16x16x32_bf16 v[28:31], a[228:231], v[76:79], v[28:31]
    v_mfma_f32_16x16x32_bf16 v[44:47], v[180:183], v[76:79], v[44:47]
    v_mfma_f32_16x16x32_bf16 v[60:63], v[244:247], v[76:79], v[60:63]
    s_waitcnt lgkmcnt(4)
    v_mfma_f32_16x16x32_bf16 v[32:35], a[228:231], v[80:83], v[32:35]
    v_mfma_f32_16x16x32_bf16 v[48:51], v[180:183], v[80:83], v[48:51]
    v_mfma_f32_16x16x32_bf16 v[64:67], v[244:247], v[80:83], v[64:67]
    v_mfma_f32_16x16x32_bf16 v[28:31], a[232:235], v[84:87], v[28:31]
    v_mfma_f32_16x16x32_bf16 v[44:47], v[184:187], v[84:87], v[44:47]
    v_mfma_f32_16x16x32_bf16 v[60:63], v[248:251], v[84:87], v[60:63]
    v_mfma_f32_16x16x32_bf16 v[32:35], a[232:235], v[88:91], v[32:35]
    s_barrier
    ds_read2_b32 v[136:137], v103 offset0:32 offset1:48
    v_mfma_f32_16x16x32_bf16 v[48:51], v[184:187], v[88:91], v[48:51]
    s_waitcnt vmcnt(0)
    v_mfma_f32_16x16x32_bf16 v[64:67], v[248:251], v[88:91], v[64:67]
    v_cmp_gt_u32 vcc, 1, v102
    s_cbranch_vccnz L_hr_36
L_hb_37:
    s_waitcnt lgkmcnt(1)
    v_mfma_f32_16x16x32_bf16 v[28:31], a[236:239], v[92:95], v[28:31]
    v_mfma_f32_16x16x32_bf16 v[44:47], v[188:191], v[92:95], v[44:47]
    s_add_u32 s86, s94, 0
    buffer_load_dwordx4 v[104:107], v143, s[32:35], s86 offen sc1
    v_mfma_f32_16x16x32_bf16 v[60:63], v[252:255], v[92:95], v[60:63]
    v_mfma_f32_16x16x32_bf16 v[32:35], a[236:239], v[96:99], v[32:35]
    v_mfma_f32_16x16x32_bf16 v[48:51], v[188:191], v[96:99], v[48:51]
    s_add_u32 s86, s94, 8192
    buffer_load_dwordx4 v[108:111], v143, s[32:35], s86 offen sc1
    v_mfma_f32_16x16x32_bf16 v[64:67], v[252:255], v[96:99], v[64:67]
    s_add_u32 s86, s95, 0
    buffer_load_dwordx4 v[112:115], v143, s[32:35], s86 offen sc1
    s_waitcnt lgkmcnt(0)
    v_pk_fma_f32 v[28:29], v[136:137], v[2:3], v[28:29] op_sel:[0,0,0] op_sel_hi:[0,1,1] neg_lo:[1,0,0] neg_hi:[1,0,0]
    v_pk_fma_f32 v[30:31], v[136:137], v[4:5], v[30:31] op_sel:[0,0,0] op_sel_hi:[0,1,1] neg_lo:[1,0,0] neg_hi:[1,0,0]
    v_cvt_pk_bf16_f32 v28, v28, v29
    v_cvt_pk_bf16_f32 v29, v30, v31
    v_pk_max_i16 v28, v28, 0
    v_pk_max_i16 v29, v29, 0
    v_pk_fma_f32 v[44:45], v[136:137], v[6:7], v[44:45] op_sel:[0,0,0] op_sel_hi:[0,1,1] neg_lo:[1,0,0] neg_hi:[1,0,0]
    v_pk_fma_f32 v[46:47], v[136:137], v[8:9], v[46:47] op_sel:[0,0,0] op_sel_hi:[0,1,1] neg_lo:[1,0,0] neg_hi:[1,0,0]
    s_add_u32 s86, s95, 8192
    buffer_load_dwordx4 v[116:119], v143, s[32:35], s86 offen sc1
    v_cvt_pk_bf16_f32 v30, v44, v45
    v_cvt_pk_bf16_f32 v31, v46, v47
    v_pk_max_i16 v30, v30, 0
    v_pk_max_i16 v31, v31, 0
    s_add_u32 s86, s100, 0
    buffer_load_dwordx4 v[120:123], v143, s[32:35], s86 offen sc1
    s_add_u32 s80, s12, 131072
    s_cmp_eq_u32 s53, 0
    s_cbranch_scc1 L_hs_59
    buffer_store_dwordx4 v[28:31], v143, s[32:35], s80 offen
L_he_60:
    v_pk_fma_f32 v[32:33], v[136:137], v[2:3], v[32:33] op_sel:[1,0,0] op_sel_hi:[1,1,1] neg_lo:[1,0,0] neg_hi:[1,0,0]
    v_pk_fma_f32 v[34:35], v[136:137], v[4:5], v[34:35] op_sel:[1,0,0] op_sel_hi:[1,1,1] neg_lo:[1,0,0] neg_hi:[1,0,0]
    v_cvt_pk_bf16_f32 v32, v32, v33
    s_add_u32 s86, s100, 8192
    buffer_load_dwordx4 v[124:127], v143, s[32:35], s86 offen sc1
    v_cvt_pk_bf16_f32 v33, v34, v35
    v_pk_max_i16 v32, v32, 0
    v_pk_max_i16 v33, v33, 0
    v_pk_fma_f32 v[48:49], v[136:137], v[6:7], v[48:49] op_sel:[1,0,0] op_sel_hi:[1,1,1] neg_lo:[1,0,0] neg_hi:[1,0,0]
    s_add_u32 s86, s4, 0
    buffer_load_dwordx4 v[128:131], v143, s[32:35], s86 offen sc1
    v_pk_fma_f32 v[50:51], v[136:137], v[8:9], v[50:51] op_sel:[1,0,0] op_sel_hi:[1,1,1] neg_lo:[1,0,0] neg_hi:[1,0,0]
    v_cvt_pk_bf16_f32 v34, v48, v49
    v_cvt_pk_bf16_f32 v35, v50, v51
    v_pk_max_i16 v34, v34, 0
    s_add_u32 s86, s4, 8192
    buffer_load_dwordx4 v[132:135], v143, s[32:35], s86 offen sc1
    v_pk_max_i16 v35, v35, 0
    s_add_u32 s80, s12, 196608
    s_cmp_eq_u32 s53, 0
    s_cbranch_scc1 L_hs_61
    buffer_store_dwordx4 v[32:35], v143, s[32:35], s80 offen
L_he_62:
    v_pk_fma_f32 v[60:61], v[136:137], v[10:11], v[60:61] op_sel:[0,0,0] op_sel_hi:[0,1,1] neg_lo:[1,0,0] neg_hi:[1,0,0]
    v_pk_fma_f32 v[62:63], v[136:137], v[12:13], v[62:63] op_sel:[0,0,0] op_sel_hi:[0,1,1] neg_lo:[1,0,0] neg_hi:[1,0,0]
    v_cvt_pk_bf16_f32 v60, v60, v61
    v_cvt_pk_bf16_f32 v61, v62, v63
    v_pk_max_i16 v60, v60, 0
    v_pk_max_i16 v61, v61, 0
    v_pk_fma_f32 v[64:65], v[136:137], v[10:11], v[64:65] op_sel:[1,0,0] op_sel_hi:[1,1,1] neg_lo:[1,0,0] neg_hi:[1,0,0]
    v_pk_fma_f32 v[66:67], v[136:137], v[12:13], v[66:67] op_sel:[1,0,0] op_sel_hi:[1,1,1] neg_lo:[1,0,0] neg_hi:[1,0,0]
    v_cvt_pk_bf16_f32 v62, v64, v65
    v_cvt_pk_bf16_f32 v63, v66, v67
    v_pk_max_i16 v62, v62, 0
    v_pk_max_i16 v63, v63, 0
    s_cmp_eq_u32 s14, 0
    s_cbranch_scc1 L_nosw_58
    v_swap_b32 v60, v62
    v_swap_b32 v61, v63
L_nosw_58:
    s_add_u32 s80, s13, 49152
    s_cmp_eq_u32 s53, 0
    s_cbranch_scc1 L_hs_63
    buffer_store_dwordx4 v[60:63], v143, s[32:35], s80 offen
L_he_64:
    s_branch L_g1j_28
L_g1w3_27:
    ds_read_b64_tr_b16 v[68:69], v14 offset:0
    ds_read_b64_tr_b16 v[70:71], v14 offset:1024
    ds_read_b64_tr_b16 v[72:73], v15 offset:0
    ds_read_b64_tr_b16 v[74:75], v15 offset:1024
    ds_read_b64_tr_b16 v[76:77], v14 offset:2048
    ds_read_b64_tr_b16 v[78:79], v14 offset:3072
    s_waitcnt lgkmcnt(4)
    v_mfma_f32_16x16x32_bf16 v[20:23], a[176:179], v[68:71], 0
    ds_read_b64_tr_b16 v[80:81], v15 offset:2048
    buffer_load_dword v132, v133, s[32:35], s31 offen sc1
    v_mfma_f32_16x16x32_bf16 v[36:39], a[240:243], v[68:71], 0
    ds_read_b64_tr_b16 v[82:83], v15 offset:3072
    s_add_u32 m0, s64, 4096
    v_mfma_f32_16x16x32_bf16 v[52:55], v[68:71], v[68:71], 0
    ds_read_b64_tr_b16 v[84:85], v14 offset:4096
    s_waitcnt lgkmcnt(5)
    v_mfma_f32_16x16x32_bf16 v[24:27], a[176:179], v[72:75], 0
    ds_read_b64_tr_b16 v[86:87], v14 offset:5120
    s_add_u32 s58, s88, 49152
    v_mfma_f32_16x16x32_bf16 v[40:43], a[240:243], v[72:75], 0
    ds_read_b64_tr_b16 v[88:89], v15 offset:4096
    buffer_load_dwordx4 v142, s[40:43], s58 offen offset:0 lds
    v_mfma_f32_16x16x32_bf16 v[56:59], v[72:75], v[72:75], 0
    ds_read_b64_tr_b16 v[90:91], v15 offset:5120
    s_waitcnt lgkmcnt(6)
    v_mfma_f32_16x16x32_bf16 v[20:23], a[180:183], v[76:79], v[20:23]
    ds_read_b64_tr_b16 v[92:93], v14 offset:6144
    s_add_u32 s58, s88, 56320
    v_mfma_f32_16x16x32_bf16 v[36:39], a[244:247], v[76:79], v[36:39]
    ds_read_b64_tr_b16 v[94:95], v14 offset:7168
    buffer_load_dwordx4 v142, s[40:43], s58 offen offset:1024 lds
    v_mfma_f32_16x16x32_bf16 v[52:55], v[76:79], v[76:79], v[52:55]
    ds_read_b64_tr_b16 v[96:97], v15 offset:6144
    s_waitcnt lgkmcnt(7)
    v_mfma_f32_16x16x32_bf16 v[24:27], a[180:183], v[80:83], v[24:27]
    ds_read_b64_tr_b16 v[98:99], v15 offset:7168
    s_add_u32 s58, s88, 63488
    v_mfma_f32_16x16x32_bf16 v[40:43], a[244:247], v[80:83], v[40:43]
    ds_read_b64_tr_b16 v[68:69], v14 offset:8192
    buffer_load_dwordx4 v142, s[40:43], s58 offen offset:2048 lds
    v_mfma_f32_16x16x32_bf16 v[56:59], v[80:83], v[80:83], v[56:59]
    ds_read_b64_tr_b16 v[70:71], v14 offset:9216
    s_waitcnt lgkmcnt(8)
    v_mfma_f32_16x16x32_bf16 v[20:23], a[184:187], v[84:87], v[20:23]
    ds_read_b64_tr_b16 v[72:73], v15 offset:8192
    s_add_u32 s58, s88, 70656
    v_mfma_f32_16x16x32_bf16 v[36:39], a[248:251], v[84:87], v[36:39]
    ds_read_b64_tr_b16 v[74:75], v15 offset:9216
    buffer_load_dwordx4 v142, s[40:43], s58 offen offset:3072 lds
    v_mfma_f32_16x16x32_bf16 v[52:55], v[84:87], v[84:87], v[52:55]
    ds_read_b64_tr_b16 v[76:77], v14 offset:10240
    s_waitcnt lgkmcnt(9)
    v_mfma_f32_16x16x32_bf16 v[24:27], a[184:187], v[88:91], v[24:27]
    ds_read_b64_tr_b16 v[78:79], v14 offset:11264
    s_add_u32 m0, s64, 8192
    v_mfma_f32_16x16x32_bf16 v[40:43], a[248:251], v[88:91], v[40:43]
    ds_read_b64_tr_b16 v[80:81], v15 offset:10240
    s_add_u32 s58, s98, 0
    v_mfma_f32_16x16x32_bf16 v[56:59], v[88:91], v[88:91], v[56:59]
    ds_read_b64_tr_b16 v[82:83], v15 offset:11264
    s_waitcnt lgkmcnt(9)
    v_mfma_f32_16x16x32_bf16 v[20:23], a[188:191], v[92:95], v[20:23]
    ds_read_b64_tr_b16 v[84:85], v14 offset:12288
    buffer_load_dwordx4 v142, s[40:43], s58 offen offset:0 lds
    v_mfma_f32_16x16x32_bf16 v[36:39], a[252:255], v[92:95], v[36:39]
    ds_read_b64_tr_b16 v[86:87], v14 offset:13312
    s_add_u32 s58, s98, 7168
    v_mfma_f32_16x16x32_bf16 v[52:55], v[92:95], v[92:95], v[52:55]
    ds_read_b64_tr_b16 v[88:89], v15 offset:12288
    s_waitcnt lgkmcnt(9)
    v_mfma_f32_16x16x32_bf16 v[24:27], a[188:191], v[96:99], v[24:27]
    ds_read_b64_tr_b16 v[90:91], v15 offset:13312
    buffer_load_dwordx4 v142, s[40:43], s58 offen offset:1024 lds
    v_mfma_f32_16x16x32_bf16 v[40:43], a[252:255], v[96:99], v[40:43]
    s_waitcnt vmcnt(12)
    ds_read2st64_b32 v[104:105], v101 offset0:64 offset1:68
    v_mfma_f32_16x16x32_bf16 v[56:59], v[96:99], v[96:99], v[56:59]
    ds_read_b64_tr_b16 v[92:93], v14 offset:14336
    s_add_u32 s58, s98, 14336
    v_mfma_f32_16x16x32_bf16 v[20:23], a[192:195], v[68:71], v[20:23]
    ds_read_b64_tr_b16 v[94:95], v14 offset:15360
    buffer_load_dwordx4 v142, s[40:43], s58 offen offset:2048 lds
    v_mfma_f32_16x16x32_bf16 v[36:39], v[144:147], v[68:71], v[36:39]
    ds_read2st64_b32 v[106:107], v101 offset0:72 offset1:76
    s_add_u32 s58, s98, 21504
    v_mfma_f32_16x16x32_bf16 v[52:55], v[68:71], v[68:71], v[52:55]
    ds_read_b64_tr_b16 v[96:97], v15 offset:14336
    s_waitcnt lgkmcnt(9)
    v_mfma_f32_16x16x32_bf16 v[24:27], a[192:195], v[72:75], v[24:27]
    ds_read_b64_tr_b16 v[98:99], v15 offset:15360
    buffer_load_dwordx4 v142, s[40:43], s58 offen offset:3072 lds
    v_mfma_f32_16x16x32_bf16 v[40:43], v[144:147], v[72:75], v[40:43]
    s_add_u32 m0, s64, 12288
    s_add_u32 s58, s98, 49152
    v_mfma_f32_16x16x32_bf16 v[56:59], v[72:75], v[72:75], v[56:59]
    buffer_load_dwordx4 v142, s[40:43], s58 offen offset:0 lds
    s_waitcnt lgkmcnt(2)
    v_mfma_f32_16x16x32_bf16 v[20:23], a[196:199], v[76:79], v[20:23]
    v_or3_b32 v104, v104, v105, -2
    v_or3_b32 v102, v104, v106, v107
    v_mfma_f32_16x16x32_bf16 v[36:39], v[148:151], v[76:79], v[36:39]
    s_add_u32 s58, s98, 56320
    buffer_load_dwordx4 v142, s[40:43], s58 offen offset:1024 lds
    v_mfma_f32_16x16x32_bf16 v[52:55], v[76:79], v[76:79], v[52:55]
    v_cmp_eq_u32 vcc, -1, v102
    s_cbranch_vccnz L_re_65
L_bk_66:
    s_barrier
    v_mfma_f32_16x16x32_bf16 v[24:27], a[196:199], v[80:83], v[24:27]
    ds_read_b64_tr_b16 v[68:69], v14 offset:16384
    v_xad_u32 v138, v16, 0, s64
    v_mfma_f32_16x16x32_bf16 v[40:43], v[148:151], v[80:83], v[40:43]
    ds_read_b64_tr_b16 v[70:71], v14 offset:17408
    v_xad_u32 v139, v17, 0, s64
    v_mfma_f32_16x16x32_bf16 v[56:59], v[80:83], v[80:83], v[56:59]
    ds_read_b64_tr_b16 v[72:73], v15 offset:16384
    s_add_u32 s58, s98, 63488
    v_mfma_f32_16x16x32_bf16 v[20:23], a[200:203], v[84:87], v[20:23]
    ds_read_b64_tr_b16 v[74:75], v15 offset:17408
    buffer_load_dwordx4 v142, s[40:43], s58 offen offset:2048 lds
    v_mfma_f32_16x16x32_bf16 v[36:39], v[152:155], v[84:87], v[36:39]
    ds_read_b64_tr_b16 v[76:77], v14 offset:18432
    v_xad_u32 v140, v16, 64, s64
    v_mfma_f32_16x16x32_bf16 v[52:55], v[84:87], v[84:87], v[52:55]
    ds_read_b64_tr_b16 v[78:79], v14 offset:19456
    v_xad_u32 v141, v17, 64, s64
    v_mfma_f32_16x16x32_bf16 v[24:27], a[200:203], v[88:91], v[24:27]
    ds_read_b64_tr_b16 v[80:81], v15 offset:18432
    s_waitcnt vmcnt(12)
    v_mfma_f32_16x16x32_bf16 v[40:43], v[152:155], v[88:91], v[40:43]
    ds_read_b64_tr_b16 v[82:83], v15 offset:19456
    s_add_u32 s58, s98, 70656
    v_mfma_f32_16x16x32_bf16 v[56:59], v[88:91], v[88:91], v[56:59]
    buffer_load_dwordx4 v142, s[40:43], s58 offen offset:3072 lds
    ds_read_b64_tr_b16 v[84:85], v14 offset:20480
    v_mfma_f32_16x16x32_bf16 v[20:23], a[204:207], v[92:95], v[20:23]
    ds_read_b64_tr_b16 a[32:33], v138 offset:0
    v_mfma_f32_16x16x32_bf16 v[36:39], v[156:159], v[92:95], v[36:39]
    ds_read_b64_tr_b16 a[34:35], v138 offset:2048
    v_mfma_f32_16x16x32_bf16 v[52:55], v[92:95], v[92:95], v[52:55]
    ds_read_b64_tr_b16 a[36:37], v139 offset:0
    s_waitcnt lgkmcnt(9)
    v_mfma_f32_16x16x32_bf16 v[24:27], a[204:207], v[96:99], v[24:27]
    ds_read_b64_tr_b16 a[38:39], v139 offset:2048
    v_mfma_f32_16x16x32_bf16 v[40:43], v[156:159], v[96:99], v[40:43]
    ds_read_b64_tr_b16 a[40:41], v140 offset:0
    v_mfma_f32_16x16x32_bf16 v[56:59], v[96:99], v[96:99], v[56:59]
    s_add_u32 m0, s20, 32768
    s_add_u32 s76, s15, 2048
    buffer_load_dwordx4 v100, s[32:35], s76 offen offset:0 sc1 lds
    v_mfma_f32_16x16x32_bf16 v[20:23], a[208:211], v[68:71], v[20:23]
    ds_read_b64_tr_b16 a[42:43], v140 offset:2048
    v_mfma_f32_16x16x32_bf16 v[36:39], v[160:163], v[68:71], v[36:39]
    ds_read_b64_tr_b16 a[44:45], v141 offset:0
    v_mfma_f32_16x16x32_bf16 v[52:55], v[68:71], v[68:71], v[52:55]
    ds_read_b64_tr_b16 v[86:87], v14 offset:21504
    s_waitcnt lgkmcnt(8)
    v_mfma_f32_16x16x32_bf16 v[24:27], a[208:211], v[72:75], v[24:27]
    ds_read_b64_tr_b16 a[46:47], v141 offset:2048
    v_mfma_f32_16x16x32_bf16 v[40:43], v[160:163], v[72:75], v[40:43]
    s_add_u32 s76, s15, 66560
    buffer_load_dwordx4 v100, s[32:35], s76 offen offset:1024 sc1 lds
    v_mfma_f32_16x16x32_bf16 v[56:59], v[72:75], v[72:75], v[56:59]
    ds_read_b64_tr_b16 v[88:89], v15 offset:20480
    s_waitcnt vmcnt(10)
    v_mfma_f32_16x16x32_bf16 v[20:23], a[212:215], v[76:79], v[20:23]
    ds_read_b64_tr_b16 v[90:91], v15 offset:21504
    ds_read_b64_tr_b16 a[48:49], v138 offset:4096
    v_mfma_f32_16x16x32_bf16 v[36:39], v[164:167], v[76:79], v[36:39]
    ds_read_b64_tr_b16 a[50:51], v138 offset:6144
    v_mfma_f32_16x16x32_bf16 v[52:55], v[76:79], v[76:79], v[52:55]
    ds_read_b64_tr_b16 v[92:93], v14 offset:22528
    s_add_u32 s76, s15, 131072
    buffer_load_dwordx4 v100, s[32:35], s76 offen offset:2048 sc1 lds
    v_mfma_f32_16x16x32_bf16 v[24:27], a[212:215], v[80:83], v[24:27]
    ds_read_b64_tr_b16 v[94:95], v14 offset:23552
    ds_read_b64_tr_b16 a[52:53], v139 offset:4096
    v_mfma_f32_16x16x32_bf16 v[40:43], v[164:167], v[80:83], v[40:43]
    ds_read_b64_tr_b16 a[54:55], v139 offset:6144
    v_mfma_f32_16x16x32_bf16 v[56:59], v[80:83], v[80:83], v[56:59]
    ds_read_b64_tr_b16 v[96:97], v15 offset:22528
    s_waitcnt lgkmcnt(10)
    v_mfma_f32_16x16x32_bf16 v[20:23], a[216:219], v[84:87], v[20:23]
    ds_read_b64_tr_b16 v[98:99], v15 offset:23552
    ds_read_b64_tr_b16 a[56:57], v140 offset:4096
    v_mfma_f32_16x16x32_bf16 v[36:39], v[168:171], v[84:87], v[36:39]
    s_add_u32 s76, s15, 195584
    buffer_load_dwordx4 v100, s[32:35], s76 offen offset:3072 sc1 lds
    v_mfma_f32_16x16x32_bf16 v[52:55], v[84:87], v[84:87], v[52:55]
    ds_read_b64_tr_b16 v[68:69], v14 offset:24576
    s_waitcnt lgkmcnt(10)
    v_mfma_f32_16x16x32_bf16 v[24:27], a[216:219], v[88:91], v[24:27]
    ds_read_b64_tr_b16 v[70:71], v14 offset:25600
    ds_read_b64_tr_b16 a[58:59], v140 offset:6144
    v_mfma_f32_16x16x32_bf16 v[40:43], v[168:171], v[88:91], v[40:43]
    ds_read_b64_tr_b16 a[60:61], v141 offset:4096
    v_mfma_f32_16x16x32_bf16 v[56:59], v[88:91], v[88:91], v[56:59]
    ds_read_b64_tr_b16 v[72:73], v15 offset:24576
    s_waitcnt lgkmcnt(10)
    v_mfma_f32_16x16x32_bf16 v[20:23], a[220:223], v[92:95], v[20:23]
    ds_read_b64_tr_b16 v[74:75], v15 offset:25600
    ds_read_b64_tr_b16 a[62:63], v141 offset:6144
    v_mfma_f32_16x16x32_bf16 v[36:39], v[172:175], v[92:95], v[36:39]
    s_add_u32 m0, s20, 49152
    s_add_u32 s76, s52, 2048
    buffer_load_dwordx4 v100, s[32:35], s76 offen offset:0 sc1 lds
    v_mfma_f32_16x16x32_bf16 v[52:55], v[92:95], v[92:95], v[52:55]
    ds_read_b64_tr_b16 v[76:77], v14 offset:26624
    s_waitcnt lgkmcnt(9)
    v_mfma_f32_16x16x32_bf16 v[24:27], a[220:223], v[96:99], v[24:27]
    ds_read_b64_tr_b16 v[78:79], v14 offset:27648
    s_waitcnt vmcnt(9)
    v_mfma_f32_16x16x32_bf16 v[40:43], v[172:175], v[96:99], v[40:43]
    ds_read_b64_tr_b16 a[64:65], v138 offset:8192
    v_mfma_f32_16x16x32_bf16 v[56:59], v[96:99], v[96:99], v[56:59]
    ds_read_b64_tr_b16 v[80:81], v15 offset:26624
    s_waitcnt lgkmcnt(9)
    v_mfma_f32_16x16x32_bf16 v[20:23], a[224:227], v[68:71], v[20:23]
    ds_read_b64_tr_b16 v[82:83], v15 offset:27648
    ds_read_b64_tr_b16 a[66:67], v138 offset:10240
    s_add_u32 s76, s52, 66560
    buffer_load_dwordx4 v100, s[32:35], s76 offen offset:1024 sc1 lds
    ds_read_b64_tr_b16 a[68:69], v139 offset:8192
    ds_read_b64_tr_b16 a[70:71], v139 offset:10240
    ds_read_b64_tr_b16 a[72:73], v140 offset:8192
    s_add_u32 s76, s52, 131072
    buffer_load_dwordx4 v100, s[32:35], s76 offen offset:2048 sc1 lds
    ds_read_b64_tr_b16 a[74:75], v140 offset:10240
    ds_read_b64_tr_b16 a[76:77], v141 offset:8192
    ds_read_b64_tr_b16 a[78:79], v141 offset:10240
    s_add_u32 s76, s52, 195584
    buffer_load_dwordx4 v100, s[32:35], s76 offen offset:3072 sc1 lds
    s_waitcnt vmcnt(8)
    ds_read_b64_tr_b16 a[80:81], v138 offset:12288
    ds_read_b64_tr_b16 a[82:83], v138 offset:14336
    ds_read_b64_tr_b16 a[84:85], v139 offset:12288
    ds_read_b64_tr_b16 a[86:87], v139 offset:14336
    ds_read_b64_tr_b16 a[88:89], v140 offset:12288
    ds_read_b64_tr_b16 a[90:91], v140 offset:14336
    ds_read_b64_tr_b16 a[92:93], v141 offset:12288
L_stub_4:
    s_cbranch_execz L_stub_8
    s_nop 0
    ds_read_b64_tr_b16 a[94:95], v141 offset:14336
    s_waitcnt lgkmcnt(0)
    v_mfma_f32_16x16x32_bf16 v[36:39], v[176:179], v[68:71], v[36:39]
    ds_read_b64_tr_b16 v[84:85], v14 offset:28672
    s_add_u32 m0, s64, 0
    v_mfma_f32_16x16x32_bf16 v[52:55], v[68:71], v[68:71], v[52:55]
    ds_read_b64_tr_b16 v[86:87], v14 offset:29696
    s_add_u32 s58, s99, 0
    v_mfma_f32_16x16x32_bf16 v[24:27], a[224:227], v[72:75], v[24:27]
    ds_read_b64_tr_b16 v[88:89], v15 offset:28672
    buffer_load_dwordx4 v142, s[40:43], s58 offen offset:0 lds
    v_mfma_f32_16x16x32_bf16 v[40:43], v[176:179], v[72:75], v[40:43]
    ds_read_b64_tr_b16 v[90:91], v15 offset:29696
    v_mfma_f32_16x16x32_bf16 v[56:59], v[72:75], v[72:75], v[56:59]
    ds_read_b64_tr_b16 v[92:93], v14 offset:30720
    v_mfma_f32_16x16x32_bf16 v[20:23], a[228:231], v[76:79], v[20:23]
    ds_read_b64_tr_b16 v[94:95], v14 offset:31744
    s_add_u32 s58, s99, 7168
    v_mfma_f32_16x16x32_bf16 v[36:39], v[180:183], v[76:79], v[36:39]
    ds_read_b64_tr_b16 v[96:97], v15 offset:30720
    buffer_load_dwordx4 v142, s[40:43], s58 offen offset:1024 lds
    v_mfma_f32_16x16x32_bf16 v[52:55], v[76:79], v[76:79], v[52:55]
    ds_read_b64_tr_b16 v[98:99], v15 offset:31744
    s_waitcnt vmcnt(6)
    v_mfma_f32_16x16x32_bf16 v[24:27], a[228:231], v[80:83], v[24:27]
    ds_read2st64_b32 v[104:105], v101 offset0:128 offset1:132
    v_mfma_f32_16x16x32_bf16 v[40:43], v[180:183], v[80:83], v[40:43]
    ds_read2st64_b32 v[106:107], v101 offset0:136 offset1:140
    v_mfma_f32_16x16x32_bf16 v[56:59], v[80:83], v[80:83], v[56:59]
    s_add_u32 s58, s99, 14336
    s_waitcnt lgkmcnt(8)
    v_mfma_f32_16x16x32_bf16 v[20:23], a[232:235], v[84:87], v[20:23]
    buffer_load_dwordx4 v142, s[40:43], s58 offen offset:2048 lds
    v_mfma_f32_16x16x32_bf16 v[36:39], v[184:187], v[84:87], v[36:39]
    v_mfma_f32_16x16x32_bf16 v[52:55], v[84:87], v[84:87], v[52:55]
    s_waitcnt lgkmcnt(5)
    v_mfma_f32_16x16x32_bf16 v[24:27], a[232:235], v[88:91], v[24:27]
    s_waitcnt lgkmcnt(0)
    v_mfma_f32_16x16x32_bf16 v[40:43], v[184:187], v[88:91], v[40:43]
    v_or3_b32 v104, v104, v105, -2
    v_or3_b32 v102, v104, v106, v107
    v_mfma_f32_16x16x32_bf16 v[56:59], v[88:91], v[88:91], v[56:59]
    s_add_u32 s58, s99, 21504
    buffer_load_dwordx4 v142, s[40:43], s58 offen offset:3072 lds
    v_mfma_f32_16x16x32_bf16 v[20:23], a[236:239], v[92:95], v[20:23]
    v_cmp_eq_u32 vcc, -1, v102
    s_cbranch_vccnz L_re_67
L_bk_68:
    s_barrier
    v_mfma_f32_16x16x32_bf16 v[36:39], v[188:191], v[92:95], v[36:39]
    ds_read_b64_tr_b16 v[68:69], v14 offset:32768
    v_mfma_f32_16x16x32_bf16 v[52:55], v[92:95], v[92:95], v[52:55]
    ds_read_b64_tr_b16 v[70:71], v14 offset:33792
    v_mfma_f32_16x16x32_bf16 v[24:27], a[236:239], v[96:99], v[24:27]
    ds_read_b64_tr_b16 v[72:73], v15 offset:32768
    s_add_u32 m0, s64, 4096
    v_mfma_f32_16x16x32_bf16 v[40:43], v[188:191], v[96:99], v[40:43]
    ds_read_b64_tr_b16 v[74:75], v15 offset:33792
    s_add_u32 s58, s99, 49152
    v_mfma_f32_16x16x32_bf16 v[56:59], v[96:99], v[96:99], v[56:59]
    ds_read_b64_tr_b16 v[76:77], v14 offset:34816
    s_waitcnt lgkmcnt(3)
    v_mfma_f32_16x16x32_bf16 v[28:31], a[176:179], v[68:71], 0
    ds_read_b64_tr_b16 v[78:79], v14 offset:35840
    buffer_load_dwordx4 v142, s[40:43], s58 offen offset:0 lds
    v_mfma_f32_16x16x32_bf16 v[44:47], a[240:243], v[68:71], 0
    s_mov_b32 exec_lo, 0
    s_mov_b32 exec_hi, 0xffff0000
    ds_write_b32 v103, v36 offset:0
    ds_write_b32 v103, v40 offset:64
    v_mov_b64 v[36:37], 0
    v_mov_b64 v[38:39], 0
    v_mov_b64 v[40:41], 0
    v_mov_b64 v[42:43], 0
    v_mov_b64 v[6:7], 0
    v_mov_b64 v[8:9], 0
    s_mov_b64 exec, -1
    v_mfma_f32_16x16x32_bf16 v[60:63], v[68:71], v[68:71], 0
    ds_read_b64_tr_b16 v[80:81], v15 offset:34816
    s_waitcnt lgkmcnt(5)
    v_mfma_f32_16x16x32_bf16 v[32:35], a[176:179], v[72:75], 0
    ds_read_b64_tr_b16 v[82:83], v15 offset:35840
    s_add_u32 s58, s99, 56320
    v_mfma_f32_16x16x32_bf16 v[48:51], a[240:243], v[72:75], 0
    ds_read_b64_tr_b16 v[84:85], v14 offset:36864
    buffer_load_dwordx4 v142, s[40:43], s58 offen offset:1024 lds
    v_mfma_f32_16x16x32_bf16 v[64:67], v[72:75], v[72:75], 0
    ds_read_b64_tr_b16 v[86:87], v14 offset:37888
    s_waitcnt lgkmcnt(6)
    v_mfma_f32_16x16x32_bf16 v[28:31], a[180:183], v[76:79], v[28:31]
    s_waitcnt lgkmcnt(4)
    s_barrier
    v_mfma_f32_16x16x32_bf16 v[44:47], a[244:247], v[76:79], v[44:47]
    ds_read_b64_tr_b16 v[88:89], v15 offset:36864
    ds_read2_b32 v[136:137], v103 offset0:0 offset1:16
    v_mfma_f32_16x16x32_bf16 v[60:63], v[76:79], v[76:79], v[60:63]
    ds_read_b64_tr_b16 v[90:91], v15 offset:37888
    s_waitcnt lgkmcnt(5)
    v_mfma_f32_16x16x32_bf16 v[32:35], a[180:183], v[80:83], v[32:35]
    ds_read_b64_tr_b16 v[92:93], v14 offset:38912
    s_add_u32 s58, s99, 63488
    v_mfma_f32_16x16x32_bf16 v[48:51], a[244:247], v[80:83], v[48:51]
    ds_read_b64_tr_b16 v[94:95], v14 offset:39936
    buffer_load_dwordx4 v142, s[40:43], s58 offen offset:2048 lds
    v_mfma_f32_16x16x32_bf16 v[64:67], v[80:83], v[80:83], v[64:67]
    ds_read_b64_tr_b16 v[96:97], v15 offset:38912
    s_waitcnt lgkmcnt(6)
    v_mfma_f32_16x16x32_bf16 v[28:31], a[184:187], v[84:87], v[28:31]
    ds_read_b64_tr_b16 v[98:99], v15 offset:39936
    s_waitcnt lgkmcnt(5)
    v_mfma_f32_16x16x32_bf16 v[44:47], a[248:251], v[84:87], v[44:47]
    ds_read_b64_tr_b16 v[68:69], v14 offset:40960
    v_fma_f32 v20, -v136, v2, v20
    v_mfma_f32_16x16x32_bf16 v[60:63], v[84:87], v[84:87], v[60:63]
    ds_read_b64_tr_b16 v[70:71], v14 offset:41984
    s_waitcnt lgkmcnt(6)
    v_mfma_f32_16x16x32_bf16 v[32:35], a[184:187], v[88:91], v[32:35]
    ds_read_b64_tr_b16 v[72:73], v15 offset:40960
    v_fma_f32 v21, -v136, v3, v21
    v_mfma_f32_16x16x32_bf16 v[48:51], a[248:251], v[88:91], v[48:51]
    ds_read_b64_tr_b16 v[74:75], v15 offset:41984
    v_fma_f32 v22, -v136, v4, v22
    v_mfma_f32_16x16x32_bf16 v[64:67], v[88:91], v[88:91], v[64:67]
    ds_read_b64_tr_b16 v[76:77], v14 offset:43008
    s_waitcnt lgkmcnt(7)
    v_mfma_f32_16x16x32_bf16 v[28:31], a[188:191], v[92:95], v[28:31]
    v_fma_f32 v23, -v136, v5, v23
    v_cvt_pk_bf16_f32 v20, v20, v21
    v_mfma_f32_16x16x32_bf16 v[44:47], a[252:255], v[92:95], v[44:47]
    v_cvt_pk_bf16_f32 v21, v22, v23
    v_pk_max_i16 v20, v20, 0
    v_mfma_f32_16x16x32_bf16 v[60:63], v[92:95], v[92:95], v[60:63]
    ds_read_b64_tr_b16 v[78:79], v14 offset:44032
    s_waitcnt lgkmcnt(6)
    v_mfma_f32_16x16x32_bf16 v[32:35], a[188:191], v[96:99], v[32:35]
    s_add_u32 s58, s99, 70656
    buffer_load_dwordx4 v142, s[40:43], s58 offen offset:3072 lds
    v_mfma_f32_16x16x32_bf16 v[48:51], a[252:255], v[96:99], v[48:51]
    v_pk_max_i16 v21, v21, 0
    v_fma_f32 v36, -v136, v6, v36
    v_mfma_f32_16x16x32_bf16 v[64:67], v[96:99], v[96:99], v[64:67]
    ds_read_b64_tr_b16 v[80:81], v15 offset:43008
    s_waitcnt lgkmcnt(5)
    v_mfma_f32_16x16x32_bf16 v[28:31], a[192:195], v[68:71], v[28:31]
    ds_read_b64_tr_b16 v[82:83], v15 offset:44032
    v_fma_f32 v37, -v136, v7, v37
    v_mfma_f32_16x16x32_bf16 v[44:47], v[144:147], v[68:71], v[44:47]
    v_fma_f32 v38, -v136, v8, v38
    v_fma_f32 v39, -v136, v9, v39
    v_mfma_f32_16x16x32_bf16 v[60:63], v[68:71], v[68:71], v[60:63]
    ds_read_b64_tr_b16 v[84:85], v14 offset:45056
    s_waitcnt lgkmcnt(4)
    v_mfma_f32_16x16x32_bf16 v[32:35], a[192:195], v[72:75], v[32:35]
    ds_read_b64_tr_b16 v[86:87], v14 offset:46080
    v_cvt_pk_bf16_f32 v22, v36, v37
    v_mfma_f32_16x16x32_bf16 v[48:51], v[144:147], v[72:75], v[48:51]
    v_cvt_pk_bf16_f32 v23, v38, v39
    v_pk_max_i16 v22, v22, 0
    v_mfma_f32_16x16x32_bf16 v[64:67], v[72:75], v[72:75], v[64:67]
    ds_read_b64_tr_b16 v[88:89], v15 offset:45056
    s_waitcnt lgkmcnt(5)
    v_mfma_f32_16x16x32_bf16 v[28:31], a[196:199], v[76:79], v[28:31]
    ds_read_b64_tr_b16 v[90:91], v15 offset:46080
    v_pk_max_i16 v23, v23, 0
    v_mfma_f32_16x16x32_bf16 v[44:47], v[148:151], v[76:79], v[44:47]
    s_add_u32 s80, s12, 0
    s_cmp_eq_u32 s53, 0
    s_cbranch_scc1 L_hs_79
    buffer_store_dwordx4 v[20:23], v143, s[32:35], s80 offen
L_he_80:
    v_mfma_f32_16x16x32_bf16 v[60:63], v[76:79], v[76:79], v[60:63]
    ds_read_b64_tr_b16 v[92:93], v14 offset:47104
    s_waitcnt lgkmcnt(5)
    v_mfma_f32_16x16x32_bf16 v[32:35], a[196:199], v[80:83], v[32:35]
    ds_read_b64_tr_b16 v[94:95], v14 offset:48128
    v_fma_f32 v24, -v137, v2, v24
    v_mfma_f32_16x16x32_bf16 v[48:51], v[148:151], v[80:83], v[48:51]
    v_fma_f32 v25, -v137, v3, v25
    s_add_u32 m0, s64, 8192
    s_add_u32 s58, s66, 32768
    buffer_load_dwordx4 v142, s[40:43], s58 offen offset:0 lds
    v_mfma_f32_16x16x32_bf16 v[64:67], v[80:83], v[80:83], v[64:67]
    ds_read_b64_tr_b16 v[96:97], v15 offset:47104
    s_waitcnt lgkmcnt(5)
    v_mfma_f32_16x16x32_bf16 v[28:31], a[200:203], v[84:87], v[28:31]
    ds_read_b64_tr_b16 v[98:99], v15 offset:48128
    v_fma_f32 v26, -v137, v4, v26
    v_mfma_f32_16x16x32_bf16 v[44:47], v[152:155], v[84:87], v[44:47]
    v_fma_f32 v27, -v137, v5, v27
    v_cvt_pk_bf16_f32 v24, v24, v25
    v_mfma_f32_16x16x32_bf16 v[60:63], v[84:87], v[84:87], v[60:63]
    v_cvt_pk_bf16_f32 v25, v26, v27
    s_waitcnt lgkmcnt(4)
    v_mfma_f32_16x16x32_bf16 v[32:35], a[200:203], v[88:91], v[32:35]
    v_pk_max_i16 v24, v24, 0
    v_pk_max_i16 v25, v25, 0
    v_mfma_f32_16x16x32_bf16 v[48:51], v[152:155], v[88:91], v[48:51]
    v_fma_f32 v40, -v137, v6, v40
    v_fma_f32 v41, -v137, v7, v41
    v_mfma_f32_16x16x32_bf16 v[64:67], v[88:91], v[88:91], v[64:67]
    s_waitcnt vmcnt(10)
    ds_read2st64_b32 v[104:105], v101 offset0:192 offset1:196
    v_fma_f32 v42, -v137, v8, v42
    v_fma_f32 v43, -v137, v9, v43
    ds_read2st64_b32 v[106:107], v101 offset0:200 offset1:204
    v_cvt_pk_bf16_f32 v26, v40, v41
    v_cvt_pk_bf16_f32 v27, v42, v43
    v_pk_max_i16 v26, v26, 0
    s_add_u32 s58, s66, 39936
    buffer_load_dwordx4 v142, s[40:43], s58 offen offset:1024 lds
    v_pk_max_i16 v27, v27, 0
    s_add_u32 s80, s12, 65536
    s_cmp_eq_u32 s53, 0
    s_cbranch_scc1 L_hs_81
    buffer_store_dwordx4 v[24:27], v143, s[32:35], s80 offen
L_he_82:
    v_cndmask_b32 v52, v52, v53, s[24:25]
    v_cndmask_b32 v56, v56, v57, s[24:25]
    v_cndmask_b32 v52, v52, v54, s[68:69]
    v_cndmask_b32 v56, v56, v58, s[68:69]
    v_cndmask_b32 v52, v52, v55, s[70:71]
    v_cndmask_b32 v56, v56, v59, s[70:71]
    s_mov_b32 exec_lo, 0x00f0000f
    s_mov_b32 exec_hi, 0xf0000f00
    ds_write_b32 v103, v52 offset:256
    ds_write_b32 v103, v56 offset:320
    s_mov_b64 exec, -1
    s_waitcnt lgkmcnt(6)
    v_mfma_f32_16x16x32_bf16 v[28:31], a[204:207], v[92:95], v[28:31]
    s_add_u32 s58, s66, 79872
    buffer_load_dwordx4 v142, s[40:43], s58 offen offset:2048 lds
    v_mfma_f32_16x16x32_bf16 v[44:47], v[156:159], v[92:95], v[44:47]
    s_waitcnt lgkmcnt(2)
    v_or3_b32 v104, v104, v105, -2
    v_mfma_f32_16x16x32_bf16 v[60:63], v[92:95], v[92:95], v[60:63]
    v_or3_b32 v102, v104, v106, v107
    v_cmp_eq_u32 vcc, -1, v102
    s_cbranch_vccnz L_re_69
L_bk_70:
    s_barrier
    v_mfma_f32_16x16x32_bf16 v[32:35], a[204:207], v[96:99], v[32:35]
    ds_read_b64_tr_b16 v[20:21], v14 offset:49152
    s_add_u32 s58, s66, 87040
    buffer_load_dwordx4 v142, s[40:43], s58 offen offset:3072 lds
    v_mfma_f32_16x16x32_bf16 v[48:51], v[156:159], v[96:99], v[48:51]
    ds_read_b64_tr_b16 v[22:23], v14 offset:50176
    s_add_u32 m0, s64, 12288
    s_add_u32 s58, s66, 208896
    buffer_load_dwordx4 v142, s[40:43], s58 offen offset:0 lds
    v_mfma_f32_16x16x32_bf16 v[64:67], v[96:99], v[96:99], v[64:67]
    ds_read_b64_tr_b16 v[24:25], v15 offset:49152
    s_waitcnt lgkmcnt(1)
    v_mfma_f32_16x16x32_bf16 v[28:31], a[208:211], v[20:23], v[28:31]
    ds_read_b64_tr_b16 v[26:27], v15 offset:50176
    s_add_u32 s58, s66, 216064
    v_mfma_f32_16x16x32_bf16 v[44:47], v[160:163], v[20:23], v[44:47]
    ds_read_b64_tr_b16 v[36:37], v14 offset:51200
    buffer_load_dwordx4 v142, s[40:43], s58 offen offset:1024 lds
    v_mfma_f32_16x16x32_bf16 v[60:63], v[20:23], v[20:23], v[60:63]
    ds_read_b64_tr_b16 v[38:39], v14 offset:52224
    s_waitcnt lgkmcnt(2)
    v_mfma_f32_16x16x32_bf16 v[32:35], a[208:211], v[24:27], v[32:35]
    ds_read_b64_tr_b16 v[40:41], v15 offset:51200
    s_add_u32 s58, s66, 256000
    v_mfma_f32_16x16x32_bf16 v[48:51], v[160:163], v[24:27], v[48:51]
    ds_read_b64_tr_b16 v[42:43], v15 offset:52224
    buffer_load_dwordx4 v142, s[40:43], s58 offen offset:2048 lds
    v_mfma_f32_16x16x32_bf16 v[64:67], v[24:27], v[24:27], v[64:67]
    ds_read_b64_tr_b16 v[52:53], v14 offset:53248
    s_waitcnt lgkmcnt(3)
    v_mfma_f32_16x16x32_bf16 v[28:31], a[212:215], v[36:39], v[28:31]
    ds_read_b64_tr_b16 v[54:55], v14 offset:54272
    v_mov_b32 v102, 1
    v_mfma_f32_16x16x32_bf16 v[44:47], v[164:167], v[36:39], v[44:47]
    ds_read_b64_tr_b16 v[56:57], v15 offset:53248
    s_waitcnt vmcnt(5)
    v_mfma_f32_16x16x32_bf16 v[60:63], v[36:39], v[36:39], v[60:63]
    ds_read_b64_tr_b16 v[58:59], v15 offset:54272
    s_waitcnt lgkmcnt(4)
    v_mfma_f32_16x16x32_bf16 v[32:35], a[212:215], v[40:43], v[32:35]
    ds_read_b64_tr_b16 v[68:69], v14 offset:55296
    v_mfma_f32_16x16x32_bf16 v[48:51], v[164:167], v[40:43], v[48:51]
    ds_read_b64_tr_b16 v[70:71], v14 offset:56320
    s_mov_b32 exec_lo, 1
    s_mov_b32 exec_hi, 0
    s_cmp_eq_u32 s53, 0
    s_cbranch_scc1 L_hs_97
    buffer_store_dword v102, v143, s[32:35], s19 offen
L_he_98:
    s_mov_b64 exec, -1
    v_mfma_f32_16x16x32_bf16 v[64:67], v[40:43], v[40:43], v[64:67]
    ds_read_b64_tr_b16 v[72:73], v15 offset:55296
    s_waitcnt lgkmcnt(5)
    v_mfma_f32_16x16x32_bf16 v[28:31], a[216:219], v[52:55], v[28:31]
    ds_read_b64_tr_b16 v[74:75], v15 offset:56320
    s_add_u32 s58, s66, 263168
    buffer_load_dwordx4 v142, s[40:43], s58 offen offset:3072 lds
    v_mfma_f32_16x16x32_bf16 v[44:47], v[168:171], v[52:55], v[44:47]
    ds_read_b64_tr_b16 v[76:77], v14 offset:57344
    s_waitcnt lgkmcnt(5)
    v_mfma_f32_16x16x32_bf16 v[32:35], a[216:219], v[56:59], v[32:35]
    ds_read_b64_tr_b16 v[78:79], v14 offset:58368
    s_add_u32 m0, s63, 0
    v_mfma_f32_16x16x32_bf16 v[48:51], v[168:171], v[56:59], v[48:51]
    ds_read_b64_tr_b16 v[80:81], v15 offset:57344
    s_waitcnt lgkmcnt(5)
    v_mfma_f32_16x16x32_bf16 v[28:31], a[220:223], v[68:71], v[28:31]
    ds_read_b64_tr_b16 v[82:83], v15 offset:58368
    s_add_u32 s58, s66, 131072
    buffer_load_dwordx4 v142, s[40:43], s58 offen offset:0 lds
    v_mfma_f32_16x16x32_bf16 v[44:47], v[172:175], v[68:71], v[44:47]
    ds_read_b64_tr_b16 v[84:85], v14 offset:59392
    s_waitcnt lgkmcnt(5)
    v_mfma_f32_16x16x32_bf16 v[32:35], a[220:223], v[72:75], v[32:35]
    ds_read_b64_tr_b16 v[86:87], v14 offset:60416
    s_add_u32 s58, s66, 138240
    v_mfma_f32_16x16x32_bf16 v[48:51], v[172:175], v[72:75], v[48:51]
    ds_read_b64_tr_b16 v[88:89], v15 offset:59392
    s_waitcnt lgkmcnt(5)
    v_mfma_f32_16x16x32_bf16 v[28:31], a[224:227], v[76:79], v[28:31]
    ds_read_b64_tr_b16 v[90:91], v15 offset:60416
    buffer_load_dwordx4 v142, s[40:43], s58 offen offset:1024 lds
    v_mfma_f32_16x16x32_bf16 v[44:47], v[176:179], v[76:79], v[44:47]
    ds_read_b64_tr_b16 v[92:93], v14 offset:61440
    s_waitcnt lgkmcnt(5)
    v_mfma_f32_16x16x32_bf16 v[32:35], a[224:227], v[80:83], v[32:35]
    ds_read_b64_tr_b16 v[94:95], v14 offset:62464
    s_add_u32 s58, s66, 305152
    v_mfma_f32_16x16x32_bf16 v[48:51], v[176:179], v[80:83], v[48:51]
    ds_read_b64_tr_b16 v[96:97], v15 offset:61440
    s_waitcnt lgkmcnt(5)
    v_mfma_f32_16x16x32_bf16 v[28:31], a[228:231], v[84:87], v[28:31]
    ds_read_b64_tr_b16 v[98:99], v15 offset:62464
    buffer_load_dwordx4 v142, s[40:43], s58 offen offset:2048 lds
    v_mfma_f32_16x16x32_bf16 v[44:47], v[180:183], v[84:87], v[44:47]
    ds_read_b64_tr_b16 v[20:21], v14 offset:63488
    s_waitcnt lgkmcnt(5)
    v_mfma_f32_16x16x32_bf16 v[32:35], a[228:231], v[88:91], v[32:35]
    ds_read_b64_tr_b16 v[22:23], v14 offset:64512
    v_and_b32 v101, 7, v1
    v_mfma_f32_16x16x32_bf16 v[48:51], v[180:183], v[88:91], v[48:51]
    ds_read_b64_tr_b16 v[24:25], v15 offset:63488
    s_waitcnt lgkmcnt(5)
    v_mfma_f32_16x16x32_bf16 v[28:31], a[232:235], v[92:95], v[28:31]
    ds_read_b64_tr_b16 v[26:27], v15 offset:64512
    v_lshlrev_b32 v101, 2, v101
    v_mfma_f32_16x16x32_bf16 v[44:47], v[184:187], v[92:95], v[44:47]
    s_add_u32 s58, s66, 312320
    s_waitcnt lgkmcnt(4)
    v_mfma_f32_16x16x32_bf16 v[32:35], a[232:235], v[96:99], v[32:35]
    buffer_load_dwordx4 v142, s[40:43], s58 offen offset:3072 lds
    v_mfma_f32_16x16x32_bf16 v[48:51], v[184:187], v[96:99], v[48:51]
    buffer_load_dword v102, v101, s[32:35], s11 offen sc1
    s_waitcnt lgkmcnt(2)
    v_mfma_f32_16x16x32_bf16 v[28:31], a[236:239], v[20:23], v[28:31]
    v_mfma_f32_16x16x32_bf16 v[44:47], v[188:191], v[20:23], v[44:47]
    s_waitcnt lgkmcnt(0)
    v_mfma_f32_16x16x32_bf16 v[32:35], a[236:239], v[24:27], v[32:35]
    v_mfma_f32_16x16x32_bf16 v[48:51], v[188:191], v[24:27], v[48:51]
    v_mfma_f32_16x16x32_bf16 v[60:63], v[52:55], v[52:55], v[60:63]
    s_mov_b32 exec_lo, 0
    s_mov_b32 exec_hi, 0xffff0000
    s_nop 1
    ds_write_b32 v103, v44 offset:128
    s_nop 1
    ds_write_b32 v103, v48 offset:192
    v_mov_b64 v[44:45], 0
    v_mov_b64 v[46:47], 0
    v_mov_b64 v[48:49], 0
    v_mov_b64 v[50:51], 0
    s_mov_b64 exec, -1
    v_mfma_f32_16x16x32_bf16 v[64:67], v[56:59], v[56:59], v[64:67]
    v_mfma_f32_16x16x32_bf16 v[60:63], v[68:71], v[68:71], v[60:63]
    v_mfma_f32_16x16x32_bf16 v[64:67], v[72:75], v[72:75], v[64:67]
    s_waitcnt lgkmcnt(0)
    s_barrier
    v_mfma_f32_16x16x32_bf16 v[60:63], v[76:79], v[76:79], v[60:63]
    ds_read2_b32 v[136:137], v103 offset0:32 offset1:48
    s_waitcnt vmcnt(0)
    v_mfma_f32_16x16x32_bf16 v[64:67], v[80:83], v[80:83], v[64:67]
    v_cmp_gt_u32 vcc, 1, v102
    s_cbranch_vccnz L_hr_71
L_hb_72:
    v_mfma_f32_16x16x32_bf16 v[60:63], v[84:87], v[84:87], v[60:63]
    v_mfma_f32_16x16x32_bf16 v[64:67], v[88:91], v[88:91], v[64:67]
    s_add_u32 s86, s94, 0
    buffer_load_dwordx4 v[104:107], v143, s[32:35], s86 offen sc1
    v_mfma_f32_16x16x32_bf16 v[60:63], v[92:95], v[92:95], v[60:63]
    v_mfma_f32_16x16x32_bf16 v[64:67], v[96:99], v[96:99], v[64:67]
    v_mfma_f32_16x16x32_bf16 v[60:63], v[20:23], v[20:23], v[60:63]
    s_add_u32 s86, s94, 8192
    buffer_load_dwordx4 v[108:111], v143, s[32:35], s86 offen sc1
    v_mfma_f32_16x16x32_bf16 v[64:67], v[24:27], v[24:27], v[64:67]
    s_add_u32 s86, s95, 0
    buffer_load_dwordx4 v[112:115], v143, s[32:35], s86 offen sc1
    s_waitcnt lgkmcnt(0)
    v_pk_fma_f32 v[28:29], v[136:137], v[2:3], v[28:29] op_sel:[0,0,0] op_sel_hi:[0,1,1] neg_lo:[1,0,0] neg_hi:[1,0,0]
    v_pk_fma_f32 v[30:31], v[136:137], v[4:5], v[30:31] op_sel:[0,0,0] op_sel_hi:[0,1,1] neg_lo:[1,0,0] neg_hi:[1,0,0]
    v_cvt_pk_bf16_f32 v28, v28, v29
    v_cvt_pk_bf16_f32 v29, v30, v31
    v_pk_max_i16 v28, v28, 0
    v_pk_max_i16 v29, v29, 0
    v_pk_fma_f32 v[44:45], v[136:137], v[6:7], v[44:45] op_sel:[0,0,0] op_sel_hi:[0,1,1] neg_lo:[1,0,0] neg_hi:[1,0,0]
    v_pk_fma_f32 v[46:47], v[136:137], v[8:9], v[46:47] op_sel:[0,0,0] op_sel_hi:[0,1,1] neg_lo:[1,0,0] neg_hi:[1,0,0]
    s_add_u32 s86, s95, 8192
    buffer_load_dwordx4 v[116:119], v143, s[32:35], s86 offen sc1
    v_cvt_pk_bf16_f32 v30, v44, v45
    v_cvt_pk_bf16_f32 v31, v46, v47
    v_pk_max_i16 v30, v30, 0
    v_pk_max_i16 v31, v31, 0
    s_add_u32 s86, s100, 0
    buffer_load_dwordx4 v[120:123], v143, s[32:35], s86 offen sc1
    s_add_u32 s80, s12, 131072
    s_cmp_eq_u32 s53, 0
    s_cbranch_scc1 L_hs_99
    buffer_store_dwordx4 v[28:31], v143, s[32:35], s80 offen
L_he_100:
    v_pk_fma_f32 v[32:33], v[136:137], v[2:3], v[32:33] op_sel:[1,0,0] op_sel_hi:[1,1,1] neg_lo:[1,0,0] neg_hi:[1,0,0]
    v_pk_fma_f32 v[34:35], v[136:137], v[4:5], v[34:35] op_sel:[1,0,0] op_sel_hi:[1,1,1] neg_lo:[1,0,0] neg_hi:[1,0,0]
    v_cvt_pk_bf16_f32 v32, v32, v33
    s_add_u32 s86, s100, 8192
    buffer_load_dwordx4 v[124:127], v143, s[32:35], s86 offen sc1
    v_cvt_pk_bf16_f32 v33, v34, v35
    v_pk_max_i16 v32, v32, 0
    v_pk_max_i16 v33, v33, 0
    v_pk_fma_f32 v[48:49], v[136:137], v[6:7], v[48:49] op_sel:[1,0,0] op_sel_hi:[1,1,1] neg_lo:[1,0,0] neg_hi:[1,0,0]
    s_add_u32 s86, s4, 0
    buffer_load_dwordx4 v[128:131], v143, s[32:35], s86 offen sc1
    v_pk_fma_f32 v[50:51], v[136:137], v[8:9], v[50:51] op_sel:[1,0,0] op_sel_hi:[1,1,1] neg_lo:[1,0,0] neg_hi:[1,0,0]
    v_cvt_pk_bf16_f32 v34, v48, v49
    v_cvt_pk_bf16_f32 v35, v50, v51
    v_pk_max_i16 v34, v34, 0
    s_add_u32 s86, s4, 8192
    buffer_load_dwordx4 v[132:135], v143, s[32:35], s86 offen sc1
    v_pk_max_i16 v35, v35, 0
    s_add_u32 s80, s12, 196608
    s_cmp_eq_u32 s53, 0
    s_cbranch_scc1 L_hs_101
    buffer_store_dwordx4 v[32:35], v143, s[32:35], s80 offen
L_he_102:
    v_cndmask_b32 v60, v60, v61, s[24:25]
    v_cndmask_b32 v64, v64, v65, s[24:25]
    v_cndmask_b32 v60, v60, v62, s[68:69]
    v_cndmask_b32 v64, v64, v66, s[68:69]
    v_cndmask_b32 v60, v60, v63, s[70:71]
    v_cndmask_b32 v64, v64, v67, s[70:71]
    s_mov_b32 exec_lo, 0x00f0000f
    s_mov_b32 exec_hi, 0xf0000f00
    ds_write_b32 v103, v60 offset:384
    ds_write_b32 v103, v64 offset:448
    s_mov_b64 exec, -1
    s_and_b32 s73, s2, 15
    s_lshl_b32 s73, s73, 7
    s_add_u32 s73, s73, 14979072
    v_lshlrev_b32 v102, 11, v1
    v_mov_b32 v101, 1
    s_mov_b64 exec, 0xffff
    buffer_atomic_add v101, v102, s[32:35], s73 offen sc1
    s_mov_b64 exec, -1
L_g1j_28:
    s_add_u32 s86, s6, 0
    buffer_load_dwordx4 v[60:63], v143, s[32:35], s86 offen sc1
    s_add_u32 s86, s6, 8192
    buffer_load_dwordx4 v[64:67], v143, s[32:35], s86 offen sc1
    s_waitcnt vmcnt(11)
    v_mfma_f32_16x16x32_bf16 v[20:23], v[104:107], a[0:3], 0
    s_add_u32 s86, s6, 16384
    buffer_load_dwordx4 v[68:71], v143, s[32:35], s86 offen sc1
    v_mfma_f32_16x16x32_bf16 v[24:27], v[104:107], a[4:7], 0
    v_xad_u32 v56, v16, 0, s64
    v_xad_u32 v57, v17, 0, s64
    v_mfma_f32_16x16x32_bf16 v[28:31], v[104:107], a[8:11], 0
    v_and_b32 v53, 15, v1
    v_xad_u32 v58, v16, 64, s64
    v_mfma_f32_16x16x32_bf16 v[32:35], v[104:107], a[12:15], 0
    v_xad_u32 v59, v17, 64, s64
    s_waitcnt vmcnt(11)
    v_mfma_f32_16x16x32_bf16 v[20:23], v[108:111], a[16:19], v[20:23]
    s_add_u32 s86, s6, 24576
    buffer_load_dwordx4 v[72:75], v143, s[32:35], s86 offen sc1
    v_mfma_f32_16x16x32_bf16 v[24:27], v[108:111], a[20:23], v[24:27]
    v_lshlrev_b32 v140, 1, v53
    ds_read_b64_tr_b16 a[96:97], v56 offset:0
    v_mfma_f32_16x16x32_bf16 v[28:31], v[108:111], a[24:27], v[28:31]
    ds_read_b64_tr_b16 a[98:99], v56 offset:2048
    s_and_b32 s76, s22, 0x3c0
    v_mfma_f32_16x16x32_bf16 v[32:35], v[108:111], a[28:31], v[32:35]
    ds_read_b64_tr_b16 a[100:101], v57 offset:0
    s_waitcnt vmcnt(11)
    v_mfma_f32_16x16x32_bf16 v[20:23], v[112:115], a[32:35], v[20:23]
    s_add_u32 s86, s6, 32768
    buffer_load_dwordx4 v[76:79], v143, s[32:35], s86 offen sc1
    v_mfma_f32_16x16x32_bf16 v[24:27], v[112:115], a[36:39], v[24:27]
    v_add_u32 v140, s76, v140
    ds_read_b64_tr_b16 a[102:103], v57 offset:2048
    v_mfma_f32_16x16x32_bf16 v[28:31], v[112:115], a[40:43], v[28:31]
    ds_read_b64_tr_b16 a[104:105], v58 offset:0
    v_mfma_f32_16x16x32_bf16 v[32:35], v[112:115], a[44:47], v[32:35]
    ds_read_b64_tr_b16 a[106:107], v58 offset:2048
    s_waitcnt vmcnt(11)
    v_mfma_f32_16x16x32_bf16 v[20:23], v[116:119], a[48:51], v[20:23]
    s_add_u32 s86, s6, 40960
    buffer_load_dwordx4 v[80:83], v143, s[32:35], s86 offen sc1
    v_mfma_f32_16x16x32_bf16 v[24:27], v[116:119], a[52:55], v[24:27]
    v_bfe_u32 v54, v1, 2, 1
    ds_read_b64_tr_b16 a[108:109], v59 offset:0
    v_mfma_f32_16x16x32_bf16 v[28:31], v[116:119], a[56:59], v[28:31]
    ds_read_b64_tr_b16 a[110:111], v59 offset:2048
    v_xor_b32 v54, s57, v54
    v_mfma_f32_16x16x32_bf16 v[32:35], v[116:119], a[60:63], v[32:35]
    v_mov_b32 v52, 2
    s_waitcnt vmcnt(11)
    v_mfma_f32_16x16x32_bf16 v[20:23], v[120:123], a[64:67], v[20:23]
    s_add_u32 s86, s101, 0
    buffer_load_dwordx4 v[84:87], v143, s[32:35], s86 offen sc1
    v_mfma_f32_16x16x32_bf16 v[24:27], v[120:123], a[68:71], v[24:27]
    s_waitcnt vmcnt(7)
    ds_read_b64_tr_b16 a[112:113], v56 offset:4096
    v_mfma_f32_16x16x32_bf16 v[28:31], v[120:123], a[72:75], v[28:31]
    v_lshlrev_b32 v54, 5, v54
    s_mov_b32 exec_lo, 1
    s_mov_b32 exec_hi, 0
    s_cmp_eq_u32 s53, 0
    s_cbranch_scc1 L_hs_109
    buffer_store_dword v52, v143, s[32:35], s19 offen
L_he_110:
    s_mov_b64 exec, -1
    v_mfma_f32_16x16x32_bf16 v[32:35], v[120:123], a[76:79], v[32:35]
    ds_read_b64_tr_b16 a[114:115], v56 offset:6144
    v_mfma_f32_16x16x32_bf16 v[20:23], v[124:127], a[80:83], v[20:23]
    s_add_u32 s86, s101, 8192
    buffer_load_dwordx4 v[104:107], v143, s[32:35], s86 offen sc1
    v_mfma_f32_16x16x32_bf16 v[24:27], v[124:127], a[84:87], v[24:27]
    ds_read_b64_tr_b16 a[116:117], v57 offset:4096
    v_lshl_add_u32 v53, v53, 6, v54
    v_mfma_f32_16x16x32_bf16 v[28:31], v[124:127], a[88:91], v[28:31]
    ds_read_b64_tr_b16 a[118:119], v57 offset:6144
    v_mfma_f32_16x16x32_bf16 v[32:35], v[124:127], a[92:95], v[32:35]
    ds_read_b64_tr_b16 a[120:121], v58 offset:4096
    s_waitcnt lgkmcnt(5)
    v_mfma_f32_16x16x32_bf16 v[20:23], v[128:131], a[96:99], v[20:23]
    s_add_u32 s86, s18, 0
    buffer_load_dwordx4 v[108:111], v143, s[32:35], s86 offen sc1
    v_mfma_f32_16x16x32_bf16 v[24:27], v[128:131], a[100:103], v[24:27]
    ds_read_b64_tr_b16 a[122:123], v58 offset:6144
    v_lshrrev_b32 v54, 4, v1
    ds_read_b64_tr_b16 a[124:125], v59 offset:4096
    v_lshl_add_u32 v53, v54, 3, v53
    ds_read_b64_tr_b16 a[126:127], v59 offset:6144
    v_mfma_f32_16x16x32_bf16 v[28:31], v[128:131], a[104:107], v[28:31]
    ds_read_b64_tr_b16 a[128:129], v56 offset:8192
    v_lshlrev_b32 v54, 4, v54
    v_mfma_f32_16x16x32_bf16 v[32:35], v[128:131], a[108:111], v[32:35]
    ds_read_b64_tr_b16 a[130:131], v56 offset:10240
    s_waitcnt lgkmcnt(2)
    v_mfma_f32_16x16x32_bf16 v[20:23], v[132:135], a[112:115], v[20:23]
    s_add_u32 s86, s18, 8192
    buffer_load_dwordx4 v[112:115], v143, s[32:35], s86 offen sc1
    v_mfma_f32_16x16x32_bf16 v[24:27], v[132:135], a[116:119], v[24:27]
    ds_read_b64_tr_b16 a[132:133], v57 offset:8192
    s_add_u32 s76, s21, 27648
    ds_read_b64_tr_b16 a[134:135], v57 offset:10240
    ds_read_b64_tr_b16 a[136:137], v58 offset:8192
    ds_read_b64_tr_b16 a[138:139], v58 offset:10240
    v_add_u32 v53, s76, v53
    ds_read_b64_tr_b16 a[140:141], v59 offset:8192
    v_and_b32 v141, 7, v1
    ds_read_b64_tr_b16 a[142:143], v59 offset:10240
    v_mfma_f32_16x16x32_bf16 v[28:31], v[132:135], a[120:123], v[28:31]
    ds_read_b64_tr_b16 a[144:145], v56 offset:12288
    v_lshlrev_b32 v141, 7, v141
    v_mfma_f32_16x16x32_bf16 v[32:35], v[132:135], a[124:127], v[32:35]
    ds_read_b64_tr_b16 a[146:147], v56 offset:14336
    s_waitcnt vmcnt(8)
    s_waitcnt lgkmcnt(2)
    v_mfma_f32_16x16x32_bf16 v[20:23], v[62:65], a[128:131], v[20:23]
    s_add_u32 s86, s54, 0
    buffer_load_dwordx4 v[116:119], v143, s[32:35], s86 offen sc1
    v_mfma_f32_16x16x32_bf16 v[24:27], v[62:65], a[132:135], v[24:27]
    ds_read_b64_tr_b16 a[148:149], v57 offset:12288
    v_lshrrev_b32 v55, 3, v1
    ds_read_b64_tr_b16 a[150:151], v57 offset:14336
    ds_read_b64_tr_b16 a[152:153], v58 offset:12288
    ds_read_b64_tr_b16 a[154:155], v58 offset:14336
    v_lshl_add_u32 v141, v55, 4, v141
    ds_read_b64_tr_b16 a[156:157], v59 offset:12288
    v_lshrrev_b32 v55, 2, v1
    ds_read_b64_tr_b16 a[158:159], v59 offset:14336
L_stub_5:
    s_cbranch_execz L_stub_9
    s_nop 0
    v_mfma_f32_16x16x32_bf16 v[28:31], v[62:65], a[136:139], v[28:31]
    v_lshlrev_b32 v55, 3, v55
    v_xad_u32 v56, v16, 0, s63
    v_mfma_f32_16x16x32_bf16 v[32:35], v[62:65], a[140:143], v[32:35]
    v_xad_u32 v57, v17, 0, s63
    s_waitcnt vmcnt(8)
    s_waitcnt lgkmcnt(0)
    v_mfma_f32_16x16x32_bf16 v[20:23], v[70:73], a[144:147], v[20:23]
    s_add_u32 s86, s54, 8192
    buffer_load_dwordx4 v[120:123], v143, s[32:35], s86 offen sc1
    v_mfma_f32_16x16x32_bf16 v[24:27], v[70:73], a[148:151], v[24:27]
    v_lshl_add_u32 v54, s57, 6, v54
    v_xad_u32 v58, v16, 64, s63
    v_mfma_f32_16x16x32_bf16 v[28:31], v[70:73], a[152:155], v[28:31]
    v_xad_u32 v59, v17, 64, s63
    v_add_u32 v142, s10, v143
    ds_read_b64_tr_b16 a[160:161], v56 offset:0
    ds_read_b64_tr_b16 a[162:163], v56 offset:2048
    ds_read_b64_tr_b16 a[164:165], v57 offset:0
    ds_read_b64_tr_b16 a[166:167], v57 offset:2048
    ds_read_b64_tr_b16 a[168:169], v58 offset:0
    ds_read_b64_tr_b16 a[170:171], v58 offset:2048
    ds_read_b64_tr_b16 a[172:173], v59 offset:0
    ds_read_b64_tr_b16 a[174:175], v59 offset:2048
    v_mov_b32 v62, v66
    v_mov_b32 v63, v67
    v_mfma_f32_16x16x32_bf16 v[32:35], v[70:73], a[156:159], v[32:35]
    v_mov_b32 v70, v74
    v_mov_b32 v71, v75
    v_mfma_f32_16x16x32_bf16 v[36:39], v[60:63], a[128:131], 0
    s_add_u32 s86, s5, 0
    buffer_load_dwordx4 v[124:127], v143, s[32:35], s86 offen sc1
    v_mfma_f32_16x16x32_bf16 v[40:43], v[60:63], a[132:135], 0
    v_mfma_f32_16x16x32_bf16 v[44:47], v[60:63], a[136:139], 0
    v_mfma_f32_16x16x32_bf16 v[48:51], v[60:63], a[140:143], 0
    s_waitcnt vmcnt(8)
    s_waitcnt lgkmcnt(0)
    v_mfma_f32_16x16x32_bf16 v[20:23], v[78:81], a[160:163], v[20:23]
    s_add_u32 s86, s5, 8192
    buffer_load_dwordx4 v[128:131], v143, s[32:35], s86 offen sc1
    v_mfma_f32_16x16x32_bf16 v[24:27], v[78:81], a[164:167], v[24:27]
    v_and_b32 v136, 7, v1
    s_barrier
    v_mfma_f32_16x16x32_bf16 v[28:31], v[78:81], a[168:171], v[28:31]
    global_load_ushort v16, v140, s[16:17] offset:0
    v_lshlrev_b32 v136, 2, v136
    v_mfma_f32_16x16x32_bf16 v[32:35], v[78:81], a[172:175], v[32:35]
    global_load_ushort v17, v140, s[16:17] offset:32
    v_lshrrev_b32 v56, 5, v1
    v_mfma_f32_16x16x32_bf16 v[36:39], v[68:71], a[144:147], v[36:39]
    v_mov_b32 v78, v82
    v_mov_b32 v79, v83
    v_mfma_f32_16x16x32_bf16 v[40:43], v[68:71], a[148:151], v[40:43]
    buffer_load_dword v137, v136, s[32:35], s11 offen sc1
    v_and_b32 v140, 31, v1
    v_lshlrev_b32 v140, 4, v140
    v_lshl_add_u32 v140, v56, 15, v140
    v_mfma_f32_16x16x32_bf16 v[44:47], v[68:71], a[152:155], v[44:47]
    v_add_u32 v52, s7, v143
    v_mfma_f32_16x16x32_bf16 v[48:51], v[68:71], a[156:159], v[48:51]
    ds_write_b128 v52, v[20:23] offset:0
    s_waitcnt vmcnt(9)
    v_mfma_f32_16x16x32_bf16 v[36:39], v[84:87], a[0:3], v[36:39]
    ds_write_b128 v52, v[24:27] offset:1024
    v_mfma_f32_16x16x32_bf16 v[40:43], v[84:87], a[4:7], v[40:43]
    v_add_u32 v52, s8, v143
    v_mfma_f32_16x16x32_bf16 v[44:47], v[84:87], a[8:11], v[44:47]
    ds_write_b128 v52, v[28:31] offset:0
    v_mfma_f32_16x16x32_bf16 v[48:51], v[84:87], a[12:15], v[48:51]
    ds_write_b128 v52, v[32:35] offset:1024
    v_mfma_f32_16x16x32_bf16 v[36:39], v[76:79], a[160:163], v[36:39]
    v_mfma_f32_16x16x32_bf16 v[40:43], v[76:79], a[164:167], v[40:43]
    v_mfma_f32_16x16x32_bf16 v[44:47], v[76:79], a[168:171], v[44:47]
    v_mfma_f32_16x16x32_bf16 v[48:51], v[76:79], a[172:175], v[48:51]
    s_waitcnt lgkmcnt(0)
    s_barrier
    v_mfma_f32_16x16x32_bf16 v[36:39], v[104:107], a[16:19], v[36:39]
    v_mfma_f32_16x16x32_bf16 v[40:43], v[104:107], a[20:23], v[40:43]
    ds_read_b128 v[84:87], v142 offset:0
    v_mfma_f32_16x16x32_bf16 v[44:47], v[104:107], a[24:27], v[44:47]
    s_waitcnt vmcnt(0)
    ds_read_b128 v[88:91], v142 offset:1024
    v_mfma_f32_16x16x32_bf16 v[48:51], v[104:107], a[28:31], v[48:51]
    v_cmp_gt_u32 vcc, 2, v137
    s_cbranch_vccnz L_hr_103
L_hb_104:
    v_mfma_f32_16x16x32_bf16 v[36:39], v[108:111], a[32:35], v[36:39]
    s_add_u32 s86, s94, 131072
    buffer_load_dwordx4 v[132:135], v143, s[32:35], s86 offen sc1
    v_mfma_f32_16x16x32_bf16 v[40:43], v[108:111], a[36:39], v[40:43]
    ds_read_b128 v[20:23], v142 offset:2048
    v_mfma_f32_16x16x32_bf16 v[44:47], v[108:111], a[40:43], v[44:47]
    ds_read_b128 v[24:27], v142 offset:3072
    v_mfma_f32_16x16x32_bf16 v[48:51], v[108:111], a[44:47], v[48:51]
    ds_read_b128 v[136:139], v54 offset:25856
    v_mfma_f32_16x16x32_bf16 v[36:39], v[112:115], a[48:51], v[36:39]
    s_add_u32 s86, s94, 139264
    buffer_load_dwordx4 v[104:107], v143, s[32:35], s86 offen sc1
    v_mfma_f32_16x16x32_bf16 v[40:43], v[112:115], a[52:55], v[40:43]
    ds_read_b128 v[100:103], v54 offset:26112
    s_waitcnt lgkmcnt(0)
    v_mfma_f32_16x16x32_bf16 v[44:47], v[112:115], a[56:59], v[44:47]
    v_mul_f32 v136, 0x3b000000, v136
    v_fmamk_f32 v100, v100, 0x3b000000, v19
    v_mfma_f32_16x16x32_bf16 v[48:51], v[112:115], a[60:63], v[48:51]
    v_mul_f32 v137, 0x3b000000, v137
    v_fmamk_f32 v101, v101, 0x3b000000, v19
    v_mfma_f32_16x16x32_bf16 v[36:39], v[116:119], a[64:67], v[36:39]
    s_add_u32 s86, s95, 131072
    buffer_load_dwordx4 v[108:111], v143, s[32:35], s86 offen sc1
    v_mfma_f32_16x16x32_bf16 v[40:43], v[116:119], a[68:71], v[40:43]
    v_mul_f32 v138, 0x3b000000, v138
    v_fmamk_f32 v102, v102, 0x3b000000, v19
    v_mfma_f32_16x16x32_bf16 v[44:47], v[116:119], a[72:75], v[44:47]
    v_mul_f32 v139, 0x3b000000, v139
    v_add_f32 v84, v84, v20
    v_mfma_f32_16x16x32_bf16 v[48:51], v[116:119], a[76:79], v[48:51]
    v_fmamk_f32 v103, v103, 0x3b000000, v19
    v_fma_f32 v100, -v136, v136, v100
    v_mfma_f32_16x16x32_bf16 v[36:39], v[120:123], a[80:83], v[36:39]
    s_add_u32 s86, s95, 139264
    buffer_load_dwordx4 v[112:115], v143, s[32:35], s86 offen sc1
    v_mfma_f32_16x16x32_bf16 v[40:43], v[120:123], a[84:87], v[40:43]
    v_add_f32 v85, v85, v21
    v_fma_f32 v101, -v137, v137, v101
    v_mfma_f32_16x16x32_bf16 v[44:47], v[120:123], a[88:91], v[44:47]
    v_fma_f32 v102, -v138, v138, v102
    v_fma_f32 v103, -v139, v139, v103
    v_mfma_f32_16x16x32_bf16 v[48:51], v[120:123], a[92:95], v[48:51]
    v_add_f32 v86, v86, v22
    v_max_f32 v100, v100, v19
    v_mfma_f32_16x16x32_bf16 v[36:39], v[124:127], a[96:99], v[36:39]
    s_add_u32 s86, s100, 131072
    buffer_load_dwordx4 v[116:119], v143, s[32:35], s86 offen sc1
    v_mfma_f32_16x16x32_bf16 v[40:43], v[124:127], a[100:103], v[40:43]
    v_max_f32 v101, v101, v19
    v_add_f32 v87, v87, v23
    v_mfma_f32_16x16x32_bf16 v[44:47], v[124:127], a[104:107], v[44:47]
    v_max_f32 v102, v102, v19
    v_max_f32 v103, v103, v19
    v_mfma_f32_16x16x32_bf16 v[48:51], v[124:127], a[108:111], v[48:51]
    v_rsq_f32 v100, v100
    v_add_f32 v88, v88, v24
    v_mfma_f32_16x16x32_bf16 v[36:39], v[128:131], a[112:115], v[36:39]
    s_add_u32 s86, s100, 139264
    buffer_load_dwordx4 v[120:123], v143, s[32:35], s86 offen sc1
    v_mfma_f32_16x16x32_bf16 v[40:43], v[128:131], a[116:119], v[40:43]
    v_rsq_f32 v101, v101
    v_rsq_f32 v102, v102
    v_mfma_f32_16x16x32_bf16 v[44:47], v[128:131], a[120:123], v[44:47]
    v_add_f32 v89, v89, v25
    v_rsq_f32 v103, v103
    ds_read_b64 v[94:95], v53 offset:0
    ds_read_b64 v[98:99], v53 offset:1024
    v_add_f32 v90, v90, v26
    v_add_f32 v91, v91, v27
    v_mfma_f32_16x16x32_bf16 v[48:51], v[128:131], a[124:127], v[48:51]
    s_waitcnt lgkmcnt(0)
    s_waitcnt vmcnt(5)
    v_mfma_f32_16x16x32_bf16 v[20:23], v[132:135], a[0:3], 0
    s_add_u32 s86, s4, 131072
    buffer_load_dwordx4 v[124:127], v143, s[32:35], s86 offen sc1
    v_mfma_f32_16x16x32_bf16 v[24:27], v[132:135], a[4:7], 0
    v_lshlrev_b32 v92, 16, v94
    v_and_b32 v93, 0xffff0000, v94
    v_mfma_f32_16x16x32_bf16 v[28:31], v[132:135], a[8:11], 0
    v_lshlrev_b32 v94, 16, v95
    v_and_b32 v95, 0xffff0000, v95
    v_mfma_f32_16x16x32_bf16 v[32:35], v[132:135], a[12:15], 0
    v_lshlrev_b32 v96, 16, v98
    s_waitcnt vmcnt(5)
    v_mfma_f32_16x16x32_bf16 v[20:23], v[104:107], a[16:19], v[20:23]
    s_add_u32 s86, s4, 139264
    buffer_load_dwordx4 v[128:131], v143, s[32:35], s86 offen sc1
    v_mfma_f32_16x16x32_bf16 v[24:27], v[104:107], a[20:23], v[24:27]
    v_and_b32 v97, 0xffff0000, v98
    v_lshlrev_b32 v98, 16, v99
    v_mfma_f32_16x16x32_bf16 v[28:31], v[104:107], a[24:27], v[28:31]
    v_and_b32 v99, 0xffff0000, v99
    v_add_u32 v52, s9, v143
    v_mfma_f32_16x16x32_bf16 v[32:35], v[104:107], a[28:31], v[32:35]
    ds_write_b128 v52, v[36:39] offset:0
    s_waitcnt vmcnt(5)
    v_mfma_f32_16x16x32_bf16 v[20:23], v[108:111], a[32:35], v[20:23]
    s_add_u32 s86, s6, 49152
    buffer_load_dwordx4 v[60:63], v143, s[32:35], s86 offen sc1
    v_mfma_f32_16x16x32_bf16 v[24:27], v[108:111], a[36:39], v[24:27]
    ds_write_b128 v52, v[40:43] offset:1024
    v_mfma_f32_16x16x32_bf16 v[28:31], v[108:111], a[40:43], v[28:31]
    s_waitcnt lgkmcnt(0)
    s_barrier
    v_mfma_f32_16x16x32_bf16 v[32:35], v[108:111], a[44:47], v[32:35]
    ds_read_b128 v[36:39], v142 offset:4096
    s_waitcnt vmcnt(5)
    v_mfma_f32_16x16x32_bf16 v[20:23], v[112:115], a[48:51], v[20:23]
    s_add_u32 s86, s6, 57344
    buffer_load_dwordx4 v[64:67], v143, s[32:35], s86 offen sc1
    v_mfma_f32_16x16x32_bf16 v[24:27], v[112:115], a[52:55], v[24:27]
    ds_read_b128 v[40:43], v142 offset:5120
    v_add_f32 v84, v84, v44
    v_mfma_f32_16x16x32_bf16 v[28:31], v[112:115], a[56:59], v[28:31]
    v_add_f32 v85, v85, v45
    v_add_f32 v86, v86, v46
    v_mfma_f32_16x16x32_bf16 v[32:35], v[112:115], a[60:63], v[32:35]
    v_add_f32 v87, v87, v47
    s_waitcnt vmcnt(5)
    v_mfma_f32_16x16x32_bf16 v[20:23], v[116:119], a[64:67], v[20:23]
    s_add_u32 s86, s6, 65536
    buffer_load_dwordx4 v[68:71], v143, s[32:35], s86 offen sc1
    v_mfma_f32_16x16x32_bf16 v[24:27], v[116:119], a[68:71], v[24:27]
    v_add_f32 v88, v88, v48
    v_add_f32 v89, v89, v49
    v_mfma_f32_16x16x32_bf16 v[28:31], v[116:119], a[72:75], v[28:31]
    v_add_f32 v90, v90, v50
    v_add_f32 v91, v91, v51
    v_mfma_f32_16x16x32_bf16 v[32:35], v[116:119], a[76:79], v[32:35]
    s_waitcnt lgkmcnt(0)
    s_waitcnt vmcnt(5)
    v_mfma_f32_16x16x32_bf16 v[20:23], v[120:123], a[80:83], v[20:23]
    s_add_u32 s86, s6, 73728
    buffer_load_dwordx4 v[72:75], v143, s[32:35], s86 offen sc1
    v_mfma_f32_16x16x32_bf16 v[24:27], v[120:123], a[84:87], v[24:27]
    v_add_f32 v84, v84, v36
    v_add_f32 v85, v85, v37
    v_mfma_f32_16x16x32_bf16 v[28:31], v[120:123], a[88:91], v[28:31]
    v_add_f32 v86, v86, v38
    v_add_f32 v87, v87, v39
    v_mfma_f32_16x16x32_bf16 v[32:35], v[120:123], a[92:95], v[32:35]
    v_add_f32 v88, v88, v40
    s_waitcnt vmcnt(5)
    v_mfma_f32_16x16x32_bf16 v[20:23], v[124:127], a[96:99], v[20:23]
    s_add_u32 s86, s6, 81920
    buffer_load_dwordx4 v[76:79], v143, s[32:35], s86 offen sc1
    v_mfma_f32_16x16x32_bf16 v[24:27], v[124:127], a[100:103], v[24:27]
    v_add_f32 v89, v89, v41
    v_add_f32 v90, v90, v42
    v_mfma_f32_16x16x32_bf16 v[28:31], v[124:127], a[104:107], v[28:31]
    v_add_f32 v91, v91, v43
    v_fmac_f32 v92, v84, v100
    v_mfma_f32_16x16x32_bf16 v[32:35], v[124:127], a[108:111], v[32:35]
    v_fmac_f32 v93, v85, v101
    s_waitcnt vmcnt(5)
    v_mfma_f32_16x16x32_bf16 v[20:23], v[128:131], a[112:115], v[20:23]
    s_add_u32 s86, s6, 90112
    buffer_load_dwordx4 v[80:83], v143, s[32:35], s86 offen sc1
    v_mfma_f32_16x16x32_bf16 v[24:27], v[128:131], a[116:119], v[24:27]
    v_fmac_f32 v94, v86, v102
    v_fmac_f32 v95, v87, v103
    v_mfma_f32_16x16x32_bf16 v[28:31], v[128:131], a[120:123], v[28:31]
    v_fmac_f32 v96, v88, v100
    v_fmac_f32 v97, v89, v101
    v_mfma_f32_16x16x32_bf16 v[32:35], v[128:131], a[124:127], v[32:35]
    v_fmac_f32 v98, v90, v102
    s_waitcnt vmcnt(4)
    v_mfma_f32_16x16x32_bf16 v[20:23], v[62:65], a[128:131], v[20:23]
    s_add_u32 s86, s101, 131072
    buffer_load_dwordx4 v[132:135], v143, s[32:35], s86 offen sc1
    v_mfma_f32_16x16x32_bf16 v[24:27], v[62:65], a[132:135], v[24:27]
    v_fmac_f32 v99, v91, v103
    v_add_f32 v84, v92, v96
    v_mfma_f32_16x16x32_bf16 v[28:31], v[62:65], a[136:139], v[28:31]
    v_mul_f32 v88, v92, v92
    v_add_f32 v85, v93, v97
    v_mfma_f32_16x16x32_bf16 v[32:35], v[62:65], a[140:143], v[32:35]
    v_mul_f32 v89, v93, v93
    s_waitcnt vmcnt(3)
    v_mfma_f32_16x16x32_bf16 v[20:23], v[70:73], a[144:147], v[20:23]
    s_add_u32 s86, s101, 139264
    buffer_load_dwordx4 v[104:107], v143, s[32:35], s86 offen sc1
    v_mfma_f32_16x16x32_bf16 v[24:27], v[70:73], a[148:151], v[24:27]
    v_add_f32 v86, v94, v98
    v_mul_f32 v90, v94, v94
    v_mfma_f32_16x16x32_bf16 v[28:31], v[70:73], a[152:155], v[28:31]
    v_add_f32 v87, v95, v99
    v_mul_f32 v91, v95, v95
    v_fmac_f32 v88, v96, v96
    v_fmac_f32 v89, v97, v97
    v_fmac_f32 v90, v98, v98
    v_fmac_f32 v91, v99, v99
    v_add_f32_dpp v84, v84, v84 row_ror:8 row_mask:0xf bank_mask:0x3
    v_add_f32_dpp v85, v85, v85 row_ror:8 row_mask:0xf bank_mask:0x3
    v_add_f32_dpp v88, v88, v88 row_ror:8 row_mask:0xf bank_mask:0x3
    v_add_f32_dpp v89, v89, v89 row_ror:8 row_mask:0xf bank_mask:0x3
    v_add_f32_dpp v84, v86, v86 row_ror:8 row_mask:0xf bank_mask:0xc
    v_add_f32_dpp v85, v87, v87 row_ror:8 row_mask:0xf bank_mask:0xc
    v_add_f32_dpp v88, v90, v90 row_ror:8 row_mask:0xf bank_mask:0xc
    v_add_f32_dpp v89, v91, v91 row_ror:8 row_mask:0xf bank_mask:0xc
    v_add_f32_dpp v100, v84, v84 row_half_mirror row_mask:0xf bank_mask:0x5
    v_add_f32_dpp v101, v88, v88 row_half_mirror row_mask:0xf bank_mask:0x5
    s_nop 0
    v_add_f32_dpp v100, v85, v85 row_half_mirror row_mask:0xf bank_mask:0xa
    v_add_f32_dpp v101, v89, v89 row_half_mirror row_mask:0xf bank_mask:0xa
    s_nop 0
    v_add_f32_dpp v100, v100, v100 quad_perm:[2,3,0,1] row_mask:0xf bank_mask:0xf
    v_add_f32_dpp v101, v101, v101 quad_perm:[2,3,0,1] row_mask:0xf bank_mask:0xf
    s_nop 0
    v_add_f32_dpp v100, v100, v100 quad_perm:[1,0,3,2] row_mask:0xf bank_mask:0xf
    v_add_f32_dpp v101, v101, v101 quad_perm:[1,0,3,2] row_mask:0xf bank_mask:0xf
    v_min_u32 v100, -2, v100
    v_min_u32 v101, -2, v101
    s_add_u32 s76, s31, 0
    s_mov_b32 exec_lo, 0x11111111
    s_mov_b32 exec_hi, 0x11111111
    s_cmp_eq_u32 s53, 0
    s_cbranch_scc1 L_hs_111
    buffer_store_dwordx2 v[100:101], v55, s[32:35], s76 offen
L_he_112:
    s_mov_b64 exec, -1
    v_mov_b32 v62, v66
    v_mov_b32 v63, v67
    v_mfma_f32_16x16x32_bf16 v[32:35], v[70:73], a[156:159], v[32:35]
    ds_read_b128 v[136:139], v54 offset:25984
    v_mfma_f32_16x16x32_bf16 v[36:39], v[60:63], a[128:131], 0
    s_add_u32 s86, s18, 131072
    buffer_load_dwordx4 v[108:111], v143, s[32:35], s86 offen sc1
    v_mfma_f32_16x16x32_bf16 v[40:43], v[60:63], a[132:135], 0
    ds_read_b128 v[56:59], v54 offset:26240
    v_mov_b32 v70, v74
    v_mfma_f32_16x16x32_bf16 v[44:47], v[60:63], a[136:139], 0
    v_mov_b32 v71, v75
    s_waitcnt lgkmcnt(0)
    v_mfma_f32_16x16x32_bf16 v[48:51], v[60:63], a[140:143], 0
    v_mul_f32 v136, 0x3b000000, v136
    s_waitcnt vmcnt(4)
    v_mfma_f32_16x16x32_bf16 v[20:23], v[78:81], a[160:163], v[20:23]
    s_add_u32 s86, s18, 139264
    buffer_load_dwordx4 v[112:115], v143, s[32:35], s86 offen sc1
    v_mfma_f32_16x16x32_bf16 v[24:27], v[78:81], a[164:167], v[24:27]
    v_fmamk_f32 v56, v56, 0x3b000000, v19
    v_mul_f32 v137, 0x3b000000, v137
    v_mfma_f32_16x16x32_bf16 v[28:31], v[78:81], a[168:171], v[28:31]
    v_fmamk_f32 v57, v57, 0x3b000000, v19
    v_mul_f32 v138, 0x3b000000, v138
    v_mfma_f32_16x16x32_bf16 v[32:35], v[78:81], a[172:175], v[32:35]
    v_fmamk_f32 v58, v58, 0x3b000000, v19
    v_mul_f32 v139, 0x3b000000, v139
    v_mfma_f32_16x16x32_bf16 v[36:39], v[68:71], a[144:147], v[36:39]
    s_add_u32 s86, s54, 131072
    buffer_load_dwordx4 v[116:119], v143, s[32:35], s86 offen sc1
    v_mfma_f32_16x16x32_bf16 v[40:43], v[68:71], a[148:151], v[40:43]
    v_fmamk_f32 v59, v59, 0x3b000000, v19
    v_fma_f32 v56, -v136, v136, v56
    v_mfma_f32_16x16x32_bf16 v[44:47], v[68:71], a[152:155], v[44:47]
    v_fma_f32 v57, -v137, v137, v57
    v_fma_f32 v58, -v138, v138, v58
    v_mfma_f32_16x16x32_bf16 v[48:51], v[68:71], a[156:159], v[48:51]
    v_fma_f32 v59, -v139, v139, v59
    s_waitcnt vmcnt(5)
    v_mfma_f32_16x16x32_bf16 v[36:39], v[132:135], a[0:3], v[36:39]
    s_add_u32 s86, s54, 139264
    buffer_load_dwordx4 v[120:123], v143, s[32:35], s86 offen sc1
    v_mfma_f32_16x16x32_bf16 v[40:43], v[132:135], a[4:7], v[40:43]
    v_max_f32 v56, v56, v19
    v_mov_b32 v78, v82
    v_mfma_f32_16x16x32_bf16 v[44:47], v[132:135], a[8:11], v[44:47]
    v_mov_b32 v79, v83
    v_max_f32 v57, v57, v19
    v_mfma_f32_16x16x32_bf16 v[48:51], v[132:135], a[12:15], v[48:51]
    v_max_f32 v58, v58, v19
    v_max_f32 v59, v59, v19
    v_mfma_f32_16x16x32_bf16 v[36:39], v[76:79], a[160:163], v[36:39]
    s_add_u32 s86, s5, 131072
    buffer_load_dwordx4 v[124:127], v143, s[32:35], s86 offen sc1
    v_mfma_f32_16x16x32_bf16 v[40:43], v[76:79], a[164:167], v[40:43]
    v_rsq_f32 v56, v56
    v_rsq_f32 v57, v57
    v_mfma_f32_16x16x32_bf16 v[44:47], v[76:79], a[168:171], v[44:47]
    v_rsq_f32 v58, v58
    v_add_u32 v52, s7, v143
    v_mfma_f32_16x16x32_bf16 v[48:51], v[76:79], a[172:175], v[48:51]
    v_rsq_f32 v59, v59
    s_waitcnt vmcnt(6)
    v_mfma_f32_16x16x32_bf16 v[36:39], v[104:107], a[16:19], v[36:39]
    s_add_u32 s86, s5, 139264
    buffer_load_dwordx4 v[128:131], v143, s[32:35], s86 offen sc1
    v_mfma_f32_16x16x32_bf16 v[40:43], v[104:107], a[20:23], v[40:43]
    ds_write_b128 v52, v[20:23] offset:6144
    s_waitcnt vmcnt(5)
    v_mfma_f32_16x16x32_bf16 v[36:39], v[108:111], a[32:35], v[36:39]
    ds_write_b128 v52, v[24:27] offset:7168
    v_add_u32 v52, s8, v143
    v_mfma_f32_16x16x32_bf16 v[40:43], v[108:111], a[36:39], v[40:43]
    ds_read_b64 v[70:71], v53 offset:32768
    s_waitcnt vmcnt(4)
    v_mfma_f32_16x16x32_bf16 v[36:39], v[112:115], a[48:51], v[36:39]
    ds_read_b64 v[74:75], v53 offset:33792
    v_mfma_f32_16x16x32_bf16 v[40:43], v[112:115], a[52:55], v[40:43]
    s_add_u32 s76, s23, 0
    buffer_load_dwordx4 v[84:87], v141, s[32:35], s76 offen offset:0 sc1
    s_waitcnt vmcnt(4)
    v_mfma_f32_16x16x32_bf16 v[36:39], v[116:119], a[64:67], v[36:39]
    ds_write_b128 v52, v[28:31] offset:6144
    v_mfma_f32_16x16x32_bf16 v[40:43], v[116:119], a[68:71], v[40:43]
    s_add_u32 s76, s23, 0
    buffer_load_dwordx4 v[88:91], v141, s[32:35], s76 offen offset:1024 sc1
    s_waitcnt vmcnt(4)
    v_mfma_f32_16x16x32_bf16 v[36:39], v[120:123], a[80:83], v[36:39]
    ds_write_b128 v52, v[32:35] offset:7168
    v_lshlrev_b32 v16, 16, v16
    v_mfma_f32_16x16x32_bf16 v[40:43], v[120:123], a[84:87], v[40:43]
    v_lshlrev_b32 v17, 16, v17
    s_waitcnt vmcnt(3)
    v_mfma_f32_16x16x32_bf16 v[36:39], v[124:127], a[96:99], v[36:39]
    s_waitcnt lgkmcnt(2)
    v_lshlrev_b32 v68, 16, v70
    v_mfma_f32_16x16x32_bf16 v[40:43], v[124:127], a[100:103], v[40:43]
    s_waitcnt lgkmcnt(0)
    s_barrier
    s_waitcnt vmcnt(2)
    v_mfma_f32_16x16x32_bf16 v[36:39], v[128:131], a[112:115], v[36:39]
    v_and_b32 v69, 0xffff0000, v70
    v_lshlrev_b32 v70, 16, v71
    v_mfma_f32_16x16x32_bf16 v[40:43], v[128:131], a[116:119], v[40:43]
    ds_read_b128 v[60:63], v142 offset:6144
    v_and_b32 v71, 0xffff0000, v71
    v_mfma_f32_16x16x32_bf16 v[44:47], v[104:107], a[24:27], v[44:47]
    v_lshlrev_b32 v72, 16, v74
    ds_read_b128 v[64:67], v142 offset:7168
    v_mfma_f32_16x16x32_bf16 v[48:51], v[104:107], a[28:31], v[48:51]
    v_and_b32 v73, 0xffff0000, v74
    v_lshlrev_b32 v74, 16, v75
    v_mfma_f32_16x16x32_bf16 v[44:47], v[108:111], a[40:43], v[44:47]
    ds_read_b128 v[20:23], v142 offset:8192
    v_and_b32 v75, 0xffff0000, v75
    v_mfma_f32_16x16x32_bf16 v[48:51], v[108:111], a[44:47], v[48:51]
    ds_read_b128 v[24:27], v142 offset:9216
    s_waitcnt lgkmcnt(0)
    v_mfma_f32_16x16x32_bf16 v[44:47], v[112:115], a[56:59], v[44:47]
    v_add_f32 v60, v60, v20
    v_add_f32 v61, v61, v21
    v_mfma_f32_16x16x32_bf16 v[48:51], v[112:115], a[60:63], v[48:51]
    v_add_f32 v62, v62, v22
    v_add_f32 v63, v63, v23
    v_mfma_f32_16x16x32_bf16 v[44:47], v[116:119], a[72:75], v[44:47]
    v_add_f32 v64, v64, v24
    v_add_f32 v65, v65, v25
    v_mfma_f32_16x16x32_bf16 v[48:51], v[116:119], a[76:79], v[48:51]
    v_add_f32 v66, v66, v26
    v_add_u32 v52, s9, v143
    v_mfma_f32_16x16x32_bf16 v[44:47], v[120:123], a[88:91], v[44:47]
    s_waitcnt vmcnt(0)
    v_max3_u32 v136, v84, v85, v86
    v_mfma_f32_16x16x32_bf16 v[48:51], v[120:123], a[92:95], v[48:51]
    v_max3_u32 v137, v87, v88, v89
    v_max3_u32 v136, v136, v90, v91
    v_mfma_f32_16x16x32_bf16 v[44:47], v[124:127], a[104:107], v[44:47]
    v_add_f32 v67, v67, v27
    ds_write_b128 v52, v[36:39] offset:6144
    v_mfma_f32_16x16x32_bf16 v[48:51], v[124:127], a[108:111], v[48:51]
    v_max_u32 v136, v136, v137
    v_cmp_eq_u32 vcc, -1, v136
    s_cbranch_vccnz L_re_105
L_bk_106:
    v_mfma_f32_16x16x32_bf16 v[44:47], v[128:131], a[120:123], v[44:47]
    v_add_f32 v84, v84, v88
    ds_write_b128 v52, v[40:43] offset:7168
    v_add_f32 v85, v85, v89
    v_add_f32 v86, v86, v90
    v_add_f32 v87, v87, v91
    v_add_f32_dpp v84, v84, v84 quad_perm:[1,0,3,2] row_mask:0xf bank_mask:0xf
    v_add_f32_dpp v85, v85, v85 quad_perm:[1,0,3,2] row_mask:0xf bank_mask:0xf
    v_add_f32_dpp v86, v86, v86 quad_perm:[1,0,3,2] row_mask:0xf bank_mask:0xf
    v_add_f32_dpp v87, v87, v87 quad_perm:[1,0,3,2] row_mask:0xf bank_mask:0xf
    v_add_f32_dpp v84, v84, v84 quad_perm:[2,3,0,1] row_mask:0xf bank_mask:0xf
    v_add_f32_dpp v85, v85, v85 quad_perm:[2,3,0,1] row_mask:0xf bank_mask:0xf
    v_add_f32_dpp v86, v86, v86 quad_perm:[2,3,0,1] row_mask:0xf bank_mask:0xf
    v_add_f32_dpp v87, v87, v87 quad_perm:[2,3,0,1] row_mask:0xf bank_mask:0xf
    v_add_f32_dpp v84, v84, v84 row_half_mirror row_mask:0xf bank_mask:0xf
    v_add_f32_dpp v85, v85, v85 row_half_mirror row_mask:0xf bank_mask:0xf
    s_waitcnt lgkmcnt(0)
    s_barrier
    v_add_f32_dpp v86, v86, v86 row_half_mirror row_mask:0xf bank_mask:0xf
    v_add_f32_dpp v87, v87, v87 row_half_mirror row_mask:0xf bank_mask:0xf
    v_mul_f32 v84, 0xbb000000, v84
    v_fmamk_f32 v85, v85, 0x3b000000, v19
    ds_read_b128 v[28:31], v142 offset:10240
    v_mul_f32 v86, 0xbb000000, v86
    v_fmamk_f32 v87, v87, 0x3b000000, v19
    v_fma_f32 v85, -v84, v84, v85
    ds_read_b128 v[32:35], v142 offset:11264
    v_mfma_f32_16x16x32_bf16 v[48:51], v[128:131], a[124:127], v[48:51]
    v_fma_f32 v87, -v86, v86, v87
    v_max_f32 v85, v85, v19
    v_max_f32 v87, v87, v19
    v_rsq_f32 v100, v85
    v_rsq_f32 v101, v87
    v_mul_f32 v88, v84, v100
    v_mul_f32 v89, v86, v101
    v_mov_b32 v102, v100
    v_mov_b32 v90, v88
    v_mov_b32 v103, v101
    v_mov_b32 v91, v89
    v_mov_b32_dpp v100, v102 row_ror:8 row_mask:0xf bank_mask:0xc
    v_mov_b32_dpp v101, v103 row_ror:8 row_mask:0xf bank_mask:0xc
    v_mov_b32_dpp v88, v90 row_ror:8 row_mask:0xf bank_mask:0xc
    v_mov_b32_dpp v89, v91 row_ror:8 row_mask:0xf bank_mask:0xc
    v_mov_b32_dpp v102, v102 row_ror:8 row_mask:0xf bank_mask:0x3
    v_mov_b32_dpp v103, v103 row_ror:8 row_mask:0xf bank_mask:0x3
    v_mov_b32_dpp v90, v90 row_ror:8 row_mask:0xf bank_mask:0x3
    v_mov_b32_dpp v91, v91 row_ror:8 row_mask:0xf bank_mask:0x3
    v_fma_f32 v84, v92, v100, v88
    v_fma_f32 v85, v93, v101, v89
    v_fma_f32 v86, v94, v102, v90
    v_fma_f32 v87, v95, v103, v91
    v_fma_f32 v136, v96, v100, v88
    v_fma_f32 v137, v97, v101, v89
    v_fma_f32 v138, v98, v102, v90
    v_fma_f32 v139, v99, v103, v91
    v_cvt_pk_bf16_f32 v88, v84, v85
    v_cvt_pk_bf16_f32 v89, v86, v87
    v_cvt_pk_bf16_f32 v90, v136, v137
    v_cvt_pk_bf16_f32 v91, v138, v139
    v_min_u32 v88, -2, v88
    v_min_u32 v89, -2, v89
    v_min_u32 v90, -2, v90
    v_min_u32 v91, -2, v91
    s_nop 0
    v_permlane16_swap_b32 v88, v90
    v_permlane16_swap_b32 v89, v91
    s_add_u32 s76, s30, 0
    buffer_store_dwordx4 v[88:91], v140, s[32:35], s76 offen sc1
    v_fmac_f32 v92, v84, v16
    v_fmac_f32 v93, v85, v16
    v_fmac_f32 v94, v86, v16
    v_fmac_f32 v95, v87, v16
    v_fmac_f32 v96, v136, v17
    v_fmac_f32 v97, v137, v17
    v_fmac_f32 v98, v138, v17
    v_fmac_f32 v99, v139, v17
    v_cvt_pk_bf16_f32 v92, v92, v93
    v_cvt_pk_bf16_f32 v93, v94, v95
    v_cvt_pk_bf16_f32 v94, v96, v97
    v_cvt_pk_bf16_f32 v95, v98, v99
    v_min_u32 v92, -2, v92
    v_min_u32 v93, -2, v93
    v_min_u32 v94, -2, v94
    v_min_u32 v95, -2, v95
    s_nop 0
    v_permlane16_swap_b32 v92, v94
    v_permlane16_swap_b32 v93, v95
    s_add_u32 s76, s30, 8192
    buffer_store_dwordx4 v[92:95], v140, s[32:35], s76 offen sc1
    s_cmp_lg_u32 s48, 3
    s_cbranch_scc1 L_pb_113
    s_and_b32 s74, s2, 15
    s_lshl_b32 s74, s74, 11
    s_add_u32 s74, s74, 14979072
    v_and_b32 v53, 15, v1
    v_lshlrev_b32 v53, 7, v53
    buffer_load_dword v21, v53, s[32:35], s74 offen sc1
L_pb_113:
    v_pk_add_f32 v[60:61], v[60:61], v[44:45]
    v_pk_add_f32 v[62:63], v[62:63], v[46:47]
    v_pk_add_f32 v[64:65], v[64:65], v[48:49]
    v_pk_add_f32 v[66:67], v[66:67], v[50:51]
    s_waitcnt lgkmcnt(0)
    v_pk_add_f32 v[60:61], v[60:61], v[28:29]
    v_pk_add_f32 v[62:63], v[62:63], v[30:31]
    v_pk_add_f32 v[64:65], v[64:65], v[32:33]
    v_pk_add_f32 v[66:67], v[66:67], v[34:35]
    v_fmac_f32 v68, v60, v56
    v_fmac_f32 v69, v61, v57
    v_fmac_f32 v70, v62, v58
    v_fmac_f32 v71, v63, v59
    v_fmac_f32 v72, v64, v56
    v_fmac_f32 v73, v65, v57
    v_fmac_f32 v74, v66, v58
    v_fmac_f32 v75, v67, v59
    v_add_f32 v60, v68, v72
    v_mul_f32 v64, v68, v68
    v_add_f32 v61, v69, v73
    v_mul_f32 v65, v69, v69
    v_add_f32 v62, v70, v74
    v_mul_f32 v66, v70, v70
    v_add_f32 v63, v71, v75
    v_mul_f32 v67, v71, v71
    v_fmac_f32 v64, v72, v72
    v_fmac_f32 v65, v73, v73
    v_fmac_f32 v66, v74, v74
    v_fmac_f32 v67, v75, v75
    v_add_f32_dpp v60, v60, v60 row_ror:8 row_mask:0xf bank_mask:0x3
    v_add_f32_dpp v61, v61, v61 row_ror:8 row_mask:0xf bank_mask:0x3
    v_add_f32_dpp v64, v64, v64 row_ror:8 row_mask:0xf bank_mask:0x3
    v_add_f32_dpp v65, v65, v65 row_ror:8 row_mask:0xf bank_mask:0x3
    v_add_f32_dpp v60, v62, v62 row_ror:8 row_mask:0xf bank_mask:0xc
    v_add_f32_dpp v61, v63, v63 row_ror:8 row_mask:0xf bank_mask:0xc
    v_add_f32_dpp v64, v66, v66 row_ror:8 row_mask:0xf bank_mask:0xc
    v_add_f32_dpp v65, v67, v67 row_ror:8 row_mask:0xf bank_mask:0xc
    v_add_f32_dpp v56, v60, v60 row_half_mirror row_mask:0xf bank_mask:0x5
    v_add_f32_dpp v57, v64, v64 row_half_mirror row_mask:0xf bank_mask:0x5
    s_nop 0
    v_add_f32_dpp v56, v61, v61 row_half_mirror row_mask:0xf bank_mask:0xa
    v_add_f32_dpp v57, v65, v65 row_half_mirror row_mask:0xf bank_mask:0xa
    s_nop 0
    v_add_f32_dpp v56, v56, v56 quad_perm:[2,3,0,1] row_mask:0xf bank_mask:0xf
    v_add_f32_dpp v57, v57, v57 quad_perm:[2,3,0,1] row_mask:0xf bank_mask:0xf
    s_nop 0
    v_add_f32_dpp v56, v56, v56 quad_perm:[1,0,3,2] row_mask:0xf bank_mask:0xf
    v_add_f32_dpp v57, v57, v57 quad_perm:[1,0,3,2] row_mask:0xf bank_mask:0xf
    v_min_u32 v56, -2, v56
    v_min_u32 v57, -2, v57
    s_add_u32 s76, s31, 4096
    s_mov_b32 exec_lo, 0x11111111
    s_mov_b32 exec_hi, 0x11111111
    s_cmp_eq_u32 s53, 0
    s_cbranch_scc1 L_hs_114
    buffer_store_dwordx2 v[56:57], v55, s[32:35], s76 offen
L_he_115:
    s_mov_b64 exec, -1
    v_mov_b32 v20, v53
    v_and_b32 v124, 127, v0
    v_lshlrev_b32 v124, 14, v124
    s_lshl1_add_u32 s92, s49, s67
    s_lshl_b32 s92, s92, 4
    s_add_u32 s92, s92, 6291456
    s_mul_i32 s91, s67, 4608
    s_lshl_b32 s93, s57, 10
    s_add_u32 s91, s91, s93
    s_add_u32 s91, s91, 17152
    v_and_b32 v104, 15, v1
    v_lshrrev_b32 v105, 4, v1
    v_and_b32 v106, 1, v1
    v_xor_b32 v106, 1, v106
    v_mul_u32_u24 v107, 4158, v106
    v_lshl_add_u32 v108, v105, 3, v104
    v_lshlrev_b32 v108, 1, v108
    v_sub_u32 v107, v107, v108
    s_mul_i32 s75, s67, 8320
    s_lshl_b32 s76, s57, 8
    s_sub_u32 s75, s75, s76
    s_add_u32 s75, s75, 3406
    v_add_u32 v52, s75, v107
    v_subrev_u32 v53, 1024, v52
    v_subrev_u32 v54, 2048, v52
    v_subrev_u32 v55, 3072, v52
    v_lshlrev_b32 v56, 5, v104
    v_lshlrev_b32 v107, 4, v105
    v_sub_u32 v56, v56, v107
    s_mul_i32 s75, s67, 4608
    s_sub_u32 s75, s75, s76
    s_add_u32 s75, s75, 16976
    v_add_u32 v56, s75, v56
L_stub_6:
    s_cbranch_execz L_stub_10
    s_nop 0
    s_lshl_b32 s75, s67, 13
    s_add_u32 s75, s75, 60416
    v_lshl_add_u32 v57, v1, 4, s75
    v_and_b32 v106, 1, v105
    v_mul_u32_u24 v106, 3, v106
    v_xor_b32 v106, s57, v106
    v_lshlrev_b32 v106, 9, v106
    v_lshrrev_b32 v107, 1, v105
    v_mul_u32_u24 v108, 3, v107
    v_xor_b32 v108, s57, v108
    v_lshlrev_b32 v108, 5, v108
    v_and_or_b32 v108, v105, 1, v108
    v_lshl_add_u32 v106, v107, 8, v106
    v_lshl_add_u32 v58, v104, 4, v106
    v_lshl_add_u32 v59, v104, 1, v108
    v_lshlrev_b32 v59, 14, v59
    v_lshl_add_u32 v126, v1, 4, s91
    v_lshlrev_b32 v105, 1, v105
    v_xor_b32 v105, v105, v1
    v_and_b32 v105, 3, v105
    v_lshrrev_b32 v127, 2, v1
    v_lshlrev_b32 v127, 12, v127
    v_lshl_add_u32 v127, v105, 4, v127
    s_add_u32 s90, s92, 8192
    s_lshl_b32 s77, s49, 1
    s_add_u32 s77, s77, s67
    s_lshl_b32 s77, s77, 12
    s_add_u32 s77, s77, 10485760
    s_movk_i32 s89, 0x3f80
    v_lshrrev_b32 v108, 4, v1
    v_and_b32 v109, 15, v1
    v_lshlrev_b32 v108, 3, v108
    v_sub_u32 v109, v109, v108
    v_and_b32 v110, 1, v1
    v_lshlrev_b32 v110, 4, v110
    v_lshlrev_b32 v110, v110, s89
    v_ashrrev_i32 v111, 1, v109
    v_cmp_eq_u32 s[78:79], 0, v111
    v_cmp_eq_u32 s[80:81], 1, v111
    v_cmp_eq_u32 s[82:83], 2, v111
    v_cmp_eq_u32 s[84:85], 3, v111
    v_cndmask_b32 v128, 0, v110, s[78:79]
    v_cndmask_b32 v129, 0, v110, s[80:81]
    v_cndmask_b32 v130, 0, v110, s[82:83]
    v_cndmask_b32 v131, 0, v110, s[84:85]
    v_cmp_eq_u32 s[78:79], -8, v111
    v_cmp_eq_u32 s[80:81], -7, v111
    v_cmp_eq_u32 s[82:83], -6, v111
    v_cmp_eq_u32 s[84:85], -5, v111
    v_cndmask_b32 v132, 0, v110, s[78:79]
    v_cndmask_b32 v133, 0, v110, s[80:81]
    v_cndmask_b32 v134, 0, v110, s[82:83]
    v_cndmask_b32 v135, 0, v110, s[84:85]
    s_waitcnt vmcnt(0)
    s_cmp_lg_u32 s48, 3
    s_cbranch_scc1 L_pd_116
    v_cmp_gt_u32 vcc, 32, v21
    s_cbranch_vccz L_pk_118
L_pl_117:
    buffer_load_dword v21, v20, s[32:35], s74 offen sc1
    s_waitcnt vmcnt(0)
    v_cmp_gt_u32 vcc, 32, v21
    s_cbranch_vccz L_pk_118
    s_sub_u32 s56, s56, 1
    s_cbranch_scc1 L_bail
    s_branch L_pl_117
L_pk_118:
L_pd_116:
    s_add_u32 s76, s23, 4096
    buffer_load_dwordx4 v[60:63], v141, s[32:35], s76 offen offset:0 sc1
    s_add_u32 s76, s23, 4096
    buffer_load_dwordx4 v[64:67], v141, s[32:35], s76 offen offset:1024 sc1
    s_barrier
    s_waitcnt vmcnt(0)
    v_max3_u32 v80, v60, v61, v62
    v_max3_u32 v81, v63, v64, v65
    v_max3_u32 v80, v80, v66, v67
    v_max_u32 v80, v80, v81
    v_cmp_eq_u32 vcc, -1, v80
    s_cbranch_vccnz L_re_119
L_bk_120:
    s_add_u32 m0, s91, 0
    s_add_u32 s93, s92, 0
    buffer_load_dwordx4 v124, s[32:35], s93 offen sc1 lds
    s_add_u32 s93, s90, 0
    buffer_load_dwordx4 v[136:139], v59, s[32:35], s93 offen sc1
    v_add_f32 v60, v60, v64
    v_add_f32 v61, v61, v65
    v_add_f32 v62, v62, v66
    v_add_f32 v63, v63, v67
    v_add_f32_dpp v60, v60, v60 quad_perm:[1,0,3,2] row_mask:0xf bank_mask:0xf
    v_add_f32_dpp v61, v61, v61 quad_perm:[1,0,3,2] row_mask:0xf bank_mask:0xf
    v_add_f32_dpp v62, v62, v62 quad_perm:[1,0,3,2] row_mask:0xf bank_mask:0xf
    v_add_f32_dpp v63, v63, v63 quad_perm:[1,0,3,2] row_mask:0xf bank_mask:0xf
    v_add_f32_dpp v60, v60, v60 quad_perm:[2,3,0,1] row_mask:0xf bank_mask:0xf
    v_add_f32_dpp v61, v61, v61 quad_perm:[2,3,0,1] row_mask:0xf bank_mask:0xf
    v_add_f32_dpp v62, v62, v62 quad_perm:[2,3,0,1] row_mask:0xf bank_mask:0xf
    v_add_f32_dpp v63, v63, v63 quad_perm:[2,3,0,1] row_mask:0xf bank_mask:0xf
    v_add_f32_dpp v60, v60, v60 row_half_mirror row_mask:0xf bank_mask:0xf
    v_add_f32_dpp v61, v61, v61 row_half_mirror row_mask:0xf bank_mask:0xf
    v_add_f32_dpp v62, v62, v62 row_half_mirror row_mask:0xf bank_mask:0xf
    v_add_f32_dpp v63, v63, v63 row_half_mirror row_mask:0xf bank_mask:0xf
    v_mul_f32 v60, 0xbb000000, v60
    v_fmamk_f32 v61, v61, 0x3b000000, v19
    v_mul_f32 v62, 0xbb000000, v62
    v_fmamk_f32 v63, v63, 0x3b000000, v19
    v_fma_f32 v61, -v60, v60, v61
    v_fma_f32 v63, -v62, v62, v63
    v_max_f32 v61, v61, v19
    v_max_f32 v63, v63, v19
    v_rsq_f32 v76, v61
    v_rsq_f32 v77, v63
    v_mul_f32 v64, v60, v76
    v_mul_f32 v65, v62, v77
    v_mov_b32 v78, v76
    v_mov_b32 v66, v64
    v_mov_b32 v79, v77
    v_mov_b32 v67, v65
    v_mov_b32_dpp v76, v78 row_ror:8 row_mask:0xf bank_mask:0xc
    v_mov_b32_dpp v77, v79 row_ror:8 row_mask:0xf bank_mask:0xc
    v_mov_b32_dpp v64, v66 row_ror:8 row_mask:0xf bank_mask:0xc
    v_mov_b32_dpp v65, v67 row_ror:8 row_mask:0xf bank_mask:0xc
    v_mov_b32_dpp v78, v78 row_ror:8 row_mask:0xf bank_mask:0x3
    v_mov_b32_dpp v79, v79 row_ror:8 row_mask:0xf bank_mask:0x3
    v_mov_b32_dpp v66, v66 row_ror:8 row_mask:0xf bank_mask:0x3
    v_mov_b32_dpp v67, v67 row_ror:8 row_mask:0xf bank_mask:0x3
    v_fma_f32 v60, v68, v76, v64
    v_fma_f32 v61, v69, v77, v65
    v_fma_f32 v62, v70, v78, v66
    v_fma_f32 v63, v71, v79, v67
    v_fma_f32 v80, v72, v76, v64
    v_fma_f32 v81, v73, v77, v65
    v_fma_f32 v82, v74, v78, v66
    v_fma_f32 v83, v75, v79, v67
    v_cvt_pk_bf16_f32 v64, v60, v61
    v_cvt_pk_bf16_f32 v65, v62, v63
    v_cvt_pk_bf16_f32 v66, v80, v81
    v_cvt_pk_bf16_f32 v67, v82, v83
    v_min_u32 v64, -2, v64
    v_min_u32 v65, -2, v65
    v_min_u32 v66, -2, v66
    v_min_u32 v67, -2, v67
    s_nop 0
    v_permlane16_swap_b32 v64, v66
    v_permlane16_swap_b32 v65, v67
    s_add_u32 s76, s30, 2097152
    buffer_store_dwordx4 v[64:67], v140, s[32:35], s76 offen sc1
    v_fmac_f32 v68, v60, v16
    v_fmac_f32 v69, v61, v16
    v_fmac_f32 v70, v62, v16
    v_fmac_f32 v71, v63, v16
    v_fmac_f32 v72, v80, v17
    v_fmac_f32 v73, v81, v17
    v_fmac_f32 v74, v82, v17
    v_fmac_f32 v75, v83, v17
    v_cvt_pk_bf16_f32 v68, v68, v69
    v_cvt_pk_bf16_f32 v69, v70, v71
    v_cvt_pk_bf16_f32 v70, v72, v73
    v_cvt_pk_bf16_f32 v71, v74, v75
    v_min_u32 v68, -2, v68
    v_min_u32 v69, -2, v69
    v_min_u32 v70, -2, v70
    v_min_u32 v71, -2, v71
    s_nop 0
    v_permlane16_swap_b32 v68, v70
    v_permlane16_swap_b32 v69, v71
    s_add_u32 s76, s30, 2105344
    buffer_store_dwordx4 v[68:71], v140, s[32:35], s76 offen sc1
    ds_read2_b32 v[60:61], v52 offset0:176 offset1:177
    ds_read2_b32 v[62:63], v52 offset0:178 offset1:179
    ds_read2_b32 v[64:65], v52 offset0:48 offset1:49
    ds_read2_b32 v[66:67], v52 offset0:50 offset1:51
    ds_read2_b32 v[68:69], v53 offset0:176 offset1:177
    ds_read2_b32 v[70:71], v53 offset0:178 offset1:179
    ds_read2_b32 v[72:73], v53 offset0:48 offset1:49
    ds_read2_b32 v[74:75], v53 offset0:50 offset1:51
    ds_read2_b32 v[76:77], v52 offset0:160 offset1:161
    ds_read2_b32 v[78:79], v52 offset0:162 offset1:163
    ds_read2_b32 v[80:81], v52 offset0:32 offset1:33
    ds_read2_b32 v[82:83], v52 offset0:34 offset1:35
    ds_read2_b32 v[84:85], v53 offset0:160 offset1:161
    ds_read2_b32 v[86:87], v53 offset0:162 offset1:163
    ds_read2_b32 v[88:89], v53 offset0:32 offset1:33
    ds_read2_b32 v[90:91], v53 offset0:34 offset1:35
    ds_read2_b32 v[92:93], v52 offset0:144 offset1:145
    ds_read2_b32 v[94:95], v52 offset0:146 offset1:147
    ds_read2_b32 v[96:97], v52 offset0:16 offset1:17
    ds_read2_b32 v[98:99], v52 offset0:18 offset1:19
    ds_read2_b32 v[100:101], v53 offset0:144 offset1:145
    ds_read2_b32 v[102:103], v53 offset0:146 offset1:147
    s_waitcnt vmcnt(3)
    ds_read_b128 v[104:107], v126 offset:0
    s_waitcnt lgkmcnt(0)
    v_max3_u32 v125, v104, v105, v106
    v_max_u32 v125, v125, v107
    v_cmp_eq_u32 vcc, -1, v125
    s_cbranch_vccnz L_re_121
L_bk_122:
    s_waitcnt lgkmcnt(0)
    s_barrier
    s_cmp_lg_u32 s57, 0
    s_cbranch_scc1 L_tkh1_123
    ds_read_b128 v[104:107], v56 offset:192
    ds_read_b128 v[108:111], v56 offset:704
    ds_read_b128 v[112:115], v56 offset:1216
    ds_read_b128 v[116:119], v56 offset:1728
    s_waitcnt lgkmcnt(3)
    v_mfma_f32_16x16x32_bf16 v[32:35], v[72:75], v[104:107], 0
    ds_read_b128 v[120:123], v56 offset:128
    v_mfma_f32_16x16x32_bf16 v[28:31], v[68:71], v[104:107], 0
    ds_read_b128 v[72:75], v56 offset:640
    s_waitcnt lgkmcnt(4)
    v_mfma_f32_16x16x32_bf16 v[32:35], v[68:71], v[108:111], v[32:35]
    ds_read_b128 v[68:71], v56 offset:1152
    v_mfma_f32_16x16x32_bf16 v[24:27], v[64:67], v[104:107], 0
    v_mfma_f32_16x16x32_bf16 v[28:31], v[64:67], v[108:111], v[28:31]
    s_waitcnt lgkmcnt(4)
    v_mfma_f32_16x16x32_bf16 v[32:35], v[64:67], v[112:115], v[32:35]
    ds_read_b128 v[64:67], v56 offset:1664
    v_mfma_f32_16x16x32_bf16 v[20:23], v[60:63], v[104:107], 0
    ds_read2_b32 v[104:105], v53 offset0:16 offset1:17
    v_mfma_f32_16x16x32_bf16 v[24:27], v[60:63], v[108:111], v[24:27]
    ds_read2_b32 v[106:107], v53 offset0:18 offset1:19
    v_mfma_f32_16x16x32_bf16 v[28:31], v[60:63], v[112:115], v[28:31]
    ds_read_b128 v[108:111], v56 offset:64
    s_waitcnt lgkmcnt(7)
    v_mfma_f32_16x16x32_bf16 v[32:35], v[60:63], v[116:119], v[32:35]
    ds_read_b128 v[112:115], v56 offset:576
    s_waitcnt lgkmcnt(7)
    v_mfma_f32_16x16x32_bf16 v[32:35], v[88:91], v[120:123], v[32:35]
    ds_read_b128 v[116:119], v56 offset:1088
    v_mfma_f32_16x16x32_bf16 v[28:31], v[84:87], v[120:123], v[28:31]
    ds_read_b128 v[60:63], v56 offset:1600
    s_waitcnt lgkmcnt(7)
    v_mfma_f32_16x16x32_bf16 v[32:35], v[84:87], v[72:75], v[32:35]
    ds_read2_b32 v[88:89], v53 offset0:128 offset1:129
    v_mfma_f32_16x16x32_bf16 v[24:27], v[80:83], v[120:123], v[24:27]
    ds_read2_b32 v[90:91], v53 offset0:130 offset1:131
    v_mfma_f32_16x16x32_bf16 v[28:31], v[80:83], v[72:75], v[28:31]
    ds_read_b128 v[84:87], v56 offset:0
    v_mfma_f32_16x16x32_bf16 v[32:35], v[80:83], v[68:71], v[32:35]
    ds_read2_b32 v[80:81], v52 offset0:0 offset1:1
    v_mfma_f32_16x16x32_bf16 v[20:23], v[76:79], v[120:123], v[20:23]
    ds_read2_b32 v[82:83], v52 offset0:2 offset1:3
    v_mfma_f32_16x16x32_bf16 v[24:27], v[76:79], v[72:75], v[24:27]
    ds_read_b128 v[120:123], v56 offset:512
    v_mfma_f32_16x16x32_bf16 v[28:31], v[76:79], v[68:71], v[28:31]
    ds_read2_b32 v[72:73], v52 offset0:128 offset1:129
    s_waitcnt lgkmcnt(9)
    v_mfma_f32_16x16x32_bf16 v[32:35], v[76:79], v[64:67], v[32:35]
    ds_read2_b32 v[74:75], v52 offset0:130 offset1:131
    v_mfma_f32_16x16x32_bf16 v[32:35], v[104:107], v[108:111], v[32:35]
    ds_read_b128 v[68:71], v56 offset:1024
    v_mfma_f32_16x16x32_bf16 v[28:31], v[100:103], v[108:111], v[28:31]
    ds_read2_b32 v[76:77], v53 offset0:0 offset1:1
    v_mfma_f32_16x16x32_bf16 v[32:35], v[100:103], v[112:115], v[32:35]
    ds_read2_b32 v[78:79], v53 offset0:2 offset1:3
    v_mfma_f32_16x16x32_bf16 v[24:27], v[96:99], v[108:111], v[24:27]
    ds_read_b128 v[64:67], v56 offset:1536
    v_mfma_f32_16x16x32_bf16 v[28:31], v[96:99], v[112:115], v[28:31]
    ds_read2_b32 v[104:105], v54 offset0:128 offset1:129
    s_waitcnt lgkmcnt(9)
    v_mfma_f32_16x16x32_bf16 v[32:35], v[96:99], v[116:119], v[32:35]
    ds_read2_b32 v[106:107], v54 offset0:130 offset1:131
    s_waitcnt vmcnt(2)
    v_mfma_f32_16x16x32_bf16 v[20:23], v[92:95], v[108:111], v[20:23]
    ds_read2_b32 v[100:101], v54 offset0:0 offset1:1
    v_max3_u32 v125, v136, v137, v138
    v_mfma_f32_16x16x32_bf16 v[24:27], v[92:95], v[112:115], v[24:27]
    ds_read2_b32 v[102:103], v54 offset0:2 offset1:3
    v_max_u32 v125, v125, v139
    v_mfma_f32_16x16x32_bf16 v[28:31], v[92:95], v[116:119], v[28:31]
    v_cmp_eq_u32 vcc, -1, v125
    s_cbranch_vccnz L_re_125
L_bk_126:
    v_mfma_f32_16x16x32_bf16 v[32:35], v[92:95], v[60:63], v[32:35]
    ds_read2_b32 v[96:97], v55 offset0:128 offset1:129
    v_mfma_f32_16x16x32_bf16 v[28:31], v[88:91], v[84:87], v[28:31]
    ds_read2_b32 v[98:99], v55 offset0:130 offset1:131
    s_waitcnt lgkmcnt(8)
    v_mfma_f32_16x16x32_bf16 v[24:27], v[80:83], v[84:87], v[24:27]
    ds_read2_b32 v[108:109], v55 offset0:0 offset1:1
    v_mfma_f32_16x16x32_bf16 v[28:31], v[80:83], v[120:123], v[28:31]
    ds_read2_b32 v[110:111], v55 offset0:2 offset1:3
    v_mfma_f32_16x16x32_bf16 v[24:27], v[72:75], v[120:123], v[24:27]
    ds_read2_b32 v[112:113], v55 offset0:16 offset1:17
    v_mfma_f32_16x16x32_bf16 v[28:31], v[72:75], v[68:71], v[28:31]
    ds_read2_b32 v[114:115], v55 offset0:18 offset1:19
    s_waitcnt lgkmcnt(8)
    v_mfma_f32_16x16x32_bf16 v[32:35], v[76:79], v[84:87], v[32:35]
    ds_read_b128 v[116:119], v56 offset:64
    v_mfma_f32_16x16x32_bf16 v[32:35], v[88:91], v[120:123], v[32:35]
    ds_read2_b32 v[60:61], v55 offset0:144 offset1:145
    ds_write_b128 v57, v[24:27] offset:0
    v_mfma_f32_16x16x32_bf16 v[32:35], v[80:83], v[68:71], v[32:35]
    ds_read2_b32 v[62:63], v55 offset0:146 offset1:147
    s_add_u32 m0, s91, 2048
    v_mfma_f32_16x16x32_bf16 v[20:23], v[72:75], v[84:87], v[20:23]
    ds_read_b128 v[92:95], v56 offset:576
    s_add_u32 s93, s92, 2097152
    v_mfma_f32_16x16x32_bf16 v[32:35], v[72:75], v[64:67], v[32:35]
    ds_read2_b32 v[72:73], v54 offset0:16 offset1:17
    buffer_load_dwordx4 v124, s[32:35], s93 offen sc1 lds
    v_mfma_f32_16x16x32_bf16 v[20:23], v[128:131], v[136:139], v[20:23]
    ds_read2_b32 v[74:75], v54 offset0:18 offset1:19
    ds_write_b128 v57, v[28:31] offset:1024
    v_mfma_f32_16x16x32_bf16 v[32:35], v[132:135], v[136:139], v[32:35]
    s_waitcnt lgkmcnt(0)
    s_barrier
    v_mfma_f32_16x16x32_bf16 v[36:39], v[80:83], v[64:67], 0
    ds_read_b128 v[80:83], v56 offset:1088
    ds_read_b128 v[24:27], v57 offset:4096
    v_mfma_f32_16x16x32_bf16 v[36:39], v[88:91], v[68:71], v[36:39]
    ds_read_b128 v[28:31], v57 offset:5120
    v_mfma_f32_16x16x32_bf16 v[40:43], v[88:91], v[64:67], 0
    ds_read2_b32 v[88:89], v54 offset0:144 offset1:145
    v_mfma_f32_16x16x32_bf16 v[36:39], v[76:79], v[120:123], v[36:39]
    ds_read2_b32 v[90:91], v54 offset0:146 offset1:147
    v_mfma_f32_16x16x32_bf16 v[40:43], v[76:79], v[68:71], v[40:43]
    v_mfma_f32_16x16x32_bf16 v[44:47], v[76:79], v[64:67], 0
    ds_read_b128 v[76:79], v56 offset:1600
    s_waitcnt lgkmcnt(3)
    v_mfma_f32_16x16x32_bf16 v[36:39], v[104:107], v[84:87], v[36:39]
    v_add_f32 v24, v24, v20
    v_add_f32 v25, v25, v21
    v_mfma_f32_16x16x32_bf16 v[40:43], v[104:107], v[120:123], v[40:43]
    v_add_f32 v26, v26, v22
    v_add_f32 v27, v27, v23
    v_mfma_f32_16x16x32_bf16 v[44:47], v[104:107], v[68:71], v[44:47]
    v_cvt_pk_bf16_f32 v24, v24, v25
    v_cvt_pk_bf16_f32 v25, v26, v27
    v_mfma_f32_16x16x32_bf16 v[48:51], v[104:107], v[64:67], 0
    ds_read2_b32 v[64:65], v53 offset0:16 offset1:17
    v_add_f32 v28, v28, v32
    v_mfma_f32_16x16x32_bf16 v[40:43], v[100:103], v[84:87], v[40:43]
    ds_read2_b32 v[66:67], v53 offset0:18 offset1:19
    v_add_f32 v29, v29, v33
    v_mfma_f32_16x16x32_bf16 v[44:47], v[100:103], v[120:123], v[44:47]
    ds_read2_b32 v[104:105], v53 offset0:144 offset1:145
    v_add_f32 v30, v30, v34
    v_mfma_f32_16x16x32_bf16 v[48:51], v[100:103], v[68:71], v[48:51]
    ds_read2_b32 v[106:107], v53 offset0:146 offset1:147
    v_add_f32 v31, v31, v35
    v_mfma_f32_16x16x32_bf16 v[44:47], v[96:99], v[84:87], v[44:47]
    ds_read2_b32 v[68:69], v52 offset0:16 offset1:17
    v_cvt_pk_bf16_f32 v26, v28, v29
    v_mfma_f32_16x16x32_bf16 v[48:51], v[96:99], v[120:123], v[48:51]
    ds_read2_b32 v[70:71], v52 offset0:18 offset1:19
    v_cvt_pk_bf16_f32 v27, v30, v31
    v_mfma_f32_16x16x32_bf16 v[48:51], v[108:111], v[84:87], v[48:51]
    ds_read2_b32 v[100:101], v55 offset0:32 offset1:33
    v_permlane16_swap_b32 v24, v26
    v_permlane16_swap_b32 v25, v27
    v_or_b32 v24, 1, v24
    buffer_store_dwordx4 v[24:27], v58, s[32:35], s77 offen offset:0 sc1
    v_mfma_f32_16x16x32_bf16 v[48:51], v[112:115], v[116:119], v[48:51]
    ds_read2_b32 v[102:103], v55 offset0:34 offset1:35
    v_mfma_f32_16x16x32_bf16 v[44:47], v[60:63], v[116:119], v[44:47]
    ds_read_b128 v[96:99], v56 offset:128
    v_mfma_f32_16x16x32_bf16 v[48:51], v[60:63], v[92:95], v[48:51]
    ds_read2_b32 v[120:121], v55 offset0:160 offset1:161
    v_mfma_f32_16x16x32_bf16 v[40:43], v[72:75], v[116:119], v[40:43]
    ds_read2_b32 v[122:123], v55 offset0:162 offset1:163
    v_mfma_f32_16x16x32_bf16 v[44:47], v[72:75], v[92:95], v[44:47]
    ds_read_b128 v[84:87], v56 offset:640
    v_mfma_f32_16x16x32_bf16 v[48:51], v[72:75], v[80:83], v[48:51]
    ds_read2_b32 v[20:21], v54 offset0:32 offset1:33
    s_waitcnt lgkmcnt(9)
    v_mfma_f32_16x16x32_bf16 v[36:39], v[88:91], v[116:119], v[36:39]
    ds_read2_b32 v[22:23], v54 offset0:34 offset1:35
    s_add_u32 s93, s90, 2097152
    v_mfma_f32_16x16x32_bf16 v[40:43], v[88:91], v[92:95], v[40:43]
    ds_read_b128 v[24:27], v56 offset:1152
    buffer_load_dwordx4 v[140:143], v59, s[32:35], s93 offen sc1
    v_mfma_f32_16x16x32_bf16 v[44:47], v[88:91], v[80:83], v[44:47]
    ds_read2_b32 v[28:29], v54 offset0:160 offset1:161
    v_mfma_f32_16x16x32_bf16 v[48:51], v[88:91], v[76:79], v[48:51]
    ds_read2_b32 v[30:31], v54 offset0:162 offset1:163
    v_mfma_f32_16x16x32_bf16 v[36:39], v[64:67], v[92:95], v[36:39]
    ds_read_b128 v[32:35], v56 offset:1664
    v_mfma_f32_16x16x32_bf16 v[40:43], v[64:67], v[80:83], v[40:43]
    ds_read2_b32 v[108:109], v53 offset0:32 offset1:33
    v_mfma_f32_16x16x32_bf16 v[44:47], v[64:67], v[76:79], v[44:47]
    ds_read2_b32 v[110:111], v53 offset0:34 offset1:35
    v_mfma_f32_16x16x32_bf16 v[36:39], v[104:107], v[80:83], v[36:39]
    ds_read2_b32 v[112:113], v53 offset0:160 offset1:161
    v_mfma_f32_16x16x32_bf16 v[40:43], v[104:107], v[76:79], v[40:43]
    ds_read2_b32 v[114:115], v53 offset0:162 offset1:163
    s_waitcnt lgkmcnt(9)
    v_mfma_f32_16x16x32_bf16 v[36:39], v[68:71], v[76:79], v[36:39]
    ds_read2_b32 v[60:61], v52 offset0:32 offset1:33
    v_mfma_f32_16x16x32_bf16 v[48:51], v[100:103], v[96:99], v[48:51]
    ds_read2_b32 v[62:63], v52 offset0:34 offset1:35
    v_mfma_f32_16x16x32_bf16 v[44:47], v[120:123], v[96:99], v[44:47]
    ds_read2_b32 v[72:73], v52 offset0:160 offset1:161
    s_waitcnt vmcnt(2)
    v_mfma_f32_16x16x32_bf16 v[48:51], v[120:123], v[84:87], v[48:51]
    ds_read2_b32 v[74:75], v52 offset0:162 offset1:163
    s_waitcnt lgkmcnt(9)
    v_mfma_f32_16x16x32_bf16 v[40:43], v[20:23], v[96:99], v[40:43]
    ds_read2_b32 v[116:117], v53 offset0:16 offset1:17
    ds_read_b128 v[136:139], v126 offset:2048
    v_mfma_f32_16x16x32_bf16 v[44:47], v[20:23], v[84:87], v[44:47]
    ds_read2_b32 v[118:119], v53 offset0:18 offset1:19
    v_mfma_f32_16x16x32_bf16 v[48:51], v[20:23], v[24:27], v[48:51]
    ds_read2_b32 v[88:89], v53 offset0:144 offset1:145
    v_mfma_f32_16x16x32_bf16 v[36:39], v[28:31], v[96:99], v[36:39]
    ds_read2_b32 v[90:91], v53 offset0:146 offset1:147
    v_mfma_f32_16x16x32_bf16 v[40:43], v[28:31], v[84:87], v[40:43]
    ds_read2_b32 v[92:93], v52 offset0:16 offset1:17
    v_mfma_f32_16x16x32_bf16 v[44:47], v[28:31], v[24:27], v[44:47]
    ds_read2_b32 v[94:95], v52 offset0:18 offset1:19
    s_waitcnt lgkmcnt(10)
    v_mfma_f32_16x16x32_bf16 v[48:51], v[28:31], v[32:35], v[48:51]
    ds_read2_b32 v[64:65], v52 offset0:144 offset1:145
    s_waitcnt lgkmcnt(6)
    v_mfma_f32_16x16x32_bf16 v[36:39], v[108:111], v[84:87], v[36:39]
    ds_read2_b32 v[66:67], v52 offset0:146 offset1:147
    v_max3_u32 v125, v136, v137, v138
    v_mfma_f32_16x16x32_bf16 v[40:43], v[108:111], v[24:27], v[40:43]
    ds_read2_b32 v[80:81], v53 offset0:0 offset1:1
    v_max_u32 v125, v125, v139
    v_mfma_f32_16x16x32_bf16 v[44:47], v[108:111], v[32:35], v[44:47]
    v_cmp_eq_u32 vcc, -1, v125
    s_cbranch_vccnz L_re_129
L_bk_130:
    v_mfma_f32_16x16x32_bf16 v[36:39], v[112:115], v[24:27], v[36:39]
    ds_read2_b32 v[82:83], v53 offset0:2 offset1:3
    s_barrier
    v_mfma_f32_16x16x32_bf16 v[40:43], v[112:115], v[32:35], v[40:43]
    ds_read_b128 v[104:107], v56 offset:2176
    v_mfma_f32_16x16x32_bf16 v[36:39], v[60:63], v[32:35], v[36:39]
    ds_read_b128 v[76:79], v56 offset:2688
    s_waitcnt lgkmcnt(1)
    v_mfma_f32_16x16x32_bf16 v[48:51], v[108:111], v[104:107], v[48:51]
    ds_read_b128 v[68:71], v56 offset:3200
    v_mfma_f32_16x16x32_bf16 v[44:47], v[112:115], v[104:107], v[44:47]
    ds_read_b128 v[100:103], v56 offset:3712
    s_waitcnt lgkmcnt(2)
    v_mfma_f32_16x16x32_bf16 v[48:51], v[112:115], v[76:79], v[48:51]
    ds_read_b128 v[120:123], v56 offset:2112
    v_mfma_f32_16x16x32_bf16 v[40:43], v[60:63], v[104:107], v[40:43]
    ds_read_b128 v[20:23], v56 offset:2624
    v_mfma_f32_16x16x32_bf16 v[44:47], v[60:63], v[76:79], v[44:47]
    ds_read_b128 v[96:99], v56 offset:3136
    s_waitcnt lgkmcnt(4)
    v_mfma_f32_16x16x32_bf16 v[48:51], v[60:63], v[68:71], v[48:51]
    ds_read_b128 v[28:31], v56 offset:3648
    v_mfma_f32_16x16x32_bf16 v[36:39], v[72:75], v[104:107], v[36:39]
    ds_read_b128 v[84:87], v56 offset:2048
    v_mfma_f32_16x16x32_bf16 v[40:43], v[72:75], v[76:79], v[40:43]
    ds_read2_b32 v[24:25], v53 offset0:128 offset1:129
    v_mfma_f32_16x16x32_bf16 v[44:47], v[72:75], v[68:71], v[44:47]
    ds_read2_b32 v[26:27], v53 offset0:130 offset1:131
    s_waitcnt lgkmcnt(7)
    v_mfma_f32_16x16x32_bf16 v[48:51], v[72:75], v[100:103], v[48:51]
    ds_read_b128 v[32:35], v56 offset:2560
    s_waitcnt lgkmcnt(7)
    v_mfma_f32_16x16x32_bf16 v[48:51], v[116:119], v[120:123], v[48:51]
    ds_read2_b32 v[108:109], v52 offset0:0 offset1:1
    v_mfma_f32_16x16x32_bf16 v[44:47], v[88:91], v[120:123], v[44:47]
    ds_read2_b32 v[110:111], v52 offset0:2 offset1:3
    s_waitcnt lgkmcnt(8)
    v_mfma_f32_16x16x32_bf16 v[48:51], v[88:91], v[20:23], v[48:51]
    ds_read_b128 v[112:115], v56 offset:3072
    v_mfma_f32_16x16x32_bf16 v[40:43], v[92:95], v[120:123], v[40:43]
    ds_read2_b32 v[60:61], v52 offset0:128 offset1:129
    v_mfma_f32_16x16x32_bf16 v[44:47], v[92:95], v[20:23], v[44:47]
    ds_read2_b32 v[62:63], v52 offset0:130 offset1:131
    s_waitcnt lgkmcnt(9)
    v_mfma_f32_16x16x32_bf16 v[48:51], v[92:95], v[96:99], v[48:51]
    ds_read_b128 v[104:107], v56 offset:3584
    v_mfma_f32_16x16x32_bf16 v[36:39], v[64:67], v[120:123], v[36:39]
    ds_read2_b32 v[76:77], v55 offset0:176 offset1:177
    v_mfma_f32_16x16x32_bf16 v[40:43], v[64:67], v[20:23], v[40:43]
    ds_read2_b32 v[78:79], v55 offset0:178 offset1:179
    v_mfma_f32_16x16x32_bf16 v[44:47], v[64:67], v[96:99], v[44:47]
    ds_read_b128 v[68:71], v56 offset:192
    v_mfma_f32_16x16x32_bf16 v[48:51], v[64:67], v[28:31], v[48:51]
    ds_read2_b32 v[72:73], v54 offset0:48 offset1:49
    s_waitcnt lgkmcnt(9)
    v_mfma_f32_16x16x32_bf16 v[48:51], v[80:83], v[84:87], v[48:51]
    ds_read2_b32 v[74:75], v54 offset0:50 offset1:51
    v_mfma_f32_16x16x32_bf16 v[44:47], v[24:27], v[84:87], v[44:47]
    ds_read_b128 v[100:103], v56 offset:704
    v_mfma_f32_16x16x32_bf16 v[48:51], v[24:27], v[32:35], v[48:51]
    ds_read2_b32 v[116:117], v54 offset0:176 offset1:177
    s_waitcnt lgkmcnt(9)
    v_mfma_f32_16x16x32_bf16 v[40:43], v[108:111], v[84:87], v[40:43]
    ds_read2_b32 v[118:119], v54 offset0:178 offset1:179
    v_mfma_f32_16x16x32_bf16 v[44:47], v[108:111], v[32:35], v[44:47]
    ds_read_b128 v[88:91], v56 offset:1216
    v_mfma_f32_16x16x32_bf16 v[48:51], v[108:111], v[112:115], v[48:51]
    ds_read2_b32 v[92:93], v53 offset0:48 offset1:49
    s_waitcnt lgkmcnt(9)
    v_mfma_f32_16x16x32_bf16 v[36:39], v[60:63], v[84:87], v[36:39]
    ds_read2_b32 v[94:95], v53 offset0:50 offset1:51
    v_mfma_f32_16x16x32_bf16 v[40:43], v[60:63], v[32:35], v[40:43]
    ds_read_b128 v[120:123], v56 offset:1728
    v_mfma_f32_16x16x32_bf16 v[44:47], v[60:63], v[112:115], v[44:47]
    ds_read2_b32 v[20:21], v53 offset0:176 offset1:177
    v_mfma_f32_16x16x32_bf16 v[48:51], v[60:63], v[104:107], v[48:51]
    ds_read2_b32 v[22:23], v53 offset0:178 offset1:179
    s_waitcnt lgkmcnt(9)
    v_mfma_f32_16x16x32_bf16 v[44:47], v[76:79], v[68:71], v[44:47]
    ds_read_b128 v[96:99], v56 offset:2240
    s_waitcnt vmcnt(0)
    v_mfma_f32_16x16x32_bf16 v[40:43], v[72:75], v[68:71], v[40:43]
    ds_read2_b32 v[64:65], v52 offset0:48 offset1:49
    s_waitcnt lgkmcnt(9)
    v_mfma_f32_16x16x32_bf16 v[44:47], v[72:75], v[100:103], v[44:47]
    ds_read2_b32 v[66:67], v52 offset0:50 offset1:51
    s_waitcnt lgkmcnt(9)
    v_mfma_f32_16x16x32_bf16 v[40:43], v[116:119], v[100:103], v[40:43]
    ds_read_b128 v[28:31], v56 offset:2752
    s_waitcnt lgkmcnt(9)
    v_mfma_f32_16x16x32_bf16 v[44:47], v[116:119], v[88:91], v[44:47]
    ds_read2_b32 v[80:81], v52 offset0:176 offset1:177
    s_waitcnt lgkmcnt(8)
    v_mfma_f32_16x16x32_bf16 v[40:43], v[92:95], v[88:91], v[40:43]
    ds_read2_b32 v[82:83], v52 offset0:178 offset1:179
    s_waitcnt lgkmcnt(8)
    v_mfma_f32_16x16x32_bf16 v[44:47], v[92:95], v[120:123], v[44:47]
    ds_read_b128 v[24:27], v56 offset:3264
    s_waitcnt lgkmcnt(7)
    v_mfma_f32_16x16x32_bf16 v[40:43], v[20:23], v[120:123], v[40:43]
    ds_read2_b32 v[108:109], v55 offset0:48 offset1:49
    s_waitcnt lgkmcnt(7)
    v_mfma_f32_16x16x32_bf16 v[44:47], v[20:23], v[96:99], v[44:47]
    ds_read2_b32 v[110:111], v55 offset0:50 offset1:51
    s_waitcnt lgkmcnt(6)
    v_mfma_f32_16x16x32_bf16 v[40:43], v[64:67], v[96:99], v[40:43]
    v_max3_u32 v125, v140, v141, v142
    s_waitcnt lgkmcnt(5)
    v_mfma_f32_16x16x32_bf16 v[44:47], v[64:67], v[28:31], v[44:47]
    v_max_u32 v125, v125, v143
    s_waitcnt lgkmcnt(3)
    v_mfma_f32_16x16x32_bf16 v[40:43], v[80:83], v[28:31], v[40:43]
    v_cmp_eq_u32 vcc, -1, v125
    s_cbranch_vccnz L_re_127
L_bk_128:
    s_waitcnt lgkmcnt(2)
    v_mfma_f32_16x16x32_bf16 v[44:47], v[80:83], v[24:27], v[44:47]
    ds_read_b128 v[84:87], v56 offset:3776
    s_waitcnt lgkmcnt(1)
    v_mfma_f32_16x16x32_bf16 v[48:51], v[108:111], v[68:71], v[48:51]
    s_add_u32 m0, s20, 0
    s_add_u32 s76, s15, 0
    v_mfma_f32_16x16x32_bf16 v[48:51], v[76:79], v[100:103], v[48:51]
    buffer_load_dwordx4 v127, s[32:35], s76 offen offset:0 sc1 lds
    s_add_u32 s76, s15, 64512
    v_mfma_f32_16x16x32_bf16 v[48:51], v[72:75], v[88:91], v[48:51]
    buffer_load_dwordx4 v127, s[32:35], s76 offen offset:1024 sc1 lds
    s_add_u32 s76, s15, 129024
    v_mfma_f32_16x16x32_bf16 v[36:39], v[116:119], v[68:71], v[36:39]
    buffer_load_dwordx4 v127, s[32:35], s76 offen offset:2048 sc1 lds
    s_add_u32 s76, s15, 193536
    v_mfma_f32_16x16x32_bf16 v[48:51], v[116:119], v[120:123], v[48:51]
    buffer_load_dwordx4 v127, s[32:35], s76 offen offset:3072 sc1 lds
    v_mfma_f32_16x16x32_bf16 v[36:39], v[92:95], v[100:103], v[36:39]
    ds_write_b128 v57, v[40:43] offset:2048
    s_add_u32 m0, s20, 16384
    v_mfma_f32_16x16x32_bf16 v[48:51], v[92:95], v[96:99], v[48:51]
    s_add_u32 s76, s52, 0
    buffer_load_dwordx4 v127, s[32:35], s76 offen offset:0 sc1 lds
    v_mfma_f32_16x16x32_bf16 v[36:39], v[20:23], v[88:91], v[36:39]
    ds_write_b128 v57, v[44:47] offset:3072
    s_add_u32 s76, s52, 64512
    v_mfma_f32_16x16x32_bf16 v[48:51], v[20:23], v[28:31], v[48:51]
    buffer_load_dwordx4 v127, s[32:35], s76 offen offset:1024 sc1 lds
    v_mfma_f32_16x16x32_bf16 v[36:39], v[64:67], v[120:123], v[36:39]
    s_waitcnt lgkmcnt(0)
    s_barrier
    v_mfma_f32_16x16x32_bf16 v[48:51], v[64:67], v[24:27], v[48:51]
    ds_read_b128 v[40:43], v57 offset:6144
    v_mfma_f32_16x16x32_bf16 v[36:39], v[80:83], v[96:99], v[36:39]
    ds_read_b128 v[44:47], v57 offset:7168
    s_add_u32 s76, s52, 129024
    v_mfma_f32_16x16x32_bf16 v[48:51], v[80:83], v[84:87], v[48:51]
    buffer_load_dwordx4 v127, s[32:35], s76 offen offset:2048 sc1 lds
    s_add_u32 s76, s52, 193536
    v_mfma_f32_16x16x32_bf16 v[36:39], v[128:131], v[140:143], v[36:39]
    buffer_load_dwordx4 v127, s[32:35], s76 offen offset:3072 sc1 lds
    v_mfma_f32_16x16x32_bf16 v[48:51], v[132:135], v[140:143], v[48:51]
    s_waitcnt lgkmcnt(0)
    s_nop 4
    v_pk_add_f32 v[40:41], v[40:41], v[36:37]
    v_pk_add_f32 v[42:43], v[42:43], v[38:39]
    v_cvt_pk_bf16_f32 v40, v40, v41
    v_cvt_pk_bf16_f32 v41, v42, v43
    v_pk_add_f32 v[44:45], v[44:45], v[48:49]
    v_pk_add_f32 v[46:47], v[46:47], v[50:51]
    v_cvt_pk_bf16_f32 v42, v44, v45
    v_cvt_pk_bf16_f32 v43, v46, v47
    s_nop 0
    v_permlane16_swap_b32 v40, v42
    v_permlane16_swap_b32 v41, v43
    v_or_b32 v40, 1, v40
    buffer_store_dwordx4 v[40:43], v58, s[32:35], s77 offen offset:2048 sc1
    s_branch L_tkhj_124
L_tkh1_123:
    ds_read_b128 v[104:107], v56 offset:192
    ds_read_b128 v[108:111], v56 offset:704
    ds_read_b128 v[112:115], v56 offset:1216
L_stub_7:
    s_cbranch_execz L_warm_back
    s_nop 0
    ds_read_b128 v[116:119], v56 offset:1728
    s_waitcnt lgkmcnt(3)
    v_mfma_f32_16x16x32_bf16 v[32:35], v[72:75], v[104:107], 0
    ds_read_b128 v[120:123], v56 offset:128
    v_mfma_f32_16x16x32_bf16 v[28:31], v[68:71], v[104:107], 0
    ds_read_b128 v[72:75], v56 offset:640
    s_waitcnt lgkmcnt(4)
    v_mfma_f32_16x16x32_bf16 v[32:35], v[68:71], v[108:111], v[32:35]
    ds_read_b128 v[68:71], v56 offset:1152
    v_mfma_f32_16x16x32_bf16 v[24:27], v[64:67], v[104:107], 0
    v_mfma_f32_16x16x32_bf16 v[28:31], v[64:67], v[108:111], v[28:31]
    s_waitcnt lgkmcnt(4)
    v_mfma_f32_16x16x32_bf16 v[32:35], v[64:67], v[112:115], v[32:35]
    ds_read_b128 v[64:67], v56 offset:1664
    v_mfma_f32_16x16x32_bf16 v[20:23], v[60:63], v[104:107], 0
    ds_read2_b32 v[104:105], v53 offset0:16 offset1:17
    v_mfma_f32_16x16x32_bf16 v[24:27], v[60:63], v[108:111], v[24:27]
    ds_read2_b32 v[106:107], v53 offset0:18 offset1:19
    v_mfma_f32_16x16x32_bf16 v[28:31], v[60:63], v[112:115], v[28:31]
    ds_read_b128 v[108:111], v56 offset:64
    s_waitcnt lgkmcnt(7)
    v_mfma_f32_16x16x32_bf16 v[32:35], v[60:63], v[116:119], v[32:35]
    ds_read_b128 v[112:115], v56 offset:576
    s_waitcnt lgkmcnt(7)
    v_mfma_f32_16x16x32_bf16 v[32:35], v[88:91], v[120:123], v[32:35]
    ds_read_b128 v[116:119], v56 offset:1088
    v_mfma_f32_16x16x32_bf16 v[28:31], v[84:87], v[120:123], v[28:31]
    ds_read_b128 v[60:63], v56 offset:1600
    s_waitcnt lgkmcnt(7)
    v_mfma_f32_16x16x32_bf16 v[32:35], v[84:87], v[72:75], v[32:35]
    ds_read2_b32 v[88:89], v53 offset0:0 offset1:1
    v_mfma_f32_16x16x32_bf16 v[24:27], v[80:83], v[120:123], v[24:27]
    ds_read2_b32 v[90:91], v53 offset0:2 offset1:3
    v_mfma_f32_16x16x32_bf16 v[28:31], v[80:83], v[72:75], v[28:31]
    ds_read_b128 v[84:87], v56 offset:0
    v_mfma_f32_16x16x32_bf16 v[32:35], v[80:83], v[68:71], v[32:35]
    ds_read2_b32 v[80:81], v53 offset0:128 offset1:129
    v_mfma_f32_16x16x32_bf16 v[20:23], v[76:79], v[120:123], v[20:23]
    ds_read2_b32 v[82:83], v53 offset0:130 offset1:131
    v_mfma_f32_16x16x32_bf16 v[24:27], v[76:79], v[72:75], v[24:27]
    ds_read_b128 v[120:123], v56 offset:512
    v_mfma_f32_16x16x32_bf16 v[28:31], v[76:79], v[68:71], v[28:31]
    ds_read2_b32 v[72:73], v52 offset0:0 offset1:1
    s_waitcnt lgkmcnt(9)
    v_mfma_f32_16x16x32_bf16 v[32:35], v[76:79], v[64:67], v[32:35]
    ds_read2_b32 v[74:75], v52 offset0:2 offset1:3
    v_mfma_f32_16x16x32_bf16 v[32:35], v[104:107], v[108:111], v[32:35]
    ds_read_b128 v[68:71], v56 offset:1024
    v_mfma_f32_16x16x32_bf16 v[28:31], v[100:103], v[108:111], v[28:31]
    ds_read2_b32 v[76:77], v52 offset0:128 offset1:129
    v_mfma_f32_16x16x32_bf16 v[32:35], v[100:103], v[112:115], v[32:35]
    ds_read2_b32 v[78:79], v52 offset0:130 offset1:131
    v_mfma_f32_16x16x32_bf16 v[24:27], v[96:99], v[108:111], v[24:27]
    ds_read_b128 v[64:67], v56 offset:1536
    v_mfma_f32_16x16x32_bf16 v[28:31], v[96:99], v[112:115], v[28:31]
    ds_read2_b32 v[104:105], v54 offset0:128 offset1:129
    s_waitcnt lgkmcnt(9)
    v_mfma_f32_16x16x32_bf16 v[32:35], v[96:99], v[116:119], v[32:35]
    ds_read2_b32 v[106:107], v54 offset0:130 offset1:131
    s_waitcnt vmcnt(2)
    v_mfma_f32_16x16x32_bf16 v[20:23], v[92:95], v[108:111], v[20:23]
    ds_read2_b32 v[100:101], v54 offset0:0 offset1:1
    v_max3_u32 v125, v136, v137, v138
    v_mfma_f32_16x16x32_bf16 v[24:27], v[92:95], v[112:115], v[24:27]
    ds_read2_b32 v[102:103], v54 offset0:2 offset1:3
    v_max_u32 v125, v125, v139
    v_mfma_f32_16x16x32_bf16 v[28:31], v[92:95], v[116:119], v[28:31]
    v_cmp_eq_u32 vcc, -1, v125
    s_cbranch_vccnz L_re_131
L_bk_132:
    v_mfma_f32_16x16x32_bf16 v[32:35], v[92:95], v[60:63], v[32:35]
    ds_read2_b32 v[96:97], v55 offset0:128 offset1:129
    v_mfma_f32_16x16x32_bf16 v[32:35], v[88:91], v[84:87], v[32:35]
    ds_read2_b32 v[98:99], v55 offset0:130 offset1:131
    s_waitcnt lgkmcnt(8)
    v_mfma_f32_16x16x32_bf16 v[32:35], v[80:83], v[120:123], v[32:35]
    ds_read2_b32 v[108:109], v55 offset0:0 offset1:1
    v_mfma_f32_16x16x32_bf16 v[32:35], v[72:75], v[68:71], v[32:35]
    ds_read2_b32 v[110:111], v55 offset0:2 offset1:3
    s_waitcnt lgkmcnt(8)
    v_mfma_f32_16x16x32_bf16 v[20:23], v[76:79], v[84:87], v[20:23]
    ds_read2_b32 v[112:113], v55 offset0:16 offset1:17
    v_mfma_f32_16x16x32_bf16 v[32:35], v[76:79], v[64:67], v[32:35]
    ds_read2_b32 v[114:115], v55 offset0:18 offset1:19
    v_mfma_f32_16x16x32_bf16 v[28:31], v[80:83], v[84:87], v[28:31]
    ds_read_b128 v[116:119], v56 offset:64
    v_mfma_f32_16x16x32_bf16 v[24:27], v[72:75], v[84:87], v[24:27]
    ds_read2_b32 v[60:61], v55 offset0:144 offset1:145
    s_nop 0
    ds_write_b128 v57, v[20:23] offset:4096
    v_mfma_f32_16x16x32_bf16 v[28:31], v[72:75], v[120:123], v[28:31]
    ds_read2_b32 v[62:63], v55 offset0:146 offset1:147
    s_add_u32 m0, s91, 2048
    v_mfma_f32_16x16x32_bf16 v[24:27], v[76:79], v[120:123], v[24:27]
    ds_read_b128 v[92:95], v56 offset:576
    s_add_u32 s93, s92, 2097152
    v_mfma_f32_16x16x32_bf16 v[28:31], v[76:79], v[68:71], v[28:31]
    ds_read2_b32 v[76:77], v54 offset0:16 offset1:17
    buffer_load_dwordx4 v124, s[32:35], s93 offen sc1 lds
    v_mfma_f32_16x16x32_bf16 v[24:27], v[128:131], v[136:139], v[24:27]
    ds_read2_b32 v[78:79], v54 offset0:18 offset1:19
    ds_write_b128 v57, v[32:35] offset:5120
    v_mfma_f32_16x16x32_bf16 v[28:31], v[132:135], v[136:139], v[28:31]
    s_waitcnt lgkmcnt(0)
    s_barrier
    v_mfma_f32_16x16x32_bf16 v[36:39], v[72:75], v[64:67], 0
    ds_read_b128 v[72:75], v56 offset:1088
    ds_read_b128 v[20:23], v57 offset:0
    v_mfma_f32_16x16x32_bf16 v[36:39], v[80:83], v[68:71], v[36:39]
    ds_read_b128 v[32:35], v57 offset:1024
    v_mfma_f32_16x16x32_bf16 v[40:43], v[80:83], v[64:67], 0
    ds_read2_b32 v[80:81], v54 offset0:144 offset1:145
    v_mfma_f32_16x16x32_bf16 v[36:39], v[88:91], v[120:123], v[36:39]
    ds_read2_b32 v[82:83], v54 offset0:146 offset1:147
    v_mfma_f32_16x16x32_bf16 v[40:43], v[88:91], v[68:71], v[40:43]
    v_mfma_f32_16x16x32_bf16 v[44:47], v[88:91], v[64:67], 0
    ds_read_b128 v[88:91], v56 offset:1600
    s_waitcnt lgkmcnt(3)
    v_mfma_f32_16x16x32_bf16 v[36:39], v[104:107], v[84:87], v[36:39]
    v_add_f32 v20, v20, v24
    v_add_f32 v21, v21, v25
    v_mfma_f32_16x16x32_bf16 v[40:43], v[104:107], v[120:123], v[40:43]
    v_add_f32 v22, v22, v26
    v_add_f32 v23, v23, v27
    v_mfma_f32_16x16x32_bf16 v[44:47], v[104:107], v[68:71], v[44:47]
    v_cvt_pk_bf16_f32 v20, v20, v21
    v_cvt_pk_bf16_f32 v21, v22, v23
    v_mfma_f32_16x16x32_bf16 v[48:51], v[104:107], v[64:67], 0
    ds_read2_b32 v[64:65], v53 offset0:16 offset1:17
    v_add_f32 v32, v32, v28
    v_mfma_f32_16x16x32_bf16 v[40:43], v[100:103], v[84:87], v[40:43]
    ds_read2_b32 v[66:67], v53 offset0:18 offset1:19
    v_add_f32 v33, v33, v29
    v_mfma_f32_16x16x32_bf16 v[44:47], v[100:103], v[120:123], v[44:47]
    ds_read2_b32 v[104:105], v53 offset0:144 offset1:145
    v_add_f32 v34, v34, v30
    v_mfma_f32_16x16x32_bf16 v[48:51], v[100:103], v[68:71], v[48:51]
    ds_read2_b32 v[106:107], v53 offset0:146 offset1:147
    v_add_f32 v35, v35, v31
    v_mfma_f32_16x16x32_bf16 v[44:47], v[96:99], v[84:87], v[44:47]
    ds_read2_b32 v[68:69], v52 offset0:16 offset1:17
    v_cvt_pk_bf16_f32 v22, v32, v33
    v_mfma_f32_16x16x32_bf16 v[48:51], v[96:99], v[120:123], v[48:51]
    ds_read2_b32 v[70:71], v52 offset0:18 offset1:19
    v_cvt_pk_bf16_f32 v23, v34, v35
    v_mfma_f32_16x16x32_bf16 v[48:51], v[108:111], v[84:87], v[48:51]
    ds_read2_b32 v[100:101], v55 offset0:32 offset1:33
    v_permlane16_swap_b32 v20, v22
    v_permlane16_swap_b32 v21, v23
    v_or_b32 v20, 1, v20
    buffer_store_dwordx4 v[20:23], v58, s[32:35], s77 offen offset:0 sc1
    v_mfma_f32_16x16x32_bf16 v[48:51], v[112:115], v[116:119], v[48:51]
    ds_read2_b32 v[102:103], v55 offset0:34 offset1:35
    v_mfma_f32_16x16x32_bf16 v[44:47], v[60:63], v[116:119], v[44:47]
    ds_read_b128 v[96:99], v56 offset:128
    v_mfma_f32_16x16x32_bf16 v[48:51], v[60:63], v[92:95], v[48:51]
    ds_read2_b32 v[120:121], v55 offset0:160 offset1:161
    v_mfma_f32_16x16x32_bf16 v[40:43], v[76:79], v[116:119], v[40:43]
    ds_read2_b32 v[122:123], v55 offset0:162 offset1:163
    v_mfma_f32_16x16x32_bf16 v[44:47], v[76:79], v[92:95], v[44:47]
    ds_read_b128 v[84:87], v56 offset:640
    v_mfma_f32_16x16x32_bf16 v[48:51], v[76:79], v[72:75], v[48:51]
    ds_read2_b32 v[20:21], v54 offset0:32 offset1:33
    s_waitcnt lgkmcnt(9)
    v_mfma_f32_16x16x32_bf16 v[36:39], v[80:83], v[116:119], v[36:39]
    ds_read2_b32 v[22:23], v54 offset0:34 offset1:35
    s_add_u32 s93, s90, 2097152
    v_mfma_f32_16x16x32_bf16 v[40:43], v[80:83], v[92:95], v[40:43]
    ds_read_b128 v[24:27], v56 offset:1152
    buffer_load_dwordx4 v[140:143], v59, s[32:35], s93 offen sc1
    v_mfma_f32_16x16x32_bf16 v[44:47], v[80:83], v[72:75], v[44:47]
    ds_read2_b32 v[28:29], v54 offset0:160 offset1:161
    v_mfma_f32_16x16x32_bf16 v[48:51], v[80:83], v[88:91], v[48:51]
    ds_read2_b32 v[30:31], v54 offset0:162 offset1:163
    v_mfma_f32_16x16x32_bf16 v[36:39], v[64:67], v[92:95], v[36:39]
    ds_read_b128 v[32:35], v56 offset:1664
    v_mfma_f32_16x16x32_bf16 v[40:43], v[64:67], v[72:75], v[40:43]
    ds_read2_b32 v[108:109], v53 offset0:32 offset1:33
    v_mfma_f32_16x16x32_bf16 v[44:47], v[64:67], v[88:91], v[44:47]
    ds_read2_b32 v[110:111], v53 offset0:34 offset1:35
    v_mfma_f32_16x16x32_bf16 v[36:39], v[104:107], v[72:75], v[36:39]
    ds_read2_b32 v[112:113], v53 offset0:160 offset1:161
    v_mfma_f32_16x16x32_bf16 v[40:43], v[104:107], v[88:91], v[40:43]
    ds_read2_b32 v[114:115], v53 offset0:162 offset1:163
    s_waitcnt lgkmcnt(9)
    v_mfma_f32_16x16x32_bf16 v[36:39], v[68:71], v[88:91], v[36:39]
    ds_read2_b32 v[60:61], v52 offset0:32 offset1:33
    v_mfma_f32_16x16x32_bf16 v[48:51], v[100:103], v[96:99], v[48:51]
    ds_read2_b32 v[62:63], v52 offset0:34 offset1:35
    v_mfma_f32_16x16x32_bf16 v[44:47], v[120:123], v[96:99], v[44:47]
    ds_read2_b32 v[76:77], v52 offset0:160 offset1:161
    s_waitcnt vmcnt(2)
    v_mfma_f32_16x16x32_bf16 v[48:51], v[120:123], v[84:87], v[48:51]
    ds_read2_b32 v[78:79], v52 offset0:162 offset1:163
    s_waitcnt lgkmcnt(9)
    v_mfma_f32_16x16x32_bf16 v[40:43], v[20:23], v[96:99], v[40:43]
    ds_read2_b32 v[116:117], v53 offset0:16 offset1:17
    ds_read_b128 v[136:139], v126 offset:2048
    v_mfma_f32_16x16x32_bf16 v[44:47], v[20:23], v[84:87], v[44:47]
    ds_read2_b32 v[118:119], v53 offset0:18 offset1:19
    v_mfma_f32_16x16x32_bf16 v[48:51], v[20:23], v[24:27], v[48:51]
    ds_read2_b32 v[80:81], v53 offset0:144 offset1:145
    v_mfma_f32_16x16x32_bf16 v[36:39], v[28:31], v[96:99], v[36:39]
    ds_read2_b32 v[82:83], v53 offset0:146 offset1:147
    v_mfma_f32_16x16x32_bf16 v[40:43], v[28:31], v[84:87], v[40:43]
    ds_read2_b32 v[92:93], v52 offset0:16 offset1:17
    v_mfma_f32_16x16x32_bf16 v[44:47], v[28:31], v[24:27], v[44:47]
    ds_read2_b32 v[94:95], v52 offset0:18 offset1:19
    s_waitcnt lgkmcnt(10)
    v_mfma_f32_16x16x32_bf16 v[48:51], v[28:31], v[32:35], v[48:51]
    ds_read2_b32 v[64:65], v52 offset0:144 offset1:145
    s_waitcnt lgkmcnt(6)
    v_mfma_f32_16x16x32_bf16 v[36:39], v[108:111], v[84:87], v[36:39]
    ds_read2_b32 v[66:67], v52 offset0:146 offset1:147
    v_max3_u32 v125, v136, v137, v138
    v_mfma_f32_16x16x32_bf16 v[40:43], v[108:111], v[24:27], v[40:43]
    ds_read2_b32 v[72:73], v53 offset0:0 offset1:1
    v_max_u32 v125, v125, v139
    v_mfma_f32_16x16x32_bf16 v[44:47], v[108:111], v[32:35], v[44:47]
    v_cmp_eq_u32 vcc, -1, v125
    s_cbranch_vccnz L_re_135
L_bk_136:
    v_mfma_f32_16x16x32_bf16 v[36:39], v[112:115], v[24:27], v[36:39]
    ds_read2_b32 v[74:75], v53 offset0:2 offset1:3
    s_barrier
    v_mfma_f32_16x16x32_bf16 v[40:43], v[112:115], v[32:35], v[40:43]
    ds_read_b128 v[104:107], v56 offset:2176
    v_mfma_f32_16x16x32_bf16 v[36:39], v[60:63], v[32:35], v[36:39]
    ds_read_b128 v[88:91], v56 offset:2688
    s_waitcnt lgkmcnt(1)
    v_mfma_f32_16x16x32_bf16 v[48:51], v[108:111], v[104:107], v[48:51]
    ds_read_b128 v[68:71], v56 offset:3200
    v_mfma_f32_16x16x32_bf16 v[44:47], v[112:115], v[104:107], v[44:47]
    ds_read_b128 v[100:103], v56 offset:3712
    s_waitcnt lgkmcnt(2)
    v_mfma_f32_16x16x32_bf16 v[48:51], v[112:115], v[88:91], v[48:51]
    ds_read_b128 v[120:123], v56 offset:2112
    v_mfma_f32_16x16x32_bf16 v[40:43], v[60:63], v[104:107], v[40:43]
    ds_read_b128 v[20:23], v56 offset:2624
    v_mfma_f32_16x16x32_bf16 v[44:47], v[60:63], v[88:91], v[44:47]
    ds_read_b128 v[96:99], v56 offset:3136
    s_waitcnt lgkmcnt(4)
    v_mfma_f32_16x16x32_bf16 v[48:51], v[60:63], v[68:71], v[48:51]
    ds_read_b128 v[28:31], v56 offset:3648
    v_mfma_f32_16x16x32_bf16 v[36:39], v[76:79], v[104:107], v[36:39]
    ds_read_b128 v[84:87], v56 offset:2048
    v_mfma_f32_16x16x32_bf16 v[40:43], v[76:79], v[88:91], v[40:43]
    ds_read2_b32 v[24:25], v53 offset0:128 offset1:129
    v_mfma_f32_16x16x32_bf16 v[44:47], v[76:79], v[68:71], v[44:47]
    ds_read2_b32 v[26:27], v53 offset0:130 offset1:131
    s_waitcnt lgkmcnt(7)
    v_mfma_f32_16x16x32_bf16 v[48:51], v[76:79], v[100:103], v[48:51]
    ds_read_b128 v[32:35], v56 offset:2560
    s_waitcnt lgkmcnt(7)
    v_mfma_f32_16x16x32_bf16 v[48:51], v[116:119], v[120:123], v[48:51]
    ds_read2_b32 v[108:109], v52 offset0:0 offset1:1
    v_mfma_f32_16x16x32_bf16 v[44:47], v[80:83], v[120:123], v[44:47]
    ds_read2_b32 v[110:111], v52 offset0:2 offset1:3
    s_waitcnt lgkmcnt(8)
    v_mfma_f32_16x16x32_bf16 v[48:51], v[80:83], v[20:23], v[48:51]
    ds_read_b128 v[112:115], v56 offset:3072
    v_mfma_f32_16x16x32_bf16 v[40:43], v[92:95], v[120:123], v[40:43]
    ds_read2_b32 v[60:61], v52 offset0:128 offset1:129
    v_mfma_f32_16x16x32_bf16 v[44:47], v[92:95], v[20:23], v[44:47]
    ds_read2_b32 v[62:63], v52 offset0:130 offset1:131
    s_waitcnt lgkmcnt(9)
    v_mfma_f32_16x16x32_bf16 v[48:51], v[92:95], v[96:99], v[48:51]
    ds_read_b128 v[104:107], v56 offset:3584
    v_mfma_f32_16x16x32_bf16 v[36:39], v[64:67], v[120:123], v[36:39]
    ds_read2_b32 v[88:89], v55 offset0:48 offset1:49
    v_mfma_f32_16x16x32_bf16 v[40:43], v[64:67], v[20:23], v[40:43]
    ds_read2_b32 v[90:91], v55 offset0:50 offset1:51
    v_mfma_f32_16x16x32_bf16 v[44:47], v[64:67], v[96:99], v[44:47]
    ds_read_b128 v[68:71], v56 offset:192
    v_mfma_f32_16x16x32_bf16 v[48:51], v[64:67], v[28:31], v[48:51]
    ds_read2_b32 v[76:77], v55 offset0:176 offset1:177
    s_waitcnt lgkmcnt(9)
    v_mfma_f32_16x16x32_bf16 v[48:51], v[72:75], v[84:87], v[48:51]
    ds_read2_b32 v[78:79], v55 offset0:178 offset1:179
    v_mfma_f32_16x16x32_bf16 v[44:47], v[24:27], v[84:87], v[44:47]
    ds_read_b128 v[100:103], v56 offset:704
    v_mfma_f32_16x16x32_bf16 v[48:51], v[24:27], v[32:35], v[48:51]
    ds_read2_b32 v[116:117], v54 offset0:48 offset1:49
    s_waitcnt lgkmcnt(9)
    v_mfma_f32_16x16x32_bf16 v[40:43], v[108:111], v[84:87], v[40:43]
    ds_read2_b32 v[118:119], v54 offset0:50 offset1:51
    v_mfma_f32_16x16x32_bf16 v[44:47], v[108:111], v[32:35], v[44:47]
    ds_read_b128 v[80:83], v56 offset:1216
    v_mfma_f32_16x16x32_bf16 v[48:51], v[108:111], v[112:115], v[48:51]
    ds_read2_b32 v[92:93], v54 offset0:176 offset1:177
    s_waitcnt lgkmcnt(9)
    v_mfma_f32_16x16x32_bf16 v[36:39], v[60:63], v[84:87], v[36:39]
    ds_read2_b32 v[94:95], v54 offset0:178 offset1:179
    v_mfma_f32_16x16x32_bf16 v[40:43], v[60:63], v[32:35], v[40:43]
    ds_read_b128 v[120:123], v56 offset:1728
    v_mfma_f32_16x16x32_bf16 v[44:47], v[60:63], v[112:115], v[44:47]
    ds_read2_b32 v[20:21], v53 offset0:48 offset1:49
    v_mfma_f32_16x16x32_bf16 v[48:51], v[60:63], v[104:107], v[48:51]
    ds_read2_b32 v[22:23], v53 offset0:50 offset1:51
    s_waitcnt lgkmcnt(9)
    v_mfma_f32_16x16x32_bf16 v[48:51], v[88:91], v[68:71], v[48:51]
    ds_read_b128 v[96:99], v56 offset:2240
    s_waitcnt lgkmcnt(9)
    v_mfma_f32_16x16x32_bf16 v[48:51], v[76:79], v[100:103], v[48:51]
    ds_read2_b32 v[64:65], v53 offset0:176 offset1:177
    s_waitcnt lgkmcnt(7)
    v_mfma_f32_16x16x32_bf16 v[48:51], v[116:119], v[80:83], v[48:51]
    ds_read2_b32 v[66:67], v53 offset0:178 offset1:179
    s_waitcnt lgkmcnt(6)
    v_mfma_f32_16x16x32_bf16 v[36:39], v[92:95], v[68:71], v[36:39]
    ds_read_b128 v[28:31], v56 offset:2752
    s_waitcnt lgkmcnt(6)
    v_mfma_f32_16x16x32_bf16 v[48:51], v[92:95], v[120:123], v[48:51]
    ds_read2_b32 v[72:73], v52 offset0:48 offset1:49
    s_waitcnt lgkmcnt(5)
    v_mfma_f32_16x16x32_bf16 v[36:39], v[20:23], v[100:103], v[36:39]
    ds_read2_b32 v[74:75], v52 offset0:50 offset1:51
    s_waitcnt lgkmcnt(5)
    v_mfma_f32_16x16x32_bf16 v[48:51], v[20:23], v[96:99], v[48:51]
    ds_read_b128 v[24:27], v56 offset:3264
    s_waitcnt lgkmcnt(4)
    v_mfma_f32_16x16x32_bf16 v[36:39], v[64:67], v[80:83], v[36:39]
    ds_read2_b32 v[108:109], v52 offset0:176 offset1:177
    s_waitcnt lgkmcnt(4)
    v_mfma_f32_16x16x32_bf16 v[48:51], v[64:67], v[28:31], v[48:51]
    ds_read2_b32 v[110:111], v52 offset0:178 offset1:179
    s_waitcnt lgkmcnt(3)
    v_mfma_f32_16x16x32_bf16 v[36:39], v[72:75], v[120:123], v[36:39]
    ds_read_b128 v[84:87], v56 offset:3776
    s_waitcnt lgkmcnt(3)
    v_mfma_f32_16x16x32_bf16 v[48:51], v[72:75], v[24:27], v[48:51]
    s_waitcnt vmcnt(0)
    s_waitcnt lgkmcnt(1)
    v_mfma_f32_16x16x32_bf16 v[36:39], v[108:111], v[96:99], v[36:39]
    v_max3_u32 v125, v140, v141, v142
    s_waitcnt lgkmcnt(0)
    v_mfma_f32_16x16x32_bf16 v[48:51], v[108:111], v[84:87], v[48:51]
    v_max_u32 v125, v125, v143
    v_cmp_eq_u32 vcc, -1, v125
    s_cbranch_vccnz L_re_133
L_bk_134:
    v_mfma_f32_16x16x32_bf16 v[44:47], v[76:79], v[68:71], v[44:47]
    s_add_u32 m0, s20, 0
    s_add_u32 s76, s15, 0
    v_mfma_f32_16x16x32_bf16 v[40:43], v[116:119], v[68:71], v[40:43]
    buffer_load_dwordx4 v127, s[32:35], s76 offen offset:0 sc1 lds
    s_add_u32 s76, s15, 64512
    v_mfma_f32_16x16x32_bf16 v[44:47], v[116:119], v[100:103], v[44:47]
    buffer_load_dwordx4 v127, s[32:35], s76 offen offset:1024 sc1 lds
    s_add_u32 s76, s15, 129024
    v_mfma_f32_16x16x32_bf16 v[40:43], v[92:95], v[100:103], v[40:43]
    buffer_load_dwordx4 v127, s[32:35], s76 offen offset:2048 sc1 lds
    s_add_u32 s76, s15, 193536
    v_mfma_f32_16x16x32_bf16 v[44:47], v[92:95], v[80:83], v[44:47]
    buffer_load_dwordx4 v127, s[32:35], s76 offen offset:3072 sc1 lds
    v_mfma_f32_16x16x32_bf16 v[40:43], v[20:23], v[80:83], v[40:43]
    ds_write_b128 v57, v[36:39] offset:6144
    s_add_u32 m0, s20, 16384
    v_mfma_f32_16x16x32_bf16 v[44:47], v[20:23], v[120:123], v[44:47]
    s_add_u32 s76, s52, 0
    buffer_load_dwordx4 v127, s[32:35], s76 offen offset:0 sc1 lds
    v_mfma_f32_16x16x32_bf16 v[40:43], v[64:67], v[120:123], v[40:43]
    ds_write_b128 v57, v[48:51] offset:7168
    s_add_u32 s76, s52, 64512
    v_mfma_f32_16x16x32_bf16 v[44:47], v[64:67], v[96:99], v[44:47]
    buffer_load_dwordx4 v127, s[32:35], s76 offen offset:1024 sc1 lds
    v_mfma_f32_16x16x32_bf16 v[40:43], v[72:75], v[96:99], v[40:43]
    s_waitcnt lgkmcnt(0)
    s_barrier
    v_mfma_f32_16x16x32_bf16 v[44:47], v[72:75], v[28:31], v[44:47]
    ds_read_b128 v[36:39], v57 offset:2048
    v_mfma_f32_16x16x32_bf16 v[40:43], v[108:111], v[28:31], v[40:43]
    ds_read_b128 v[48:51], v57 offset:3072
    s_add_u32 s76, s52, 129024
    v_mfma_f32_16x16x32_bf16 v[44:47], v[108:111], v[24:27], v[44:47]
    buffer_load_dwordx4 v127, s[32:35], s76 offen offset:2048 sc1 lds
    s_add_u32 s76, s52, 193536
    v_mfma_f32_16x16x32_bf16 v[40:43], v[128:131], v[140:143], v[40:43]
    buffer_load_dwordx4 v127, s[32:35], s76 offen offset:3072 sc1 lds
    v_mfma_f32_16x16x32_bf16 v[44:47], v[132:135], v[140:143], v[44:47]
    s_waitcnt lgkmcnt(0)
    s_nop 4
    v_pk_add_f32 v[36:37], v[36:37], v[40:41]
    v_pk_add_f32 v[38:39], v[38:39], v[42:43]
    v_cvt_pk_bf16_f32 v36, v36, v37
    v_cvt_pk_bf16_f32 v37, v38, v39
    v_pk_add_f32 v[48:49], v[48:49], v[44:45]
    v_pk_add_f32 v[50:51], v[50:51], v[46:47]
    v_cvt_pk_bf16_f32 v38, v48, v49
    v_cvt_pk_bf16_f32 v39, v50, v51
    s_nop 0
    v_permlane16_swap_b32 v36, v38
    v_permlane16_swap_b32 v37, v39
    v_or_b32 v36, 1, v36
    buffer_store_dwordx4 v[36:39], v58, s[32:35], s77 offen offset:2048 sc1
L_tkhj_124:
    v_mov_b32 v100, v127
    v_lshlrev_b32 v143, 4, v1
    v_add_u32 v101, s20, v143
    v_lshlrev_b32 v103, 2, v1
    v_and_b32 v103, 60, v103
    v_add_u32 v103, 25856, v103
    s_waitcnt vmcnt(5)
    ds_read2st64_b32 v[104:105], v101 offset0:0 offset1:4
    ds_read2st64_b32 v[106:107], v101 offset0:8 offset1:12
    s_waitcnt lgkmcnt(0)
    v_and_b32 v104, v104, v105
    v_bitop3_b32 v102, v104, v106, v107 bitop3:0x7f
    v_or_b32 v102, -2, v102
    v_cmp_eq_u32 vcc, -1, v102
    s_cbranch_vccnz L_re_137
L_bk_138:
    s_barrier
    s_cmp_eq_u32 s48, 3
    s_cbranch_scc1 L_g1w3_139
    ds_read_b64_tr_b16 v[68:69], v14 offset:0
    ds_read_b64_tr_b16 v[70:71], v14 offset:1024
    ds_read_b64_tr_b16 v[72:73], v15 offset:0
    ds_read_b64_tr_b16 v[74:75], v15 offset:1024
    ds_read_b64_tr_b16 v[76:77], v14 offset:2048
    ds_read_b64_tr_b16 v[78:79], v14 offset:3072
    s_waitcnt lgkmcnt(4)
    v_mfma_f32_16x16x32_bf16 v[20:23], a[176:179], v[68:71], 0
    ds_read_b64_tr_b16 v[80:81], v15 offset:2048
    v_mfma_f32_16x16x32_bf16 v[36:39], a[240:243], v[68:71], 0
    ds_read_b64_tr_b16 v[82:83], v15 offset:3072
    v_mfma_f32_16x16x32_bf16 v[52:55], v[192:195], v[68:71], 0
    ds_read_b64_tr_b16 v[84:85], v14 offset:4096
    s_waitcnt lgkmcnt(5)
    v_mfma_f32_16x16x32_bf16 v[24:27], a[176:179], v[72:75], 0
    ds_read_b64_tr_b16 v[86:87], v14 offset:5120
    v_mfma_f32_16x16x32_bf16 v[40:43], a[240:243], v[72:75], 0
    ds_read_b64_tr_b16 v[88:89], v15 offset:4096
    v_mfma_f32_16x16x32_bf16 v[56:59], v[192:195], v[72:75], 0
    ds_read_b64_tr_b16 v[90:91], v15 offset:5120
    s_waitcnt lgkmcnt(6)
    v_mfma_f32_16x16x32_bf16 v[20:23], a[180:183], v[76:79], v[20:23]
    ds_read_b64_tr_b16 v[92:93], v14 offset:6144
    v_mfma_f32_16x16x32_bf16 v[36:39], a[244:247], v[76:79], v[36:39]
    ds_read_b64_tr_b16 v[94:95], v14 offset:7168
    v_mfma_f32_16x16x32_bf16 v[52:55], v[196:199], v[76:79], v[52:55]
    ds_read_b64_tr_b16 v[96:97], v15 offset:6144
    s_waitcnt lgkmcnt(7)
    v_mfma_f32_16x16x32_bf16 v[24:27], a[180:183], v[80:83], v[24:27]
    ds_read_b64_tr_b16 v[98:99], v15 offset:7168
    v_mfma_f32_16x16x32_bf16 v[40:43], a[244:247], v[80:83], v[40:43]
    ds_read_b64_tr_b16 v[68:69], v14 offset:8192
    v_mfma_f32_16x16x32_bf16 v[56:59], v[196:199], v[80:83], v[56:59]
    ds_read_b64_tr_b16 v[70:71], v14 offset:9216
    s_waitcnt lgkmcnt(8)
    v_mfma_f32_16x16x32_bf16 v[20:23], a[184:187], v[84:87], v[20:23]
    ds_read_b64_tr_b16 v[72:73], v15 offset:8192
    v_mfma_f32_16x16x32_bf16 v[36:39], a[248:251], v[84:87], v[36:39]
    ds_read_b64_tr_b16 v[74:75], v15 offset:9216
    v_mfma_f32_16x16x32_bf16 v[52:55], v[200:203], v[84:87], v[52:55]
    ds_read_b64_tr_b16 v[76:77], v14 offset:10240
    s_waitcnt lgkmcnt(9)
    v_mfma_f32_16x16x32_bf16 v[24:27], a[184:187], v[88:91], v[24:27]
    ds_read_b64_tr_b16 v[78:79], v14 offset:11264
    v_mfma_f32_16x16x32_bf16 v[40:43], a[248:251], v[88:91], v[40:43]
    ds_read_b64_tr_b16 v[80:81], v15 offset:10240
    v_mfma_f32_16x16x32_bf16 v[56:59], v[200:203], v[88:91], v[56:59]
    ds_read_b64_tr_b16 v[82:83], v15 offset:11264
    s_waitcnt lgkmcnt(9)
    v_mfma_f32_16x16x32_bf16 v[20:23], a[188:191], v[92:95], v[20:23]
    ds_read_b64_tr_b16 v[84:85], v14 offset:12288
    v_mfma_f32_16x16x32_bf16 v[36:39], a[252:255], v[92:95], v[36:39]
    ds_read_b64_tr_b16 v[86:87], v14 offset:13312
    s_waitcnt vmcnt(1)
    v_mfma_f32_16x16x32_bf16 v[52:55], v[204:207], v[92:95], v[52:55]
    ds_read_b64_tr_b16 v[88:89], v15 offset:12288
    s_waitcnt lgkmcnt(9)
    v_mfma_f32_16x16x32_bf16 v[24:27], a[188:191], v[96:99], v[24:27]
    ds_read_b64_tr_b16 v[90:91], v15 offset:13312
    ds_read2st64_b32 v[104:105], v101 offset0:64 offset1:68
    v_mfma_f32_16x16x32_bf16 v[40:43], a[252:255], v[96:99], v[40:43]
    ds_read2st64_b32 v[106:107], v101 offset0:72 offset1:76
    v_mfma_f32_16x16x32_bf16 v[56:59], v[204:207], v[96:99], v[56:59]
    ds_read_b64_tr_b16 v[92:93], v14 offset:14336
    v_mfma_f32_16x16x32_bf16 v[20:23], a[192:195], v[68:71], v[20:23]
    ds_read_b64_tr_b16 v[94:95], v14 offset:15360
    v_mfma_f32_16x16x32_bf16 v[36:39], v[144:147], v[68:71], v[36:39]
    v_mfma_f32_16x16x32_bf16 v[52:55], v[208:211], v[68:71], v[52:55]
    ds_read_b64_tr_b16 v[96:97], v15 offset:14336
    s_waitcnt lgkmcnt(9)
    v_mfma_f32_16x16x32_bf16 v[24:27], a[192:195], v[72:75], v[24:27]
    ds_read_b64_tr_b16 v[98:99], v15 offset:15360
    s_waitcnt lgkmcnt(4)
    v_mfma_f32_16x16x32_bf16 v[40:43], v[144:147], v[72:75], v[40:43]
    v_and_b32 v104, v104, v105
    v_bitop3_b32 v102, v104, v106, v107 bitop3:0x7f
    v_mfma_f32_16x16x32_bf16 v[56:59], v[208:211], v[72:75], v[56:59]
    v_or_b32 v102, -2, v102
    v_mfma_f32_16x16x32_bf16 v[20:23], a[196:199], v[76:79], v[20:23]
    v_cmp_eq_u32 vcc, -1, v102
    s_cbranch_vccnz L_re_141
L_bk_142:
    s_barrier
    v_mfma_f32_16x16x32_bf16 v[36:39], v[148:151], v[76:79], v[36:39]
    ds_read_b64_tr_b16 v[68:69], v14 offset:16384
    v_mfma_f32_16x16x32_bf16 v[52:55], v[212:215], v[76:79], v[52:55]
    ds_read_b64_tr_b16 v[70:71], v14 offset:17408
    v_mfma_f32_16x16x32_bf16 v[24:27], a[196:199], v[80:83], v[24:27]
    ds_read_b64_tr_b16 v[72:73], v15 offset:16384
    v_mfma_f32_16x16x32_bf16 v[40:43], v[148:151], v[80:83], v[40:43]
    ds_read_b64_tr_b16 v[74:75], v15 offset:17408
    v_mfma_f32_16x16x32_bf16 v[56:59], v[212:215], v[80:83], v[56:59]
    ds_read_b64_tr_b16 v[76:77], v14 offset:18432
    v_mfma_f32_16x16x32_bf16 v[20:23], a[200:203], v[84:87], v[20:23]
    ds_read_b64_tr_b16 v[78:79], v14 offset:19456
    v_mfma_f32_16x16x32_bf16 v[36:39], v[152:155], v[84:87], v[36:39]
    v_mfma_f32_16x16x32_bf16 v[52:55], v[216:219], v[84:87], v[52:55]
    ds_read_b64_tr_b16 v[80:81], v15 offset:18432
    v_mfma_f32_16x16x32_bf16 v[24:27], a[200:203], v[88:91], v[24:27]
    ds_read_b64_tr_b16 v[82:83], v15 offset:19456
    s_add_u32 m0, s20, 32768
    v_mfma_f32_16x16x32_bf16 v[40:43], v[152:155], v[88:91], v[40:43]
    s_add_u32 s76, s15, 2048
    buffer_load_dwordx4 v100, s[32:35], s76 offen offset:0 sc1 lds
    v_mfma_f32_16x16x32_bf16 v[56:59], v[216:219], v[88:91], v[56:59]
    ds_read_b64_tr_b16 v[84:85], v14 offset:20480
    s_waitcnt lgkmcnt(7)
    v_mfma_f32_16x16x32_bf16 v[20:23], a[204:207], v[92:95], v[20:23]
    ds_read_b64_tr_b16 v[86:87], v14 offset:21504
    s_add_u32 s76, s15, 66560
    v_mfma_f32_16x16x32_bf16 v[36:39], v[156:159], v[92:95], v[36:39]
    buffer_load_dwordx4 v100, s[32:35], s76 offen offset:1024 sc1 lds
    v_mfma_f32_16x16x32_bf16 v[52:55], v[220:223], v[92:95], v[52:55]
    ds_read_b64_tr_b16 v[88:89], v15 offset:20480
    v_mfma_f32_16x16x32_bf16 v[24:27], a[204:207], v[96:99], v[24:27]
    ds_read_b64_tr_b16 v[90:91], v15 offset:21504
    s_add_u32 s76, s15, 131072
    v_mfma_f32_16x16x32_bf16 v[40:43], v[156:159], v[96:99], v[40:43]
    buffer_load_dwordx4 v100, s[32:35], s76 offen offset:2048 sc1 lds
    v_mfma_f32_16x16x32_bf16 v[56:59], v[220:223], v[96:99], v[56:59]
    ds_read_b64_tr_b16 v[92:93], v14 offset:22528
    v_mfma_f32_16x16x32_bf16 v[20:23], a[208:211], v[68:71], v[20:23]
    ds_read_b64_tr_b16 v[94:95], v14 offset:23552
    s_add_u32 s76, s15, 195584
    v_mfma_f32_16x16x32_bf16 v[36:39], v[160:163], v[68:71], v[36:39]
    buffer_load_dwordx4 v100, s[32:35], s76 offen offset:3072 sc1 lds
    v_mfma_f32_16x16x32_bf16 v[52:55], v[224:227], v[68:71], v[52:55]
    ds_read_b64_tr_b16 v[96:97], v15 offset:22528
    s_waitcnt lgkmcnt(6)
    v_mfma_f32_16x16x32_bf16 v[24:27], a[208:211], v[72:75], v[24:27]
    ds_read_b64_tr_b16 v[98:99], v15 offset:23552
    s_add_u32 m0, s20, 49152
    v_mfma_f32_16x16x32_bf16 v[40:43], v[160:163], v[72:75], v[40:43]
    s_add_u32 s76, s52, 2048
    buffer_load_dwordx4 v100, s[32:35], s76 offen offset:0 sc1 lds
    v_mfma_f32_16x16x32_bf16 v[56:59], v[224:227], v[72:75], v[56:59]
    ds_read_b64_tr_b16 v[68:69], v14 offset:24576
    v_mfma_f32_16x16x32_bf16 v[20:23], a[212:215], v[76:79], v[20:23]
    ds_read_b64_tr_b16 v[70:71], v14 offset:25600
    s_add_u32 s76, s52, 66560
    v_mfma_f32_16x16x32_bf16 v[36:39], v[164:167], v[76:79], v[36:39]
    buffer_load_dwordx4 v100, s[32:35], s76 offen offset:1024 sc1 lds
    v_mfma_f32_16x16x32_bf16 v[52:55], v[228:231], v[76:79], v[52:55]
    ds_read_b64_tr_b16 v[72:73], v15 offset:24576
    v_mfma_f32_16x16x32_bf16 v[24:27], a[212:215], v[80:83], v[24:27]
    ds_read_b64_tr_b16 v[74:75], v15 offset:25600
    s_add_u32 s76, s52, 131072
    v_mfma_f32_16x16x32_bf16 v[40:43], v[164:167], v[80:83], v[40:43]
    buffer_load_dwordx4 v100, s[32:35], s76 offen offset:2048 sc1 lds
    v_mfma_f32_16x16x32_bf16 v[56:59], v[228:231], v[80:83], v[56:59]
    ds_read_b64_tr_b16 v[76:77], v14 offset:26624
    s_waitcnt lgkmcnt(6)
    v_mfma_f32_16x16x32_bf16 v[20:23], a[216:219], v[84:87], v[20:23]
    ds_read_b64_tr_b16 v[78:79], v14 offset:27648
    s_add_u32 s76, s52, 195584
    v_mfma_f32_16x16x32_bf16 v[36:39], v[168:171], v[84:87], v[36:39]
    buffer_load_dwordx4 v100, s[32:35], s76 offen offset:3072 sc1 lds
L_stub_8:
    s_cbranch_execz L_warm_back
    s_nop 0
    v_mfma_f32_16x16x32_bf16 v[52:55], v[232:235], v[84:87], v[52:55]
    ds_read_b64_tr_b16 v[80:81], v15 offset:26624
    v_mfma_f32_16x16x32_bf16 v[24:27], a[216:219], v[88:91], v[24:27]
    ds_read_b64_tr_b16 v[82:83], v15 offset:27648
    v_mfma_f32_16x16x32_bf16 v[40:43], v[168:171], v[88:91], v[40:43]
    v_mfma_f32_16x16x32_bf16 v[56:59], v[232:235], v[88:91], v[56:59]
    ds_read_b64_tr_b16 v[84:85], v14 offset:28672
    v_mfma_f32_16x16x32_bf16 v[20:23], a[220:223], v[92:95], v[20:23]
    ds_read_b64_tr_b16 v[86:87], v14 offset:29696
    v_mfma_f32_16x16x32_bf16 v[36:39], v[172:175], v[92:95], v[36:39]
    v_mfma_f32_16x16x32_bf16 v[52:55], v[236:239], v[92:95], v[52:55]
    ds_read_b64_tr_b16 v[88:89], v15 offset:28672
    s_waitcnt lgkmcnt(6)
    v_mfma_f32_16x16x32_bf16 v[24:27], a[220:223], v[96:99], v[24:27]
    ds_read_b64_tr_b16 v[90:91], v15 offset:29696
    v_mfma_f32_16x16x32_bf16 v[40:43], v[172:175], v[96:99], v[40:43]
    v_mfma_f32_16x16x32_bf16 v[56:59], v[236:239], v[96:99], v[56:59]
    ds_read_b64_tr_b16 v[92:93], v14 offset:30720
    v_mfma_f32_16x16x32_bf16 v[20:23], a[224:227], v[68:71], v[20:23]
    ds_read_b64_tr_b16 v[94:95], v14 offset:31744
    v_mfma_f32_16x16x32_bf16 v[36:39], v[176:179], v[68:71], v[36:39]
    v_mfma_f32_16x16x32_bf16 v[52:55], v[240:243], v[68:71], v[52:55]
    ds_read_b64_tr_b16 v[96:97], v15 offset:30720
    v_mfma_f32_16x16x32_bf16 v[24:27], a[224:227], v[72:75], v[24:27]
    ds_read_b64_tr_b16 v[98:99], v15 offset:31744
    v_mfma_f32_16x16x32_bf16 v[40:43], v[176:179], v[72:75], v[40:43]
    v_mfma_f32_16x16x32_bf16 v[56:59], v[240:243], v[72:75], v[56:59]
    s_waitcnt lgkmcnt(5)
    v_mfma_f32_16x16x32_bf16 v[20:23], a[228:231], v[76:79], v[20:23]
    v_mfma_f32_16x16x32_bf16 v[36:39], v[180:183], v[76:79], v[36:39]
    s_waitcnt vmcnt(4)
    ds_read2st64_b32 v[104:105], v101 offset0:128 offset1:132
    v_mfma_f32_16x16x32_bf16 v[52:55], v[244:247], v[76:79], v[52:55]
    ds_read2st64_b32 v[106:107], v101 offset0:136 offset1:140
    v_mfma_f32_16x16x32_bf16 v[24:27], a[228:231], v[80:83], v[24:27]
    v_mfma_f32_16x16x32_bf16 v[40:43], v[180:183], v[80:83], v[40:43]
    v_mfma_f32_16x16x32_bf16 v[56:59], v[244:247], v[80:83], v[56:59]
    v_mfma_f32_16x16x32_bf16 v[20:23], a[232:235], v[84:87], v[20:23]
    v_mfma_f32_16x16x32_bf16 v[36:39], v[184:187], v[84:87], v[36:39]
    v_mfma_f32_16x16x32_bf16 v[52:55], v[248:251], v[84:87], v[52:55]
    s_waitcnt lgkmcnt(2)
    v_mfma_f32_16x16x32_bf16 v[24:27], a[232:235], v[88:91], v[24:27]
    s_waitcnt lgkmcnt(0)
    v_mfma_f32_16x16x32_bf16 v[40:43], v[184:187], v[88:91], v[40:43]
    v_and_b32 v104, v104, v105
    v_bitop3_b32 v102, v104, v106, v107 bitop3:0x7f
    v_mfma_f32_16x16x32_bf16 v[56:59], v[248:251], v[88:91], v[56:59]
    v_or_b32 v102, -2, v102
    v_mfma_f32_16x16x32_bf16 v[20:23], a[236:239], v[92:95], v[20:23]
    v_cmp_eq_u32 vcc, -1, v102
    s_cbranch_vccnz L_re_143
L_bk_144:
    s_barrier
    v_mfma_f32_16x16x32_bf16 v[36:39], v[188:191], v[92:95], v[36:39]
    ds_read_b64_tr_b16 v[68:69], v14 offset:32768
    v_mfma_f32_16x16x32_bf16 v[52:55], v[252:255], v[92:95], v[52:55]
    ds_read_b64_tr_b16 v[70:71], v14 offset:33792
    v_mfma_f32_16x16x32_bf16 v[24:27], a[236:239], v[96:99], v[24:27]
    ds_read_b64_tr_b16 v[72:73], v15 offset:32768
    v_mfma_f32_16x16x32_bf16 v[40:43], v[188:191], v[96:99], v[40:43]
    ds_read_b64_tr_b16 v[74:75], v15 offset:33792
    v_mfma_f32_16x16x32_bf16 v[56:59], v[252:255], v[96:99], v[56:59]
    ds_read_b64_tr_b16 v[76:77], v14 offset:34816
    s_waitcnt lgkmcnt(3)
    v_mfma_f32_16x16x32_bf16 v[28:31], a[176:179], v[68:71], 0
    ds_read_b64_tr_b16 v[78:79], v14 offset:35840
    v_mfma_f32_16x16x32_bf16 v[44:47], a[240:243], v[68:71], 0
    ds_read_b64_tr_b16 v[80:81], v15 offset:34816
    v_mfma_f32_16x16x32_bf16 v[60:63], v[192:195], v[68:71], 0
    ds_read_b64_tr_b16 v[82:83], v15 offset:35840
    s_waitcnt lgkmcnt(4)
    v_mfma_f32_16x16x32_bf16 v[32:35], a[176:179], v[72:75], 0
    ds_read_b64_tr_b16 v[84:85], v14 offset:36864
    v_mfma_f32_16x16x32_bf16 v[48:51], a[240:243], v[72:75], 0
    ds_read_b64_tr_b16 v[86:87], v14 offset:37888
    s_barrier
    v_mfma_f32_16x16x32_bf16 v[64:67], v[192:195], v[72:75], 0
    ds_read_b64_tr_b16 v[88:89], v15 offset:36864
    s_waitcnt lgkmcnt(5)
    v_mfma_f32_16x16x32_bf16 v[28:31], a[180:183], v[76:79], v[28:31]
    ds_read_b64_tr_b16 v[90:91], v15 offset:37888
    ds_read2_b32 v[136:137], v103 offset0:0 offset1:16
    v_mfma_f32_16x16x32_bf16 v[44:47], a[244:247], v[76:79], v[44:47]
    ds_read_b64_tr_b16 v[92:93], v14 offset:38912
    v_mfma_f32_16x16x32_bf16 v[60:63], v[196:199], v[76:79], v[60:63]
    ds_read_b64_tr_b16 v[94:95], v14 offset:39936
    s_waitcnt lgkmcnt(7)
    v_mfma_f32_16x16x32_bf16 v[32:35], a[180:183], v[80:83], v[32:35]
    ds_read_b64_tr_b16 v[96:97], v15 offset:38912
    v_mfma_f32_16x16x32_bf16 v[48:51], a[244:247], v[80:83], v[48:51]
    ds_read_b64_tr_b16 v[98:99], v15 offset:39936
    s_waitcnt lgkmcnt(4)
    v_mfma_f32_16x16x32_bf16 v[64:67], v[196:199], v[80:83], v[64:67]
    ds_read_b64_tr_b16 v[68:69], v14 offset:40960
    v_fma_f32 v20, -v136, v2, v20
    v_mfma_f32_16x16x32_bf16 v[28:31], a[184:187], v[84:87], v[28:31]
    ds_read_b64_tr_b16 v[70:71], v14 offset:41984
    v_fma_f32 v21, -v136, v3, v21
    v_mfma_f32_16x16x32_bf16 v[44:47], a[248:251], v[84:87], v[44:47]
    ds_read_b64_tr_b16 v[72:73], v15 offset:40960
    v_fma_f32 v22, -v136, v4, v22
    v_mfma_f32_16x16x32_bf16 v[60:63], v[200:203], v[84:87], v[60:63]
    ds_read_b64_tr_b16 v[74:75], v15 offset:41984
    v_fma_f32 v23, -v136, v5, v23
    v_mfma_f32_16x16x32_bf16 v[32:35], a[184:187], v[88:91], v[32:35]
    ds_read_b64_tr_b16 v[76:77], v14 offset:43008
    v_cvt_pk_bf16_f32 v20, v20, v21
    v_mfma_f32_16x16x32_bf16 v[48:51], a[248:251], v[88:91], v[48:51]
    ds_read_b64_tr_b16 v[78:79], v14 offset:44032
    v_cvt_pk_bf16_f32 v21, v22, v23
    v_mfma_f32_16x16x32_bf16 v[64:67], v[200:203], v[88:91], v[64:67]
    ds_read_b64_tr_b16 v[80:81], v15 offset:43008
    s_waitcnt lgkmcnt(9)
    v_mfma_f32_16x16x32_bf16 v[28:31], a[188:191], v[92:95], v[28:31]
    ds_read_b64_tr_b16 v[82:83], v15 offset:44032
    v_pk_max_i16 v20, v20, 0
    v_mfma_f32_16x16x32_bf16 v[44:47], a[252:255], v[92:95], v[44:47]
    ds_read_b64_tr_b16 v[84:85], v14 offset:45056
    v_pk_max_i16 v21, v21, 0
    v_mfma_f32_16x16x32_bf16 v[60:63], v[204:207], v[92:95], v[60:63]
    v_fma_f32 v36, -v136, v6, v36
    s_waitcnt lgkmcnt(8)
    v_mfma_f32_16x16x32_bf16 v[32:35], a[188:191], v[96:99], v[32:35]
    v_fma_f32 v37, -v136, v7, v37
    v_fma_f32 v38, -v136, v8, v38
    v_mfma_f32_16x16x32_bf16 v[48:51], a[252:255], v[96:99], v[48:51]
    v_fma_f32 v39, -v136, v9, v39
    v_cvt_pk_bf16_f32 v22, v36, v37
    v_mfma_f32_16x16x32_bf16 v[64:67], v[204:207], v[96:99], v[64:67]
    v_cvt_pk_bf16_f32 v23, v38, v39
    s_waitcnt lgkmcnt(5)
    v_mfma_f32_16x16x32_bf16 v[28:31], a[192:195], v[68:71], v[28:31]
    v_pk_max_i16 v22, v22, 0
    v_pk_max_i16 v23, v23, 0
    v_mfma_f32_16x16x32_bf16 v[44:47], v[144:147], v[68:71], v[44:47]
    s_add_u32 s80, s12, 0
    s_cmp_eq_u32 s53, 0
    s_cbranch_scc1 L_hs_156
    buffer_store_dwordx4 v[20:23], v143, s[32:35], s80 offen
L_he_157:
    v_mfma_f32_16x16x32_bf16 v[60:63], v[208:211], v[68:71], v[60:63]
    ds_read_b64_tr_b16 v[86:87], v14 offset:46080
    v_fma_f32 v24, -v137, v2, v24
    v_mfma_f32_16x16x32_bf16 v[32:35], a[192:195], v[72:75], v[32:35]
    v_fma_f32 v25, -v137, v3, v25
    v_fma_f32 v26, -v137, v4, v26
    v_mfma_f32_16x16x32_bf16 v[48:51], v[144:147], v[72:75], v[48:51]
    v_fma_f32 v27, -v137, v5, v27
    v_cvt_pk_bf16_f32 v24, v24, v25
    v_mfma_f32_16x16x32_bf16 v[64:67], v[208:211], v[72:75], v[64:67]
    ds_read_b64_tr_b16 v[88:89], v15 offset:45056
    s_waitcnt lgkmcnt(2)
    v_mfma_f32_16x16x32_bf16 v[28:31], a[196:199], v[76:79], v[28:31]
    ds_read_b64_tr_b16 v[90:91], v15 offset:46080
    v_cvt_pk_bf16_f32 v25, v26, v27
    v_mfma_f32_16x16x32_bf16 v[44:47], v[148:151], v[76:79], v[44:47]
    v_pk_max_i16 v24, v24, 0
    v_pk_max_i16 v25, v25, 0
    v_mfma_f32_16x16x32_bf16 v[60:63], v[212:215], v[76:79], v[60:63]
    ds_read_b64_tr_b16 v[92:93], v14 offset:47104
    v_fma_f32 v40, -v137, v6, v40
    v_mfma_f32_16x16x32_bf16 v[32:35], a[196:199], v[80:83], v[32:35]
    ds_read_b64_tr_b16 v[94:95], v14 offset:48128
    v_fma_f32 v41, -v137, v7, v41
    v_mfma_f32_16x16x32_bf16 v[48:51], v[148:151], v[80:83], v[48:51]
    s_waitcnt vmcnt(1)
    ds_read2st64_b32 v[104:105], v101 offset0:192 offset1:196
    v_mfma_f32_16x16x32_bf16 v[64:67], v[212:215], v[80:83], v[64:67]
    ds_read_b64_tr_b16 v[96:97], v15 offset:47104
    s_waitcnt lgkmcnt(6)
    v_mfma_f32_16x16x32_bf16 v[28:31], a[200:203], v[84:87], v[28:31]
    ds_read_b64_tr_b16 v[98:99], v15 offset:48128
    v_fma_f32 v42, -v137, v8, v42
    v_mfma_f32_16x16x32_bf16 v[44:47], v[152:155], v[84:87], v[44:47]
    v_fma_f32 v43, -v137, v9, v43
    ds_read2st64_b32 v[106:107], v101 offset0:200 offset1:204
    v_mfma_f32_16x16x32_bf16 v[60:63], v[216:219], v[84:87], v[60:63]
    v_cvt_pk_bf16_f32 v26, v40, v41
    s_waitcnt lgkmcnt(6)
    v_mfma_f32_16x16x32_bf16 v[32:35], a[200:203], v[88:91], v[32:35]
    v_cvt_pk_bf16_f32 v27, v42, v43
    v_pk_max_i16 v26, v26, 0
    v_mfma_f32_16x16x32_bf16 v[48:51], v[152:155], v[88:91], v[48:51]
    v_pk_max_i16 v27, v27, 0
    s_add_u32 s80, s12, 65536
    s_cmp_eq_u32 s53, 0
    s_cbranch_scc1 L_hs_160
    buffer_store_dwordx4 v[24:27], v143, s[32:35], s80 offen
L_he_161:
    v_mfma_f32_16x16x32_bf16 v[64:67], v[216:219], v[88:91], v[64:67]
    v_fma_f32 v52, -v136, v10, v52
    v_fma_f32 v53, -v136, v11, v53
    v_fma_f32 v54, -v136, v12, v54
    v_fma_f32 v55, -v136, v13, v55
    v_cvt_pk_bf16_f32 v52, v52, v53
    v_cvt_pk_bf16_f32 v53, v54, v55
    v_pk_max_i16 v52, v52, 0
    v_pk_max_i16 v53, v53, 0
    v_fma_f32 v56, -v137, v10, v56
    v_fma_f32 v57, -v137, v11, v57
    v_fma_f32 v58, -v137, v12, v58
    v_fma_f32 v59, -v137, v13, v59
    v_cvt_pk_bf16_f32 v54, v56, v57
    s_waitcnt lgkmcnt(0)
    v_cvt_pk_bf16_f32 v55, v58, v59
    v_pk_max_i16 v54, v54, 0
    v_and_b32 v104, v104, v105
    v_bitop3_b32 v102, v104, v106, v107 bitop3:0x7f
    v_pk_max_i16 v55, v55, 0
    s_cmp_eq_u32 s14, 0
    s_cbranch_scc1 L_nosw_147
    v_swap_b32 v52, v54
    v_swap_b32 v53, v55
L_nosw_147:
    s_add_u32 s80, s13, 0
    s_cmp_eq_u32 s53, 0
    s_cbranch_scc1 L_hs_162
    buffer_store_dwordx4 v[52:55], v143, s[32:35], s80 offen
L_he_163:
    v_mfma_f32_16x16x32_bf16 v[28:31], a[204:207], v[92:95], v[28:31]
    v_or_b32 v102, -2, v102
    v_cmp_eq_u32 vcc, -1, v102
    s_cbranch_vccnz L_re_145
L_bk_146:
    s_barrier
    v_mfma_f32_16x16x32_bf16 v[44:47], v[156:159], v[92:95], v[44:47]
    ds_read_b64_tr_b16 v[68:69], v14 offset:49152
    v_mfma_f32_16x16x32_bf16 v[60:63], v[220:223], v[92:95], v[60:63]
    ds_read_b64_tr_b16 v[70:71], v14 offset:50176
    v_mfma_f32_16x16x32_bf16 v[32:35], a[204:207], v[96:99], v[32:35]
    ds_read_b64_tr_b16 v[72:73], v15 offset:49152
    v_mfma_f32_16x16x32_bf16 v[48:51], v[156:159], v[96:99], v[48:51]
    ds_read_b64_tr_b16 v[74:75], v15 offset:50176
    v_mfma_f32_16x16x32_bf16 v[64:67], v[220:223], v[96:99], v[64:67]
    ds_read_b64_tr_b16 v[76:77], v14 offset:51200
    s_waitcnt lgkmcnt(3)
    v_mfma_f32_16x16x32_bf16 v[28:31], a[208:211], v[68:71], v[28:31]
    ds_read_b64_tr_b16 v[78:79], v14 offset:52224
    v_mfma_f32_16x16x32_bf16 v[44:47], v[160:163], v[68:71], v[44:47]
    ds_read_b64_tr_b16 v[80:81], v15 offset:51200
    v_mov_b32 v102, 3
    v_mfma_f32_16x16x32_bf16 v[60:63], v[224:227], v[68:71], v[60:63]
    ds_read_b64_tr_b16 v[82:83], v15 offset:52224
    s_waitcnt lgkmcnt(4)
    v_mfma_f32_16x16x32_bf16 v[32:35], a[208:211], v[72:75], v[32:35]
    ds_read_b64_tr_b16 v[84:85], v14 offset:53248
    s_waitcnt vmcnt(0)
    v_mfma_f32_16x16x32_bf16 v[48:51], v[160:163], v[72:75], v[48:51]
    s_mov_b32 exec_lo, 1
    s_mov_b32 exec_hi, 0
    s_cmp_eq_u32 s53, 0
    s_cbranch_scc1 L_hs_170
    buffer_store_dword v102, v143, s[32:35], s19 offen
L_he_171:
    s_mov_b64 exec, -1
    v_mfma_f32_16x16x32_bf16 v[64:67], v[224:227], v[72:75], v[64:67]
    ds_read_b64_tr_b16 v[86:87], v14 offset:54272
    s_waitcnt lgkmcnt(4)
    v_mfma_f32_16x16x32_bf16 v[28:31], a[212:215], v[76:79], v[28:31]
    ds_read_b64_tr_b16 v[88:89], v15 offset:53248
    v_mfma_f32_16x16x32_bf16 v[44:47], v[164:167], v[76:79], v[44:47]
    ds_read_b64_tr_b16 v[90:91], v15 offset:54272
    v_mfma_f32_16x16x32_bf16 v[60:63], v[228:231], v[76:79], v[60:63]
    ds_read_b64_tr_b16 v[92:93], v14 offset:55296
    s_waitcnt lgkmcnt(5)
    v_mfma_f32_16x16x32_bf16 v[32:35], a[212:215], v[80:83], v[32:35]
    ds_read_b64_tr_b16 v[94:95], v14 offset:56320
    v_mfma_f32_16x16x32_bf16 v[48:51], v[164:167], v[80:83], v[48:51]
    ds_read_b64_tr_b16 v[96:97], v15 offset:55296
    v_mfma_f32_16x16x32_bf16 v[64:67], v[228:231], v[80:83], v[64:67]
    ds_read_b64_tr_b16 v[98:99], v15 offset:56320
    s_waitcnt lgkmcnt(6)
    v_mfma_f32_16x16x32_bf16 v[28:31], a[216:219], v[84:87], v[28:31]
    ds_read_b64_tr_b16 v[68:69], v14 offset:57344
    v_mfma_f32_16x16x32_bf16 v[44:47], v[168:171], v[84:87], v[44:47]
    ds_read_b64_tr_b16 v[70:71], v14 offset:58368
    v_mfma_f32_16x16x32_bf16 v[60:63], v[232:235], v[84:87], v[60:63]
    ds_read_b64_tr_b16 v[72:73], v15 offset:57344
    s_waitcnt lgkmcnt(7)
    v_mfma_f32_16x16x32_bf16 v[32:35], a[216:219], v[88:91], v[32:35]
    ds_read_b64_tr_b16 v[74:75], v15 offset:58368
    v_mfma_f32_16x16x32_bf16 v[48:51], v[168:171], v[88:91], v[48:51]
    ds_read_b64_tr_b16 v[76:77], v14 offset:59392
    v_mfma_f32_16x16x32_bf16 v[64:67], v[232:235], v[88:91], v[64:67]
    ds_read_b64_tr_b16 v[78:79], v14 offset:60416
    s_waitcnt lgkmcnt(8)
    v_mfma_f32_16x16x32_bf16 v[28:31], a[220:223], v[92:95], v[28:31]
    ds_read_b64_tr_b16 v[80:81], v15 offset:59392
    v_mfma_f32_16x16x32_bf16 v[44:47], v[172:175], v[92:95], v[44:47]
    ds_read_b64_tr_b16 v[82:83], v15 offset:60416
    v_mfma_f32_16x16x32_bf16 v[60:63], v[236:239], v[92:95], v[60:63]
    ds_read_b64_tr_b16 v[84:85], v14 offset:61440
    s_waitcnt lgkmcnt(9)
    v_mfma_f32_16x16x32_bf16 v[32:35], a[220:223], v[96:99], v[32:35]
    ds_read_b64_tr_b16 v[86:87], v14 offset:62464
    v_mfma_f32_16x16x32_bf16 v[48:51], v[172:175], v[96:99], v[48:51]
    ds_read_b64_tr_b16 v[88:89], v15 offset:61440
    v_mfma_f32_16x16x32_bf16 v[64:67], v[236:239], v[96:99], v[64:67]
    ds_read_b64_tr_b16 v[90:91], v15 offset:62464
    s_waitcnt lgkmcnt(9)
    v_mfma_f32_16x16x32_bf16 v[28:31], a[224:227], v[68:71], v[28:31]
    ds_read_b64_tr_b16 v[92:93], v14 offset:63488
    v_and_b32 v101, 7, v1
    v_mfma_f32_16x16x32_bf16 v[44:47], v[176:179], v[68:71], v[44:47]
    ds_read_b64_tr_b16 v[94:95], v14 offset:64512
    v_lshlrev_b32 v101, 2, v101
    v_mfma_f32_16x16x32_bf16 v[60:63], v[240:243], v[68:71], v[60:63]
    ds_read_b64_tr_b16 v[96:97], v15 offset:63488
    s_waitcnt lgkmcnt(9)
    v_mfma_f32_16x16x32_bf16 v[32:35], a[224:227], v[72:75], v[32:35]
    ds_read_b64_tr_b16 v[98:99], v15 offset:64512
    buffer_load_dword v102, v101, s[32:35], s11 offen sc1
    v_mfma_f32_16x16x32_bf16 v[48:51], v[176:179], v[72:75], v[48:51]
    v_mfma_f32_16x16x32_bf16 v[64:67], v[240:243], v[72:75], v[64:67]
    v_mfma_f32_16x16x32_bf16 v[28:31], a[228:231], v[76:79], v[28:31]
    v_mfma_f32_16x16x32_bf16 v[44:47], v[180:183], v[76:79], v[44:47]
    v_mfma_f32_16x16x32_bf16 v[60:63], v[244:247], v[76:79], v[60:63]
    s_waitcnt lgkmcnt(4)
    v_mfma_f32_16x16x32_bf16 v[32:35], a[228:231], v[80:83], v[32:35]
    v_mfma_f32_16x16x32_bf16 v[48:51], v[180:183], v[80:83], v[48:51]
    v_mfma_f32_16x16x32_bf16 v[64:67], v[244:247], v[80:83], v[64:67]
    v_mfma_f32_16x16x32_bf16 v[28:31], a[232:235], v[84:87], v[28:31]
    v_mfma_f32_16x16x32_bf16 v[44:47], v[184:187], v[84:87], v[44:47]
    v_mfma_f32_16x16x32_bf16 v[60:63], v[248:251], v[84:87], v[60:63]
    v_mfma_f32_16x16x32_bf16 v[32:35], a[232:235], v[88:91], v[32:35]
    s_barrier
    ds_read2_b32 v[136:137], v103 offset0:32 offset1:48
    v_mfma_f32_16x16x32_bf16 v[48:51], v[184:187], v[88:91], v[48:51]
    s_waitcnt vmcnt(0)
    v_mfma_f32_16x16x32_bf16 v[64:67], v[248:251], v[88:91], v[64:67]
    v_cmp_gt_u32 vcc, 3, v102
    s_cbranch_vccnz L_hr_148
L_hb_149:
    s_waitcnt lgkmcnt(1)
    v_mfma_f32_16x16x32_bf16 v[28:31], a[236:239], v[92:95], v[28:31]
    v_mfma_f32_16x16x32_bf16 v[44:47], v[188:191], v[92:95], v[44:47]
    s_add_u32 s86, s94, 0
    buffer_load_dwordx4 v[104:107], v143, s[32:35], s86 offen sc1
    v_mfma_f32_16x16x32_bf16 v[60:63], v[252:255], v[92:95], v[60:63]
    v_mfma_f32_16x16x32_bf16 v[32:35], a[236:239], v[96:99], v[32:35]
    v_mfma_f32_16x16x32_bf16 v[48:51], v[188:191], v[96:99], v[48:51]
    s_add_u32 s86, s94, 8192
    buffer_load_dwordx4 v[108:111], v143, s[32:35], s86 offen sc1
    v_mfma_f32_16x16x32_bf16 v[64:67], v[252:255], v[96:99], v[64:67]
    s_add_u32 s86, s95, 0
    buffer_load_dwordx4 v[112:115], v143, s[32:35], s86 offen sc1
    s_waitcnt lgkmcnt(0)
    v_pk_fma_f32 v[28:29], v[136:137], v[2:3], v[28:29] op_sel:[0,0,0] op_sel_hi:[0,1,1] neg_lo:[1,0,0] neg_hi:[1,0,0]
    v_pk_fma_f32 v[30:31], v[136:137], v[4:5], v[30:31] op_sel:[0,0,0] op_sel_hi:[0,1,1] neg_lo:[1,0,0] neg_hi:[1,0,0]
    v_cvt_pk_bf16_f32 v28, v28, v29
    v_cvt_pk_bf16_f32 v29, v30, v31
    v_pk_max_i16 v28, v28, 0
    v_pk_max_i16 v29, v29, 0
    v_pk_fma_f32 v[44:45], v[136:137], v[6:7], v[44:45] op_sel:[0,0,0] op_sel_hi:[0,1,1] neg_lo:[1,0,0] neg_hi:[1,0,0]
    v_pk_fma_f32 v[46:47], v[136:137], v[8:9], v[46:47] op_sel:[0,0,0] op_sel_hi:[0,1,1] neg_lo:[1,0,0] neg_hi:[1,0,0]
    s_add_u32 s86, s95, 8192
    buffer_load_dwordx4 v[116:119], v143, s[32:35], s86 offen sc1
    v_cvt_pk_bf16_f32 v30, v44, v45
    v_cvt_pk_bf16_f32 v31, v46, v47
    v_pk_max_i16 v30, v30, 0
    v_pk_max_i16 v31, v31, 0
    s_add_u32 s86, s100, 0
    buffer_load_dwordx4 v[120:123], v143, s[32:35], s86 offen sc1
    s_add_u32 s80, s12, 131072
    s_cmp_eq_u32 s53, 0
    s_cbranch_scc1 L_hs_173
    buffer_store_dwordx4 v[28:31], v143, s[32:35], s80 offen
L_he_174:
    v_pk_fma_f32 v[32:33], v[136:137], v[2:3], v[32:33] op_sel:[1,0,0] op_sel_hi:[1,1,1] neg_lo:[1,0,0] neg_hi:[1,0,0]
    v_pk_fma_f32 v[34:35], v[136:137], v[4:5], v[34:35] op_sel:[1,0,0] op_sel_hi:[1,1,1] neg_lo:[1,0,0] neg_hi:[1,0,0]
    v_cvt_pk_bf16_f32 v32, v32, v33
    s_add_u32 s86, s100, 8192
    buffer_load_dwordx4 v[124:127], v143, s[32:35], s86 offen sc1
    v_cvt_pk_bf16_f32 v33, v34, v35
    v_pk_max_i16 v32, v32, 0
    v_pk_max_i16 v33, v33, 0
    v_pk_fma_f32 v[48:49], v[136:137], v[6:7], v[48:49] op_sel:[1,0,0] op_sel_hi:[1,1,1] neg_lo:[1,0,0] neg_hi:[1,0,0]
    s_add_u32 s86, s4, 0
    buffer_load_dwordx4 v[128:131], v143, s[32:35], s86 offen sc1
    v_pk_fma_f32 v[50:51], v[136:137], v[8:9], v[50:51] op_sel:[1,0,0] op_sel_hi:[1,1,1] neg_lo:[1,0,0] neg_hi:[1,0,0]
    v_cvt_pk_bf16_f32 v34, v48, v49
    v_cvt_pk_bf16_f32 v35, v50, v51
    v_pk_max_i16 v34, v34, 0
    s_add_u32 s86, s4, 8192
    buffer_load_dwordx4 v[132:135], v143, s[32:35], s86 offen sc1
    v_pk_max_i16 v35, v35, 0
    s_add_u32 s80, s12, 196608
    s_cmp_eq_u32 s53, 0
    s_cbranch_scc1 L_hs_175
    buffer_store_dwordx4 v[32:35], v143, s[32:35], s80 offen
L_he_176:
    v_pk_fma_f32 v[60:61], v[136:137], v[10:11], v[60:61] op_sel:[0,0,0] op_sel_hi:[0,1,1] neg_lo:[1,0,0] neg_hi:[1,0,0]
    v_pk_fma_f32 v[62:63], v[136:137], v[12:13], v[62:63] op_sel:[0,0,0] op_sel_hi:[0,1,1] neg_lo:[1,0,0] neg_hi:[1,0,0]
    v_cvt_pk_bf16_f32 v60, v60, v61
    v_cvt_pk_bf16_f32 v61, v62, v63
    v_pk_max_i16 v60, v60, 0
    v_pk_max_i16 v61, v61, 0
    v_pk_fma_f32 v[64:65], v[136:137], v[10:11], v[64:65] op_sel:[1,0,0] op_sel_hi:[1,1,1] neg_lo:[1,0,0] neg_hi:[1,0,0]
    v_pk_fma_f32 v[66:67], v[136:137], v[12:13], v[66:67] op_sel:[1,0,0] op_sel_hi:[1,1,1] neg_lo:[1,0,0] neg_hi:[1,0,0]
    v_cvt_pk_bf16_f32 v62, v64, v65
    v_cvt_pk_bf16_f32 v63, v66, v67
    v_pk_max_i16 v62, v62, 0
    v_pk_max_i16 v63, v63, 0
    s_cmp_eq_u32 s14, 0
    s_cbranch_scc1 L_nosw_172
    v_swap_b32 v60, v62
    v_swap_b32 v61, v63
L_nosw_172:
    s_add_u32 s80, s13, 49152
    s_cmp_eq_u32 s53, 0
    s_cbranch_scc1 L_hs_177
    buffer_store_dwordx4 v[60:63], v143, s[32:35], s80 offen
L_he_178:
    s_branch L_g1j_140
L_g1w3_139:
    ds_read_b64_tr_b16 v[68:69], v14 offset:0
    ds_read_b64_tr_b16 v[70:71], v14 offset:1024
    ds_read_b64_tr_b16 v[72:73], v15 offset:0
    ds_read_b64_tr_b16 v[74:75], v15 offset:1024
    ds_read_b64_tr_b16 v[76:77], v14 offset:2048
    ds_read_b64_tr_b16 v[78:79], v14 offset:3072
    s_waitcnt lgkmcnt(4)
    v_mfma_f32_16x16x32_bf16 v[20:23], a[176:179], v[68:71], 0
    ds_read_b64_tr_b16 v[80:81], v15 offset:2048
    v_mfma_f32_16x16x32_bf16 v[36:39], a[240:243], v[68:71], 0
    ds_read_b64_tr_b16 v[82:83], v15 offset:3072
    v_mfma_f32_16x16x32_bf16 v[52:55], v[68:71], v[68:71], 0
    ds_read_b64_tr_b16 v[84:85], v14 offset:4096
    s_waitcnt lgkmcnt(5)
    v_mfma_f32_16x16x32_bf16 v[24:27], a[176:179], v[72:75], 0
    ds_read_b64_tr_b16 v[86:87], v14 offset:5120
    v_mfma_f32_16x16x32_bf16 v[40:43], a[240:243], v[72:75], 0
    ds_read_b64_tr_b16 v[88:89], v15 offset:4096
    v_mfma_f32_16x16x32_bf16 v[56:59], v[72:75], v[72:75], 0
    ds_read_b64_tr_b16 v[90:91], v15 offset:5120
    s_waitcnt lgkmcnt(6)
    v_mfma_f32_16x16x32_bf16 v[20:23], a[180:183], v[76:79], v[20:23]
    ds_read_b64_tr_b16 v[92:93], v14 offset:6144
    v_mfma_f32_16x16x32_bf16 v[36:39], a[244:247], v[76:79], v[36:39]
    ds_read_b64_tr_b16 v[94:95], v14 offset:7168
    v_mfma_f32_16x16x32_bf16 v[52:55], v[76:79], v[76:79], v[52:55]
    ds_read_b64_tr_b16 v[96:97], v15 offset:6144
    s_waitcnt lgkmcnt(7)
    v_mfma_f32_16x16x32_bf16 v[24:27], a[180:183], v[80:83], v[24:27]
    ds_read_b64_tr_b16 v[98:99], v15 offset:7168
    v_mfma_f32_16x16x32_bf16 v[40:43], a[244:247], v[80:83], v[40:43]
    ds_read_b64_tr_b16 v[68:69], v14 offset:8192
    v_mfma_f32_16x16x32_bf16 v[56:59], v[80:83], v[80:83], v[56:59]
    ds_read_b64_tr_b16 v[70:71], v14 offset:9216
    s_waitcnt lgkmcnt(8)
    v_mfma_f32_16x16x32_bf16 v[20:23], a[184:187], v[84:87], v[20:23]
    ds_read_b64_tr_b16 v[72:73], v15 offset:8192
    v_mfma_f32_16x16x32_bf16 v[36:39], a[248:251], v[84:87], v[36:39]
    ds_read_b64_tr_b16 v[74:75], v15 offset:9216
    v_mfma_f32_16x16x32_bf16 v[52:55], v[84:87], v[84:87], v[52:55]
    ds_read_b64_tr_b16 v[76:77], v14 offset:10240
    s_waitcnt lgkmcnt(9)
    v_mfma_f32_16x16x32_bf16 v[24:27], a[184:187], v[88:91], v[24:27]
    ds_read_b64_tr_b16 v[78:79], v14 offset:11264
    v_mfma_f32_16x16x32_bf16 v[40:43], a[248:251], v[88:91], v[40:43]
    ds_read_b64_tr_b16 v[80:81], v15 offset:10240
    v_mfma_f32_16x16x32_bf16 v[56:59], v[88:91], v[88:91], v[56:59]
    ds_read_b64_tr_b16 v[82:83], v15 offset:11264
    s_waitcnt lgkmcnt(9)
    v_mfma_f32_16x16x32_bf16 v[20:23], a[188:191], v[92:95], v[20:23]
    ds_read_b64_tr_b16 v[84:85], v14 offset:12288
    v_mfma_f32_16x16x32_bf16 v[36:39], a[252:255], v[92:95], v[36:39]
    ds_read_b64_tr_b16 v[86:87], v14 offset:13312
    s_waitcnt vmcnt(1)
    v_mfma_f32_16x16x32_bf16 v[52:55], v[92:95], v[92:95], v[52:55]
    ds_read_b64_tr_b16 v[88:89], v15 offset:12288
    s_waitcnt lgkmcnt(9)
    v_mfma_f32_16x16x32_bf16 v[24:27], a[188:191], v[96:99], v[24:27]
    ds_read_b64_tr_b16 v[90:91], v15 offset:13312
    ds_read2st64_b32 v[104:105], v101 offset0:64 offset1:68
    v_mfma_f32_16x16x32_bf16 v[40:43], a[252:255], v[96:99], v[40:43]
    ds_read2st64_b32 v[106:107], v101 offset0:72 offset1:76
    v_mfma_f32_16x16x32_bf16 v[56:59], v[96:99], v[96:99], v[56:59]
    ds_read_b64_tr_b16 v[92:93], v14 offset:14336
    v_mfma_f32_16x16x32_bf16 v[20:23], a[192:195], v[68:71], v[20:23]
    ds_read_b64_tr_b16 v[94:95], v14 offset:15360
    v_mfma_f32_16x16x32_bf16 v[36:39], v[144:147], v[68:71], v[36:39]
    v_mfma_f32_16x16x32_bf16 v[52:55], v[68:71], v[68:71], v[52:55]
    ds_read_b64_tr_b16 v[96:97], v15 offset:14336
    s_waitcnt lgkmcnt(9)
    v_mfma_f32_16x16x32_bf16 v[24:27], a[192:195], v[72:75], v[24:27]
    ds_read_b64_tr_b16 v[98:99], v15 offset:15360
    s_waitcnt lgkmcnt(4)
    v_mfma_f32_16x16x32_bf16 v[40:43], v[144:147], v[72:75], v[40:43]
    v_and_b32 v104, v104, v105
    v_bitop3_b32 v102, v104, v106, v107 bitop3:0x7f
    v_mfma_f32_16x16x32_bf16 v[56:59], v[72:75], v[72:75], v[56:59]
    v_or_b32 v102, -2, v102
    v_mfma_f32_16x16x32_bf16 v[20:23], a[196:199], v[76:79], v[20:23]
    v_cmp_eq_u32 vcc, -1, v102
    s_cbranch_vccnz L_re_179
L_bk_180:
    s_barrier
    v_mfma_f32_16x16x32_bf16 v[36:39], v[148:151], v[76:79], v[36:39]
    ds_read_b64_tr_b16 v[68:69], v14 offset:16384
    v_mfma_f32_16x16x32_bf16 v[52:55], v[76:79], v[76:79], v[52:55]
    ds_read_b64_tr_b16 v[70:71], v14 offset:17408
    v_mfma_f32_16x16x32_bf16 v[24:27], a[196:199], v[80:83], v[24:27]
    ds_read_b64_tr_b16 v[72:73], v15 offset:16384
    v_mfma_f32_16x16x32_bf16 v[40:43], v[148:151], v[80:83], v[40:43]
    ds_read_b64_tr_b16 v[74:75], v15 offset:17408
    v_mfma_f32_16x16x32_bf16 v[56:59], v[80:83], v[80:83], v[56:59]
    ds_read_b64_tr_b16 v[76:77], v14 offset:18432
    v_mfma_f32_16x16x32_bf16 v[20:23], a[200:203], v[84:87], v[20:23]
    ds_read_b64_tr_b16 v[78:79], v14 offset:19456
    v_mfma_f32_16x16x32_bf16 v[36:39], v[152:155], v[84:87], v[36:39]
    v_mfma_f32_16x16x32_bf16 v[52:55], v[84:87], v[84:87], v[52:55]
    ds_read_b64_tr_b16 v[80:81], v15 offset:18432
    v_mfma_f32_16x16x32_bf16 v[24:27], a[200:203], v[88:91], v[24:27]
    ds_read_b64_tr_b16 v[82:83], v15 offset:19456
    s_add_u32 m0, s20, 32768
    v_mfma_f32_16x16x32_bf16 v[40:43], v[152:155], v[88:91], v[40:43]
    s_add_u32 s76, s15, 2048
    buffer_load_dwordx4 v100, s[32:35], s76 offen offset:0 sc1 lds
    v_mfma_f32_16x16x32_bf16 v[56:59], v[88:91], v[88:91], v[56:59]
    ds_read_b64_tr_b16 v[84:85], v14 offset:20480
    s_waitcnt lgkmcnt(7)
    v_mfma_f32_16x16x32_bf16 v[20:23], a[204:207], v[92:95], v[20:23]
    ds_read_b64_tr_b16 v[86:87], v14 offset:21504
    s_add_u32 s76, s15, 66560
    v_mfma_f32_16x16x32_bf16 v[36:39], v[156:159], v[92:95], v[36:39]
    buffer_load_dwordx4 v100, s[32:35], s76 offen offset:1024 sc1 lds
    v_mfma_f32_16x16x32_bf16 v[52:55], v[92:95], v[92:95], v[52:55]
    ds_read_b64_tr_b16 v[88:89], v15 offset:20480
    v_mfma_f32_16x16x32_bf16 v[24:27], a[204:207], v[96:99], v[24:27]
    ds_read_b64_tr_b16 v[90:91], v15 offset:21504
    s_add_u32 s76, s15, 131072
    v_mfma_f32_16x16x32_bf16 v[40:43], v[156:159], v[96:99], v[40:43]
    buffer_load_dwordx4 v100, s[32:35], s76 offen offset:2048 sc1 lds
    v_mfma_f32_16x16x32_bf16 v[56:59], v[96:99], v[96:99], v[56:59]
    ds_read_b64_tr_b16 v[92:93], v14 offset:22528
    v_mfma_f32_16x16x32_bf16 v[20:23], a[208:211], v[68:71], v[20:23]
    ds_read_b64_tr_b16 v[94:95], v14 offset:23552
    s_add_u32 s76, s15, 195584
    v_mfma_f32_16x16x32_bf16 v[36:39], v[160:163], v[68:71], v[36:39]
    buffer_load_dwordx4 v100, s[32:35], s76 offen offset:3072 sc1 lds
    v_mfma_f32_16x16x32_bf16 v[52:55], v[68:71], v[68:71], v[52:55]
    ds_read_b64_tr_b16 v[96:97], v15 offset:22528
    s_waitcnt lgkmcnt(6)
    v_mfma_f32_16x16x32_bf16 v[24:27], a[208:211], v[72:75], v[24:27]
    ds_read_b64_tr_b16 v[98:99], v15 offset:23552
    s_add_u32 m0, s20, 49152
    v_mfma_f32_16x16x32_bf16 v[40:43], v[160:163], v[72:75], v[40:43]
    s_add_u32 s76, s52, 2048
    buffer_load_dwordx4 v100, s[32:35], s76 offen offset:0 sc1 lds
    v_mfma_f32_16x16x32_bf16 v[56:59], v[72:75], v[72:75], v[56:59]
    ds_read_b64_tr_b16 v[68:69], v14 offset:24576
    v_mfma_f32_16x16x32_bf16 v[20:23], a[212:215], v[76:79], v[20:23]
    ds_read_b64_tr_b16 v[70:71], v14 offset:25600
    s_add_u32 s76, s52, 66560
    v_mfma_f32_16x16x32_bf16 v[36:39], v[164:167], v[76:79], v[36:39]
    buffer_load_dwordx4 v100, s[32:35], s76 offen offset:1024 sc1 lds
    v_mfma_f32_16x16x32_bf16 v[52:55], v[76:79], v[76:79], v[52:55]
    ds_read_b64_tr_b16 v[72:73], v15 offset:24576
    v_mfma_f32_16x16x32_bf16 v[24:27], a[212:215], v[80:83], v[24:27]
    ds_read_b64_tr_b16 v[74:75], v15 offset:25600
    s_add_u32 s76, s52, 131072
    v_mfma_f32_16x16x32_bf16 v[40:43], v[164:167], v[80:83], v[40:43]
    buffer_load_dwordx4 v100, s[32:35], s76 offen offset:2048 sc1 lds
    v_mfma_f32_16x16x32_bf16 v[56:59], v[80:83], v[80:83], v[56:59]
    ds_read_b64_tr_b16 v[76:77], v14 offset:26624
    s_waitcnt lgkmcnt(6)
    v_mfma_f32_16x16x32_bf16 v[20:23], a[216:219], v[84:87], v[20:23]
    ds_read_b64_tr_b16 v[78:79], v14 offset:27648
    s_add_u32 s76, s52, 195584
    v_mfma_f32_16x16x32_bf16 v[36:39], v[168:171], v[84:87], v[36:39]
    buffer_load_dwordx4 v100, s[32:35], s76 offen offset:3072 sc1 lds
    v_mfma_f32_16x16x32_bf16 v[52:55], v[84:87], v[84:87], v[52:55]
    ds_read_b64_tr_b16 v[80:81], v15 offset:26624
    v_mfma_f32_16x16x32_bf16 v[24:27], a[216:219], v[88:91], v[24:27]
L_stub_9:
    s_cbranch_execz L_warm_back
    s_nop 0
    ds_read_b64_tr_b16 v[82:83], v15 offset:27648
    v_mfma_f32_16x16x32_bf16 v[40:43], v[168:171], v[88:91], v[40:43]
    v_mfma_f32_16x16x32_bf16 v[56:59], v[88:91], v[88:91], v[56:59]
    ds_read_b64_tr_b16 v[84:85], v14 offset:28672
    v_mfma_f32_16x16x32_bf16 v[20:23], a[220:223], v[92:95], v[20:23]
    ds_read_b64_tr_b16 v[86:87], v14 offset:29696
    v_mfma_f32_16x16x32_bf16 v[36:39], v[172:175], v[92:95], v[36:39]
    v_mfma_f32_16x16x32_bf16 v[52:55], v[92:95], v[92:95], v[52:55]
    ds_read_b64_tr_b16 v[88:89], v15 offset:28672
    s_waitcnt lgkmcnt(6)
    v_mfma_f32_16x16x32_bf16 v[24:27], a[220:223], v[96:99], v[24:27]
    ds_read_b64_tr_b16 v[90:91], v15 offset:29696
    v_mfma_f32_16x16x32_bf16 v[40:43], v[172:175], v[96:99], v[40:43]
    v_mfma_f32_16x16x32_bf16 v[56:59], v[96:99], v[96:99], v[56:59]
    ds_read_b64_tr_b16 v[92:93], v14 offset:30720
    v_mfma_f32_16x16x32_bf16 v[20:23], a[224:227], v[68:71], v[20:23]
    ds_read_b64_tr_b16 v[94:95], v14 offset:31744
    v_mfma_f32_16x16x32_bf16 v[36:39], v[176:179], v[68:71], v[36:39]
    v_mfma_f32_16x16x32_bf16 v[52:55], v[68:71], v[68:71], v[52:55]
    ds_read_b64_tr_b16 v[96:97], v15 offset:30720
    v_mfma_f32_16x16x32_bf16 v[24:27], a[224:227], v[72:75], v[24:27]
    ds_read_b64_tr_b16 v[98:99], v15 offset:31744
    v_mfma_f32_16x16x32_bf16 v[40:43], v[176:179], v[72:75], v[40:43]
    v_mfma_f32_16x16x32_bf16 v[56:59], v[72:75], v[72:75], v[56:59]
    s_waitcnt lgkmcnt(5)
    v_mfma_f32_16x16x32_bf16 v[20:23], a[228:231], v[76:79], v[20:23]
    v_mfma_f32_16x16x32_bf16 v[36:39], v[180:183], v[76:79], v[36:39]
    s_waitcnt vmcnt(4)
    ds_read2st64_b32 v[104:105], v101 offset0:128 offset1:132
    v_mfma_f32_16x16x32_bf16 v[52:55], v[76:79], v[76:79], v[52:55]
    ds_read2st64_b32 v[106:107], v101 offset0:136 offset1:140
    v_mfma_f32_16x16x32_bf16 v[24:27], a[228:231], v[80:83], v[24:27]
    v_mfma_f32_16x16x32_bf16 v[40:43], v[180:183], v[80:83], v[40:43]
    v_mfma_f32_16x16x32_bf16 v[56:59], v[80:83], v[80:83], v[56:59]
    v_mfma_f32_16x16x32_bf16 v[20:23], a[232:235], v[84:87], v[20:23]
    v_mfma_f32_16x16x32_bf16 v[36:39], v[184:187], v[84:87], v[36:39]
    v_mfma_f32_16x16x32_bf16 v[52:55], v[84:87], v[84:87], v[52:55]
    s_waitcnt lgkmcnt(2)
    v_mfma_f32_16x16x32_bf16 v[24:27], a[232:235], v[88:91], v[24:27]
    s_waitcnt lgkmcnt(0)
    v_mfma_f32_16x16x32_bf16 v[40:43], v[184:187], v[88:91], v[40:43]
    v_and_b32 v104, v104, v105
    v_bitop3_b32 v102, v104, v106, v107 bitop3:0x7f
    v_mfma_f32_16x16x32_bf16 v[56:59], v[88:91], v[88:91], v[56:59]
    v_or_b32 v102, -2, v102
    v_mfma_f32_16x16x32_bf16 v[20:23], a[236:239], v[92:95], v[20:23]
    v_cmp_eq_u32 vcc, -1, v102
    s_cbranch_vccnz L_re_181
L_bk_182:
    s_barrier
    v_mfma_f32_16x16x32_bf16 v[36:39], v[188:191], v[92:95], v[36:39]
    ds_read_b64_tr_b16 v[68:69], v14 offset:32768
    v_mfma_f32_16x16x32_bf16 v[52:55], v[92:95], v[92:95], v[52:55]
    ds_read_b64_tr_b16 v[70:71], v14 offset:33792
    v_mfma_f32_16x16x32_bf16 v[24:27], a[236:239], v[96:99], v[24:27]
    ds_read_b64_tr_b16 v[72:73], v15 offset:32768
    v_mfma_f32_16x16x32_bf16 v[40:43], v[188:191], v[96:99], v[40:43]
    ds_read_b64_tr_b16 v[74:75], v15 offset:33792
    v_mfma_f32_16x16x32_bf16 v[56:59], v[96:99], v[96:99], v[56:59]
    ds_read_b64_tr_b16 v[76:77], v14 offset:34816
    s_waitcnt lgkmcnt(3)
    v_mfma_f32_16x16x32_bf16 v[28:31], a[176:179], v[68:71], 0
    ds_read_b64_tr_b16 v[78:79], v14 offset:35840
    v_mfma_f32_16x16x32_bf16 v[44:47], a[240:243], v[68:71], 0
    s_mov_b32 exec_lo, 0
    s_mov_b32 exec_hi, 0xffff0000
    ds_write_b32 v103, v36 offset:0
    ds_write_b32 v103, v40 offset:64
    v_mov_b64 v[36:37], 0
    v_mov_b64 v[38:39], 0
    v_mov_b64 v[40:41], 0
    v_mov_b64 v[42:43], 0
    s_mov_b64 exec, -1
    v_mfma_f32_16x16x32_bf16 v[60:63], v[68:71], v[68:71], 0
    ds_read_b64_tr_b16 v[80:81], v15 offset:34816
    s_waitcnt lgkmcnt(5)
    v_mfma_f32_16x16x32_bf16 v[32:35], a[176:179], v[72:75], 0
    ds_read_b64_tr_b16 v[82:83], v15 offset:35840
    v_mfma_f32_16x16x32_bf16 v[48:51], a[240:243], v[72:75], 0
    s_waitcnt lgkmcnt(2)
    s_barrier
    v_mfma_f32_16x16x32_bf16 v[64:67], v[72:75], v[72:75], 0
    ds_read_b64_tr_b16 v[84:85], v14 offset:36864
    ds_read2_b32 v[136:137], v103 offset0:0 offset1:16
    v_mfma_f32_16x16x32_bf16 v[28:31], a[180:183], v[76:79], v[28:31]
    ds_read_b64_tr_b16 v[86:87], v14 offset:37888
    v_mfma_f32_16x16x32_bf16 v[44:47], a[244:247], v[76:79], v[44:47]
    ds_read_b64_tr_b16 v[88:89], v15 offset:36864
    v_mfma_f32_16x16x32_bf16 v[60:63], v[76:79], v[76:79], v[60:63]
    ds_read_b64_tr_b16 v[90:91], v15 offset:37888
    s_waitcnt lgkmcnt(5)
    v_mfma_f32_16x16x32_bf16 v[32:35], a[180:183], v[80:83], v[32:35]
    ds_read_b64_tr_b16 v[92:93], v14 offset:38912
    v_mfma_f32_16x16x32_bf16 v[48:51], a[244:247], v[80:83], v[48:51]
    ds_read_b64_tr_b16 v[94:95], v14 offset:39936
    s_waitcnt lgkmcnt(5)
    v_mfma_f32_16x16x32_bf16 v[64:67], v[80:83], v[80:83], v[64:67]
    ds_read_b64_tr_b16 v[96:97], v15 offset:38912
    s_waitcnt lgkmcnt(5)
    v_mfma_f32_16x16x32_bf16 v[28:31], a[184:187], v[84:87], v[28:31]
    ds_read_b64_tr_b16 v[98:99], v15 offset:39936
    v_fma_f32 v20, -v136, v2, v20
    v_mfma_f32_16x16x32_bf16 v[44:47], a[248:251], v[84:87], v[44:47]
    ds_read_b64_tr_b16 v[68:69], v14 offset:40960
    v_fma_f32 v21, -v136, v3, v21
    v_mfma_f32_16x16x32_bf16 v[60:63], v[84:87], v[84:87], v[60:63]
    ds_read_b64_tr_b16 v[70:71], v14 offset:41984
    s_waitcnt lgkmcnt(6)
    v_mfma_f32_16x16x32_bf16 v[32:35], a[184:187], v[88:91], v[32:35]
    ds_read_b64_tr_b16 v[72:73], v15 offset:40960
    v_fma_f32 v22, -v136, v4, v22
    v_mfma_f32_16x16x32_bf16 v[48:51], a[248:251], v[88:91], v[48:51]
    ds_read_b64_tr_b16 v[74:75], v15 offset:41984
    v_fma_f32 v23, -v136, v5, v23
    v_mfma_f32_16x16x32_bf16 v[64:67], v[88:91], v[88:91], v[64:67]
    ds_read_b64_tr_b16 v[76:77], v14 offset:43008
    s_waitcnt lgkmcnt(7)
    v_mfma_f32_16x16x32_bf16 v[28:31], a[188:191], v[92:95], v[28:31]
    ds_read_b64_tr_b16 v[78:79], v14 offset:44032
    v_cvt_pk_bf16_f32 v20, v20, v21
    v_mfma_f32_16x16x32_bf16 v[44:47], a[252:255], v[92:95], v[44:47]
    v_cvt_pk_bf16_f32 v21, v22, v23
    v_pk_max_i16 v20, v20, 0
    v_mfma_f32_16x16x32_bf16 v[60:63], v[92:95], v[92:95], v[60:63]
    v_pk_max_i16 v21, v21, 0
    s_waitcnt lgkmcnt(6)
    v_mfma_f32_16x16x32_bf16 v[32:35], a[188:191], v[96:99], v[32:35]
    v_fma_f32 v36, -v136, v6, v36
    v_fma_f32 v37, -v136, v7, v37
    v_mfma_f32_16x16x32_bf16 v[48:51], a[252:255], v[96:99], v[48:51]
    v_fma_f32 v38, -v136, v8, v38
    v_fma_f32 v39, -v136, v9, v39
    v_mfma_f32_16x16x32_bf16 v[64:67], v[96:99], v[96:99], v[64:67]
    ds_read_b64_tr_b16 v[80:81], v15 offset:43008
    s_waitcnt lgkmcnt(5)
    v_mfma_f32_16x16x32_bf16 v[28:31], a[192:195], v[68:71], v[28:31]
    ds_read_b64_tr_b16 v[82:83], v15 offset:44032
    v_cvt_pk_bf16_f32 v22, v36, v37
    v_mfma_f32_16x16x32_bf16 v[44:47], v[144:147], v[68:71], v[44:47]
    v_cvt_pk_bf16_f32 v23, v38, v39
    v_pk_max_i16 v22, v22, 0
    v_mfma_f32_16x16x32_bf16 v[60:63], v[68:71], v[68:71], v[60:63]
    ds_read_b64_tr_b16 v[84:85], v14 offset:45056
    s_waitcnt lgkmcnt(4)
    v_mfma_f32_16x16x32_bf16 v[32:35], a[192:195], v[72:75], v[32:35]
    ds_read_b64_tr_b16 v[86:87], v14 offset:46080
    v_pk_max_i16 v23, v23, 0
    v_mfma_f32_16x16x32_bf16 v[48:51], v[144:147], v[72:75], v[48:51]
    s_add_u32 s80, s12, 0
    s_cmp_eq_u32 s53, 0
    s_cbranch_scc1 L_hs_193
    buffer_store_dwordx4 v[20:23], v143, s[32:35], s80 offen
L_he_194:
    v_mfma_f32_16x16x32_bf16 v[64:67], v[72:75], v[72:75], v[64:67]
    ds_read_b64_tr_b16 v[88:89], v15 offset:45056
    s_waitcnt lgkmcnt(5)
    v_mfma_f32_16x16x32_bf16 v[28:31], a[196:199], v[76:79], v[28:31]
    ds_read_b64_tr_b16 v[90:91], v15 offset:46080
    v_fma_f32 v24, -v137, v2, v24
    v_mfma_f32_16x16x32_bf16 v[44:47], v[148:151], v[76:79], v[44:47]
    v_fma_f32 v25, -v137, v3, v25
    v_fma_f32 v26, -v137, v4, v26
    v_mfma_f32_16x16x32_bf16 v[60:63], v[76:79], v[76:79], v[60:63]
    ds_read_b64_tr_b16 v[92:93], v14 offset:47104
    s_waitcnt lgkmcnt(5)
    v_mfma_f32_16x16x32_bf16 v[32:35], a[196:199], v[80:83], v[32:35]
    ds_read_b64_tr_b16 v[94:95], v14 offset:48128
    v_fma_f32 v27, -v137, v5, v27
    v_mfma_f32_16x16x32_bf16 v[48:51], v[148:151], v[80:83], v[48:51]
    v_cvt_pk_bf16_f32 v24, v24, v25
    v_cvt_pk_bf16_f32 v25, v26, v27
    v_mfma_f32_16x16x32_bf16 v[64:67], v[80:83], v[80:83], v[64:67]
    ds_read_b64_tr_b16 v[96:97], v15 offset:47104
    s_waitcnt lgkmcnt(5)
    v_mfma_f32_16x16x32_bf16 v[28:31], a[200:203], v[84:87], v[28:31]
    ds_read_b64_tr_b16 v[98:99], v15 offset:48128
    v_pk_max_i16 v24, v24, 0
    v_mfma_f32_16x16x32_bf16 v[44:47], v[152:155], v[84:87], v[44:47]
    v_pk_max_i16 v25, v25, 0
    v_fma_f32 v40, -v137, v6, v40
    v_mfma_f32_16x16x32_bf16 v[60:63], v[84:87], v[84:87], v[60:63]
    v_fma_f32 v41, -v137, v7, v41
    s_waitcnt lgkmcnt(4)
    v_mfma_f32_16x16x32_bf16 v[32:35], a[200:203], v[88:91], v[32:35]
    s_waitcnt vmcnt(1)
    ds_read2st64_b32 v[104:105], v101 offset0:192 offset1:196
    v_mfma_f32_16x16x32_bf16 v[48:51], v[152:155], v[88:91], v[48:51]
    v_fma_f32 v42, -v137, v8, v42
    v_fma_f32 v43, -v137, v9, v43
    v_mfma_f32_16x16x32_bf16 v[64:67], v[88:91], v[88:91], v[64:67]
    ds_read2st64_b32 v[106:107], v101 offset0:200 offset1:204
    v_cvt_pk_bf16_f32 v26, v40, v41
    v_cvt_pk_bf16_f32 v27, v42, v43
    v_pk_max_i16 v26, v26, 0
    v_pk_max_i16 v27, v27, 0
    s_add_u32 s80, s12, 65536
    s_cmp_eq_u32 s53, 0
    s_cbranch_scc1 L_hs_195
    buffer_store_dwordx4 v[24:27], v143, s[32:35], s80 offen
L_he_196:
    v_cndmask_b32 v52, v52, v53, s[24:25]
    v_cndmask_b32 v56, v56, v57, s[24:25]
    v_cndmask_b32 v52, v52, v54, s[68:69]
    v_cndmask_b32 v56, v56, v58, s[68:69]
    v_cndmask_b32 v52, v52, v55, s[70:71]
    v_cndmask_b32 v56, v56, v59, s[70:71]
    s_mov_b32 exec_lo, 0x00f0000f
    s_mov_b32 exec_hi, 0xf0000f00
    ds_write_b32 v103, v52 offset:256
    ds_write_b32 v103, v56 offset:320
    s_mov_b64 exec, -1
    s_waitcnt lgkmcnt(6)
    v_mfma_f32_16x16x32_bf16 v[28:31], a[204:207], v[92:95], v[28:31]
    s_waitcnt lgkmcnt(2)
    v_and_b32 v104, v104, v105
    v_mfma_f32_16x16x32_bf16 v[44:47], v[156:159], v[92:95], v[44:47]
    v_bitop3_b32 v102, v104, v106, v107 bitop3:0x7f
    v_or_b32 v102, -2, v102
    v_mfma_f32_16x16x32_bf16 v[60:63], v[92:95], v[92:95], v[60:63]
    v_cmp_eq_u32 vcc, -1, v102
    s_cbranch_vccnz L_re_183
L_bk_184:
    s_barrier
    v_mfma_f32_16x16x32_bf16 v[32:35], a[204:207], v[96:99], v[32:35]
    ds_read_b64_tr_b16 v[20:21], v14 offset:49152
    v_mfma_f32_16x16x32_bf16 v[48:51], v[156:159], v[96:99], v[48:51]
    ds_read_b64_tr_b16 v[22:23], v14 offset:50176
    v_mfma_f32_16x16x32_bf16 v[64:67], v[96:99], v[96:99], v[64:67]
    ds_read_b64_tr_b16 v[24:25], v15 offset:49152
    s_waitcnt lgkmcnt(1)
    v_mfma_f32_16x16x32_bf16 v[28:31], a[208:211], v[20:23], v[28:31]
    ds_read_b64_tr_b16 v[26:27], v15 offset:50176
    v_mfma_f32_16x16x32_bf16 v[44:47], v[160:163], v[20:23], v[44:47]
    ds_read_b64_tr_b16 v[36:37], v14 offset:51200
    v_mov_b32 v102, 3
    v_mfma_f32_16x16x32_bf16 v[60:63], v[20:23], v[20:23], v[60:63]
    ds_read_b64_tr_b16 v[38:39], v14 offset:52224
    s_waitcnt lgkmcnt(2)
    v_mfma_f32_16x16x32_bf16 v[32:35], a[208:211], v[24:27], v[32:35]
    ds_read_b64_tr_b16 v[40:41], v15 offset:51200
    s_waitcnt vmcnt(0)
    v_mfma_f32_16x16x32_bf16 v[48:51], v[160:163], v[24:27], v[48:51]
    ds_read_b64_tr_b16 v[42:43], v15 offset:52224
    v_mfma_f32_16x16x32_bf16 v[64:67], v[24:27], v[24:27], v[64:67]
    ds_read_b64_tr_b16 v[52:53], v14 offset:53248
    s_waitcnt lgkmcnt(3)
    v_mfma_f32_16x16x32_bf16 v[28:31], a[212:215], v[36:39], v[28:31]
    ds_read_b64_tr_b16 v[54:55], v14 offset:54272
    v_mfma_f32_16x16x32_bf16 v[44:47], v[164:167], v[36:39], v[44:47]
    ds_read_b64_tr_b16 v[56:57], v15 offset:53248
    v_mfma_f32_16x16x32_bf16 v[60:63], v[36:39], v[36:39], v[60:63]
    ds_read_b64_tr_b16 v[58:59], v15 offset:54272
    s_waitcnt lgkmcnt(4)
    v_mfma_f32_16x16x32_bf16 v[32:35], a[212:215], v[40:43], v[32:35]
    ds_read_b64_tr_b16 v[68:69], v14 offset:55296
    v_mfma_f32_16x16x32_bf16 v[48:51], v[164:167], v[40:43], v[48:51]
    ds_read_b64_tr_b16 v[70:71], v14 offset:56320
    s_mov_b32 exec_lo, 1
    s_mov_b32 exec_hi, 0
    s_cmp_eq_u32 s53, 0
    s_cbranch_scc1 L_hs_227
    buffer_store_dword v102, v143, s[32:35], s19 offen
L_he_228:
    s_mov_b64 exec, -1
    v_mfma_f32_16x16x32_bf16 v[64:67], v[40:43], v[40:43], v[64:67]
    ds_read_b64_tr_b16 v[72:73], v15 offset:55296
    s_waitcnt lgkmcnt(5)
    v_mfma_f32_16x16x32_bf16 v[28:31], a[216:219], v[52:55], v[28:31]
    ds_read_b64_tr_b16 v[74:75], v15 offset:56320
    v_mfma_f32_16x16x32_bf16 v[44:47], v[168:171], v[52:55], v[44:47]
    ds_read_b64_tr_b16 v[76:77], v14 offset:57344
    s_waitcnt lgkmcnt(5)
    v_mfma_f32_16x16x32_bf16 v[32:35], a[216:219], v[56:59], v[32:35]
    ds_read_b64_tr_b16 v[78:79], v14 offset:58368
    v_mfma_f32_16x16x32_bf16 v[48:51], v[168:171], v[56:59], v[48:51]
    ds_read_b64_tr_b16 v[80:81], v15 offset:57344
    s_waitcnt lgkmcnt(5)
    v_mfma_f32_16x16x32_bf16 v[28:31], a[220:223], v[68:71], v[28:31]
    ds_read_b64_tr_b16 v[82:83], v15 offset:58368
    v_mfma_f32_16x16x32_bf16 v[44:47], v[172:175], v[68:71], v[44:47]
    ds_read_b64_tr_b16 v[84:85], v14 offset:59392
    s_waitcnt lgkmcnt(5)
    v_mfma_f32_16x16x32_bf16 v[32:35], a[220:223], v[72:75], v[32:35]
    ds_read_b64_tr_b16 v[86:87], v14 offset:60416
    v_mfma_f32_16x16x32_bf16 v[48:51], v[172:175], v[72:75], v[48:51]
    ds_read_b64_tr_b16 v[88:89], v15 offset:59392
    s_waitcnt lgkmcnt(5)
    v_mfma_f32_16x16x32_bf16 v[28:31], a[224:227], v[76:79], v[28:31]
    ds_read_b64_tr_b16 v[90:91], v15 offset:60416
    v_mfma_f32_16x16x32_bf16 v[44:47], v[176:179], v[76:79], v[44:47]
    ds_read_b64_tr_b16 v[92:93], v14 offset:61440
    s_waitcnt lgkmcnt(5)
    v_mfma_f32_16x16x32_bf16 v[32:35], a[224:227], v[80:83], v[32:35]
    ds_read_b64_tr_b16 v[94:95], v14 offset:62464
    v_mfma_f32_16x16x32_bf16 v[48:51], v[176:179], v[80:83], v[48:51]
    ds_read_b64_tr_b16 v[96:97], v15 offset:61440
    s_waitcnt lgkmcnt(5)
    v_mfma_f32_16x16x32_bf16 v[28:31], a[228:231], v[84:87], v[28:31]
    ds_read_b64_tr_b16 v[98:99], v15 offset:62464
    v_and_b32 v101, 7, v1
    v_mfma_f32_16x16x32_bf16 v[44:47], v[180:183], v[84:87], v[44:47]
    ds_read_b64_tr_b16 v[20:21], v14 offset:63488
    s_waitcnt lgkmcnt(5)
    v_mfma_f32_16x16x32_bf16 v[32:35], a[228:231], v[88:91], v[32:35]
    ds_read_b64_tr_b16 v[22:23], v14 offset:64512
    v_lshlrev_b32 v101, 2, v101
    v_mfma_f32_16x16x32_bf16 v[48:51], v[180:183], v[88:91], v[48:51]
    ds_read_b64_tr_b16 v[24:25], v15 offset:63488
    s_waitcnt lgkmcnt(5)
    v_mfma_f32_16x16x32_bf16 v[28:31], a[232:235], v[92:95], v[28:31]
    ds_read_b64_tr_b16 v[26:27], v15 offset:64512
    buffer_load_dword v102, v101, s[32:35], s11 offen sc1
    v_mfma_f32_16x16x32_bf16 v[44:47], v[184:187], v[92:95], v[44:47]
    s_waitcnt lgkmcnt(4)
    v_mfma_f32_16x16x32_bf16 v[32:35], a[232:235], v[96:99], v[32:35]
    v_mfma_f32_16x16x32_bf16 v[48:51], v[184:187], v[96:99], v[48:51]
    s_waitcnt lgkmcnt(2)
    v_mfma_f32_16x16x32_bf16 v[28:31], a[236:239], v[20:23], v[28:31]
    v_mfma_f32_16x16x32_bf16 v[44:47], v[188:191], v[20:23], v[44:47]
    s_waitcnt lgkmcnt(0)
    v_mfma_f32_16x16x32_bf16 v[32:35], a[236:239], v[24:27], v[32:35]
    v_mfma_f32_16x16x32_bf16 v[48:51], v[188:191], v[24:27], v[48:51]
    v_mfma_f32_16x16x32_bf16 v[60:63], v[52:55], v[52:55], v[60:63]
    s_mov_b32 exec_lo, 0
    s_mov_b32 exec_hi, 0xffff0000
    s_nop 1
    ds_write_b32 v103, v44 offset:128
    s_nop 1
    ds_write_b32 v103, v48 offset:192
    v_mov_b64 v[44:45], 0
    v_mov_b64 v[46:47], 0
    v_mov_b64 v[48:49], 0
    v_mov_b64 v[50:51], 0
    s_mov_b64 exec, -1
    v_mfma_f32_16x16x32_bf16 v[64:67], v[56:59], v[56:59], v[64:67]
    v_mfma_f32_16x16x32_bf16 v[60:63], v[68:71], v[68:71], v[60:63]
    v_mfma_f32_16x16x32_bf16 v[64:67], v[72:75], v[72:75], v[64:67]
    s_waitcnt lgkmcnt(0)
    s_barrier
    v_mfma_f32_16x16x32_bf16 v[60:63], v[76:79], v[76:79], v[60:63]
    ds_read2_b32 v[136:137], v103 offset0:32 offset1:48
    s_waitcnt vmcnt(0)
    v_mfma_f32_16x16x32_bf16 v[64:67], v[80:83], v[80:83], v[64:67]
    v_cmp_gt_u32 vcc, 3, v102
    s_cbranch_vccnz L_hr_185
L_hb_186:
    v_mfma_f32_16x16x32_bf16 v[60:63], v[84:87], v[84:87], v[60:63]
    v_mfma_f32_16x16x32_bf16 v[64:67], v[88:91], v[88:91], v[64:67]
    s_add_u32 s86, s94, 0
    buffer_load_dwordx4 v[104:107], v143, s[32:35], s86 offen sc1
    v_mfma_f32_16x16x32_bf16 v[60:63], v[92:95], v[92:95], v[60:63]
    v_mfma_f32_16x16x32_bf16 v[64:67], v[96:99], v[96:99], v[64:67]
    v_mfma_f32_16x16x32_bf16 v[60:63], v[20:23], v[20:23], v[60:63]
    s_add_u32 s86, s94, 8192
    buffer_load_dwordx4 v[108:111], v143, s[32:35], s86 offen sc1
    v_mfma_f32_16x16x32_bf16 v[64:67], v[24:27], v[24:27], v[64:67]
    s_add_u32 s86, s95, 0
    buffer_load_dwordx4 v[112:115], v143, s[32:35], s86 offen sc1
    s_waitcnt lgkmcnt(0)
    v_pk_fma_f32 v[28:29], v[136:137], v[2:3], v[28:29] op_sel:[0,0,0] op_sel_hi:[0,1,1] neg_lo:[1,0,0] neg_hi:[1,0,0]
    v_pk_fma_f32 v[30:31], v[136:137], v[4:5], v[30:31] op_sel:[0,0,0] op_sel_hi:[0,1,1] neg_lo:[1,0,0] neg_hi:[1,0,0]
    v_cvt_pk_bf16_f32 v28, v28, v29
    v_cvt_pk_bf16_f32 v29, v30, v31
    v_pk_max_i16 v28, v28, 0
    v_pk_max_i16 v29, v29, 0
    v_pk_fma_f32 v[44:45], v[136:137], v[6:7], v[44:45] op_sel:[0,0,0] op_sel_hi:[0,1,1] neg_lo:[1,0,0] neg_hi:[1,0,0]
    v_pk_fma_f32 v[46:47], v[136:137], v[8:9], v[46:47] op_sel:[0,0,0] op_sel_hi:[0,1,1] neg_lo:[1,0,0] neg_hi:[1,0,0]
    s_add_u32 s86, s95, 8192
    buffer_load_dwordx4 v[116:119], v143, s[32:35], s86 offen sc1
    v_cvt_pk_bf16_f32 v30, v44, v45
    v_cvt_pk_bf16_f32 v31, v46, v47
    v_pk_max_i16 v30, v30, 0
    v_pk_max_i16 v31, v31, 0
    s_add_u32 s86, s100, 0
    buffer_load_dwordx4 v[120:123], v143, s[32:35], s86 offen sc1
    s_add_u32 s80, s12, 131072
    s_cmp_eq_u32 s53, 0
    s_cbranch_scc1 L_hs_229
    buffer_store_dwordx4 v[28:31], v143, s[32:35], s80 offen
L_he_230:
    v_pk_fma_f32 v[32:33], v[136:137], v[2:3], v[32:33] op_sel:[1,0,0] op_sel_hi:[1,1,1] neg_lo:[1,0,0] neg_hi:[1,0,0]
    v_pk_fma_f32 v[34:35], v[136:137], v[4:5], v[34:35] op_sel:[1,0,0] op_sel_hi:[1,1,1] neg_lo:[1,0,0] neg_hi:[1,0,0]
    v_cvt_pk_bf16_f32 v32, v32, v33
    s_add_u32 s86, s100, 8192
    buffer_load_dwordx4 v[124:127], v143, s[32:35], s86 offen sc1
    v_cvt_pk_bf16_f32 v33, v34, v35
    v_pk_max_i16 v32, v32, 0
    v_pk_max_i16 v33, v33, 0
    v_pk_fma_f32 v[48:49], v[136:137], v[6:7], v[48:49] op_sel:[1,0,0] op_sel_hi:[1,1,1] neg_lo:[1,0,0] neg_hi:[1,0,0]
    s_add_u32 s86, s4, 0
    buffer_load_dwordx4 v[128:131], v143, s[32:35], s86 offen sc1
    v_pk_fma_f32 v[50:51], v[136:137], v[8:9], v[50:51] op_sel:[1,0,0] op_sel_hi:[1,1,1] neg_lo:[1,0,0] neg_hi:[1,0,0]
    v_cvt_pk_bf16_f32 v34, v48, v49
    v_cvt_pk_bf16_f32 v35, v50, v51
    v_pk_max_i16 v34, v34, 0
    s_add_u32 s86, s4, 8192
    buffer_load_dwordx4 v[132:135], v143, s[32:35], s86 offen sc1
    v_pk_max_i16 v35, v35, 0
    s_add_u32 s80, s12, 196608
    s_cmp_eq_u32 s53, 0
    s_cbranch_scc1 L_hs_231
    buffer_store_dwordx4 v[32:35], v143, s[32:35], s80 offen
L_he_232:
    v_cndmask_b32 v60, v60, v61, s[24:25]
    v_cndmask_b32 v64, v64, v65, s[24:25]
    v_cndmask_b32 v60, v60, v62, s[68:69]
    v_cndmask_b32 v64, v64, v66, s[68:69]
    v_cndmask_b32 v60, v60, v63, s[70:71]
    v_cndmask_b32 v64, v64, v67, s[70:71]
    s_mov_b32 exec_lo, 0x00f0000f
    s_mov_b32 exec_hi, 0xf0000f00
    ds_write_b32 v103, v60 offset:384
    ds_write_b32 v103, v64 offset:448
    s_mov_b64 exec, -1
L_g1j_140:
    s_add_u32 s86, s6, 0
    buffer_load_dwordx4 v[60:63], v143, s[32:35], s86 offen sc1
    s_add_u32 s86, s6, 8192
    buffer_load_dwordx4 v[64:67], v143, s[32:35], s86 offen sc1
    s_waitcnt vmcnt(11)
    v_mfma_f32_16x16x32_bf16 v[20:23], a[0:3], v[104:107], 0
    s_add_u32 s86, s6, 16384
    buffer_load_dwordx4 v[68:71], v143, s[32:35], s86 offen sc1
    v_mfma_f32_16x16x32_bf16 v[24:27], a[4:7], v[104:107], 0
    s_lshl_b32 s76, s57, 5
    v_xor_b32 v53, s76, v14
    v_mfma_f32_16x16x32_bf16 v[28:31], a[8:11], v[104:107], 0
    v_mfma_f32_16x16x32_bf16 v[32:35], a[12:15], v[104:107], 0
    v_add_u32 v53, s21, v53
    s_waitcnt vmcnt(11)
    v_mfma_f32_16x16x32_bf16 v[20:23], a[16:19], v[108:111], v[20:23]
    s_add_u32 s86, s6, 24576
    buffer_load_dwordx4 v[72:75], v143, s[32:35], s86 offen sc1
    v_mfma_f32_16x16x32_bf16 v[24:27], a[20:23], v[108:111], v[24:27]
    v_bfe_u32 v140, v1, 3, 1
    v_mfma_f32_16x16x32_bf16 v[28:31], a[24:27], v[108:111], v[28:31]
    v_lshlrev_b32 v140, 14, v140
    v_mfma_f32_16x16x32_bf16 v[32:35], a[28:31], v[108:111], v[32:35]
    v_and_b32 v54, 7, v1
    s_waitcnt vmcnt(11)
    v_mfma_f32_16x16x32_bf16 v[20:23], a[32:35], v[112:115], v[20:23]
    s_add_u32 s86, s6, 32768
    buffer_load_dwordx4 v[76:79], v143, s[32:35], s86 offen sc1
    v_mfma_f32_16x16x32_bf16 v[24:27], a[36:39], v[112:115], v[24:27]
    v_mov_b32 v52, 4
    s_waitcnt vmcnt(5)
    v_mfma_f32_16x16x32_bf16 v[28:31], a[40:43], v[112:115], v[28:31]
    v_lshl_add_u32 v140, v54, 10, v140
    v_mfma_f32_16x16x32_bf16 v[32:35], a[44:47], v[112:115], v[32:35]
    s_mov_b32 exec_lo, 1
    s_mov_b32 exec_hi, 0
    s_cmp_eq_u32 s53, 0
    s_cbranch_scc1 L_hs_241
    buffer_store_dword v52, v143, s[32:35], s19 offen
L_he_242:
    s_mov_b64 exec, -1
    v_mfma_f32_16x16x32_bf16 v[20:23], a[48:51], v[116:119], v[20:23]
    s_add_u32 s86, s6, 40960
    buffer_load_dwordx4 v[80:83], v143, s[32:35], s86 offen sc1
    v_mfma_f32_16x16x32_bf16 v[24:27], a[52:55], v[116:119], v[24:27]
    v_bfe_u32 v54, v1, 4, 1
    v_lshl_add_u32 v140, v54, 5, v140
    v_mfma_f32_16x16x32_bf16 v[28:31], a[56:59], v[116:119], v[28:31]
    v_lshrrev_b32 v54, 5, v1
    v_mfma_f32_16x16x32_bf16 v[32:35], a[60:63], v[116:119], v[32:35]
    v_lshl_add_u32 v140, v54, 4, v140
    v_mfma_f32_16x16x32_bf16 v[20:23], a[64:67], v[120:123], v[20:23]
    s_add_u32 s86, s101, 0
    buffer_load_dwordx4 v[84:87], v143, s[32:35], s86 offen sc1
    v_mfma_f32_16x16x32_bf16 v[24:27], a[68:71], v[120:123], v[24:27]
    v_and_b32 v54, 15, v1
    v_mfma_f32_16x16x32_bf16 v[28:31], a[72:75], v[120:123], v[28:31]
    v_lshlrev_b32 v54, 2, v54
    v_mfma_f32_16x16x32_bf16 v[32:35], a[76:79], v[120:123], v[32:35]
    v_lshl_add_u32 v54, s57, 6, v54
    v_mfma_f32_16x16x32_bf16 v[20:23], a[80:83], v[124:127], v[20:23]
    s_add_u32 s86, s101, 8192
    buffer_load_dwordx4 v[144:147], v143, s[32:35], s86 offen sc1
    v_mfma_f32_16x16x32_bf16 v[24:27], a[84:87], v[124:127], v[24:27]
    v_add_u32 v142, s10, v143
    v_mfma_f32_16x16x32_bf16 v[28:31], a[88:91], v[124:127], v[28:31]
    v_mfma_f32_16x16x32_bf16 v[32:35], a[92:95], v[124:127], v[32:35]
    v_mfma_f32_16x16x32_bf16 v[20:23], a[96:99], v[128:131], v[20:23]
    s_add_u32 s86, s18, 0
    buffer_load_dwordx4 v[148:151], v143, s[32:35], s86 offen sc1
    v_mfma_f32_16x16x32_bf16 v[24:27], a[100:103], v[128:131], v[24:27]
    v_mfma_f32_16x16x32_bf16 v[28:31], a[104:107], v[128:131], v[28:31]
    v_mfma_f32_16x16x32_bf16 v[32:35], a[108:111], v[128:131], v[32:35]
    v_mfma_f32_16x16x32_bf16 v[20:23], a[112:115], v[132:135], v[20:23]
    s_add_u32 s86, s18, 8192
    buffer_load_dwordx4 v[152:155], v143, s[32:35], s86 offen sc1
    v_mfma_f32_16x16x32_bf16 v[24:27], a[116:119], v[132:135], v[24:27]
    v_mfma_f32_16x16x32_bf16 v[28:31], a[120:123], v[132:135], v[28:31]
    v_mfma_f32_16x16x32_bf16 v[32:35], a[124:127], v[132:135], v[32:35]
    s_waitcnt vmcnt(8)
    v_mfma_f32_16x16x32_bf16 v[20:23], a[128:131], v[62:65], v[20:23]
    s_add_u32 s86, s54, 0
    buffer_load_dwordx4 v[156:159], v143, s[32:35], s86 offen sc1
    v_mfma_f32_16x16x32_bf16 v[24:27], a[132:135], v[62:65], v[24:27]
    v_mfma_f32_16x16x32_bf16 v[28:31], a[136:139], v[62:65], v[28:31]
    v_mfma_f32_16x16x32_bf16 v[32:35], a[140:143], v[62:65], v[32:35]
    v_mov_b32 v62, v66
    s_waitcnt vmcnt(8)
    v_mfma_f32_16x16x32_bf16 v[20:23], a[144:147], v[70:73], v[20:23]
    s_add_u32 s86, s54, 8192
    buffer_load_dwordx4 v[160:163], v143, s[32:35], s86 offen sc1
    v_mfma_f32_16x16x32_bf16 v[24:27], a[148:151], v[70:73], v[24:27]
    v_mov_b32 v63, v67
    v_mfma_f32_16x16x32_bf16 v[28:31], a[152:155], v[70:73], v[28:31]
    v_mfma_f32_16x16x32_bf16 v[32:35], a[156:159], v[70:73], v[32:35]
    v_mov_b32 v70, v74
    v_mov_b32 v71, v75
    v_mfma_f32_16x16x32_bf16 v[36:39], a[128:131], v[60:63], 0
    s_add_u32 s86, s5, 0
    buffer_load_dwordx4 v[164:167], v143, s[32:35], s86 offen sc1
    v_mfma_f32_16x16x32_bf16 v[40:43], a[132:135], v[60:63], 0
    v_mfma_f32_16x16x32_bf16 v[44:47], a[136:139], v[60:63], 0
    v_mfma_f32_16x16x32_bf16 v[48:51], a[140:143], v[60:63], 0
    s_waitcnt vmcnt(7)
    v_mfma_f32_16x16x32_bf16 v[20:23], a[160:163], v[78:81], v[20:23]
    s_add_u32 s86, s5, 8192
    buffer_load_dwordx4 v[168:171], v143, s[32:35], s86 offen sc1
    v_mfma_f32_16x16x32_bf16 v[24:27], a[164:167], v[78:81], v[24:27]
    v_and_b32 v136, 7, v1
    v_mfma_f32_16x16x32_bf16 v[28:31], a[168:171], v[78:81], v[28:31]
    v_lshlrev_b32 v136, 2, v136
    v_mfma_f32_16x16x32_bf16 v[32:35], a[172:175], v[78:81], v[32:35]
    v_mov_b32 v78, v82
    v_mov_b32 v79, v83
    v_mfma_f32_16x16x32_bf16 v[36:39], a[144:147], v[68:71], v[36:39]
    buffer_load_dword v137, v136, s[32:35], s11 offen sc1
    v_mfma_f32_16x16x32_bf16 v[40:43], a[148:151], v[68:71], v[40:43]
    v_mfma_f32_16x16x32_bf16 v[44:47], a[152:155], v[68:71], v[44:47]
    v_add_u32 v52, s7, v143
    v_mfma_f32_16x16x32_bf16 v[48:51], a[156:159], v[68:71], v[48:51]
    ds_write_b128 v52, v[20:23] offset:0
    s_waitcnt vmcnt(7)
    v_mfma_f32_16x16x32_bf16 v[36:39], a[0:3], v[84:87], v[36:39]
    ds_write_b128 v52, v[24:27] offset:1024
    v_mfma_f32_16x16x32_bf16 v[40:43], a[4:7], v[84:87], v[40:43]
    v_add_u32 v52, s8, v143
    v_mfma_f32_16x16x32_bf16 v[44:47], a[8:11], v[84:87], v[44:47]
    ds_write_b128 v52, v[28:31] offset:0
    v_mfma_f32_16x16x32_bf16 v[48:51], a[12:15], v[84:87], v[48:51]
    ds_write_b128 v52, v[32:35] offset:1024
    v_mfma_f32_16x16x32_bf16 v[36:39], a[160:163], v[76:79], v[36:39]
    v_mfma_f32_16x16x32_bf16 v[40:43], a[164:167], v[76:79], v[40:43]
    v_mfma_f32_16x16x32_bf16 v[44:47], a[168:171], v[76:79], v[44:47]
    v_mfma_f32_16x16x32_bf16 v[48:51], a[172:175], v[76:79], v[48:51]
    s_waitcnt lgkmcnt(0)
    s_barrier
    v_mfma_f32_16x16x32_bf16 v[36:39], a[16:19], v[144:147], v[36:39]
    v_mfma_f32_16x16x32_bf16 v[40:43], a[20:23], v[144:147], v[40:43]
    ds_read_b128 v[84:87], v142 offset:0
    v_mfma_f32_16x16x32_bf16 v[44:47], a[24:27], v[144:147], v[44:47]
    s_waitcnt vmcnt(0)
    ds_read_b128 v[88:91], v142 offset:1024
    v_mfma_f32_16x16x32_bf16 v[48:51], a[28:31], v[144:147], v[48:51]
    v_cmp_gt_u32 vcc, 4, v137
    s_cbranch_vccnz L_hr_233
L_hb_234:
    v_mfma_f32_16x16x32_bf16 v[36:39], a[32:35], v[148:151], v[36:39]
    s_add_u32 s86, s94, 131072
    buffer_load_dwordx4 v[172:175], v143, s[32:35], s86 offen sc1
    v_mfma_f32_16x16x32_bf16 v[40:43], a[36:39], v[148:151], v[40:43]
    ds_read_b128 v[20:23], v142 offset:2048
    v_mfma_f32_16x16x32_bf16 v[44:47], a[40:43], v[148:151], v[44:47]
    ds_read_b128 v[24:27], v142 offset:3072
    v_mfma_f32_16x16x32_bf16 v[48:51], a[44:47], v[148:151], v[48:51]
    ds_read_b32 v136, v54 offset:25856
    v_mfma_f32_16x16x32_bf16 v[36:39], a[48:51], v[152:155], v[36:39]
    s_add_u32 s86, s94, 139264
    buffer_load_dwordx4 v[104:107], v143, s[32:35], s86 offen sc1
    v_mfma_f32_16x16x32_bf16 v[40:43], a[52:55], v[152:155], v[40:43]
    ds_read_b32 v100, v54 offset:26112
    s_waitcnt lgkmcnt(0)
    v_mfma_f32_16x16x32_bf16 v[44:47], a[56:59], v[152:155], v[44:47]
    v_mul_f32 v136, 0x3b000000, v136
    v_fmamk_f32 v100, v100, 0x3b000000, v19
    v_mfma_f32_16x16x32_bf16 v[48:51], a[60:63], v[152:155], v[48:51]
    v_fma_f32 v100, -v136, v136, v100
    v_max_f32 v100, v100, v19
    v_mfma_f32_16x16x32_bf16 v[36:39], a[64:67], v[156:159], v[36:39]
    s_add_u32 s86, s95, 131072
    buffer_load_dwordx4 v[108:111], v143, s[32:35], s86 offen sc1
    v_mfma_f32_16x16x32_bf16 v[40:43], a[68:71], v[156:159], v[40:43]
    v_rsq_f32 v100, v100
    ds_read_b64_tr_b16 v[94:95], v53 offset:0
    v_mfma_f32_16x16x32_bf16 v[44:47], a[72:75], v[156:159], v[44:47]
    ds_read_b64_tr_b16 v[98:99], v53 offset:1024
    v_add_f32 v84, v84, v20
    v_mfma_f32_16x16x32_bf16 v[48:51], a[76:79], v[156:159], v[48:51]
    v_add_f32 v85, v85, v21
L_stub_10:
    s_cbranch_execz L_warm_back
    s_nop 0
    v_add_f32 v86, v86, v22
    v_mfma_f32_16x16x32_bf16 v[36:39], a[80:83], v[160:163], v[36:39]
    s_add_u32 s86, s95, 139264
    buffer_load_dwordx4 v[112:115], v143, s[32:35], s86 offen sc1
    v_mfma_f32_16x16x32_bf16 v[40:43], a[84:87], v[160:163], v[40:43]
    v_add_f32 v87, v87, v23
    s_waitcnt lgkmcnt(0)
    v_mfma_f32_16x16x32_bf16 v[44:47], a[88:91], v[160:163], v[44:47]
    v_lshlrev_b32 v92, 16, v94
    v_add_f32 v88, v88, v24
    v_mfma_f32_16x16x32_bf16 v[48:51], a[92:95], v[160:163], v[48:51]
    v_and_b32 v93, 0xffff0000, v94
    v_lshlrev_b32 v94, 16, v95
    v_mfma_f32_16x16x32_bf16 v[36:39], a[96:99], v[164:167], v[36:39]
    s_add_u32 s86, s100, 131072
    buffer_load_dwordx4 v[116:119], v143, s[32:35], s86 offen sc1
    v_mfma_f32_16x16x32_bf16 v[40:43], a[100:103], v[164:167], v[40:43]
    v_add_f32 v89, v89, v25
    v_and_b32 v95, 0xffff0000, v95
    v_mfma_f32_16x16x32_bf16 v[44:47], a[104:107], v[164:167], v[44:47]
    v_lshlrev_b32 v96, 16, v98
    v_and_b32 v97, 0xffff0000, v98
    v_mfma_f32_16x16x32_bf16 v[48:51], a[108:111], v[164:167], v[48:51]
    v_add_f32 v90, v90, v26
    v_lshlrev_b32 v98, 16, v99
    v_mfma_f32_16x16x32_bf16 v[36:39], a[112:115], v[168:171], v[36:39]
    s_add_u32 s86, s100, 139264
    buffer_load_dwordx4 v[120:123], v143, s[32:35], s86 offen sc1
    v_mfma_f32_16x16x32_bf16 v[40:43], a[116:119], v[168:171], v[40:43]
    v_and_b32 v99, 0xffff0000, v99
    v_add_f32 v91, v91, v27
    v_mfma_f32_16x16x32_bf16 v[44:47], a[120:123], v[168:171], v[44:47]
    v_mfma_f32_16x16x32_bf16 v[48:51], a[124:127], v[168:171], v[48:51]
    v_add_u32 v52, s9, v143
    s_waitcnt vmcnt(5)
    v_mfma_f32_16x16x32_bf16 v[20:23], a[0:3], v[172:175], 0
    s_add_u32 s86, s4, 131072
    buffer_load_dwordx4 v[124:127], v143, s[32:35], s86 offen sc1
    v_mfma_f32_16x16x32_bf16 v[24:27], a[4:7], v[172:175], 0
    ds_write_b128 v52, v[36:39] offset:0
    v_mfma_f32_16x16x32_bf16 v[28:31], a[8:11], v[172:175], 0
    ds_write_b128 v52, v[40:43] offset:1024
    v_mfma_f32_16x16x32_bf16 v[32:35], a[12:15], v[172:175], 0
    s_waitcnt vmcnt(5)
    v_mfma_f32_16x16x32_bf16 v[20:23], a[16:19], v[104:107], v[20:23]
    s_add_u32 s86, s4, 139264
    buffer_load_dwordx4 v[128:131], v143, s[32:35], s86 offen sc1
    v_mfma_f32_16x16x32_bf16 v[24:27], a[20:23], v[104:107], v[24:27]
    s_waitcnt lgkmcnt(0)
    s_barrier
    v_mfma_f32_16x16x32_bf16 v[28:31], a[24:27], v[104:107], v[28:31]
    ds_read_b128 v[36:39], v142 offset:4096
    v_mfma_f32_16x16x32_bf16 v[32:35], a[28:31], v[104:107], v[32:35]
    ds_read_b128 v[40:43], v142 offset:5120
    s_waitcnt vmcnt(5)
    v_mfma_f32_16x16x32_bf16 v[20:23], a[32:35], v[108:111], v[20:23]
    s_add_u32 s86, s6, 49152
    buffer_load_dwordx4 v[60:63], v143, s[32:35], s86 offen sc1
    v_mfma_f32_16x16x32_bf16 v[24:27], a[36:39], v[108:111], v[24:27]
    v_add_f32 v84, v84, v44
    v_add_f32 v85, v85, v45
    v_mfma_f32_16x16x32_bf16 v[28:31], a[40:43], v[108:111], v[28:31]
    v_add_f32 v86, v86, v46
    v_add_f32 v87, v87, v47
    v_mfma_f32_16x16x32_bf16 v[32:35], a[44:47], v[108:111], v[32:35]
    v_add_f32 v88, v88, v48
    s_waitcnt vmcnt(5)
    v_mfma_f32_16x16x32_bf16 v[20:23], a[48:51], v[112:115], v[20:23]
    s_add_u32 s86, s6, 57344
    buffer_load_dwordx4 v[64:67], v143, s[32:35], s86 offen sc1
    v_mfma_f32_16x16x32_bf16 v[24:27], a[52:55], v[112:115], v[24:27]
    v_add_f32 v89, v89, v49
    v_add_f32 v90, v90, v50
    v_mfma_f32_16x16x32_bf16 v[28:31], a[56:59], v[112:115], v[28:31]
    v_add_f32 v91, v91, v51
    s_waitcnt lgkmcnt(0)
    v_mfma_f32_16x16x32_bf16 v[32:35], a[60:63], v[112:115], v[32:35]
    v_add_f32 v84, v84, v36
    s_waitcnt vmcnt(5)
    v_mfma_f32_16x16x32_bf16 v[20:23], a[64:67], v[116:119], v[20:23]
    s_add_u32 s86, s6, 65536
    buffer_load_dwordx4 v[68:71], v143, s[32:35], s86 offen sc1
    v_mfma_f32_16x16x32_bf16 v[24:27], a[68:71], v[116:119], v[24:27]
    v_add_f32 v85, v85, v37
    v_add_f32 v86, v86, v38
    v_mfma_f32_16x16x32_bf16 v[28:31], a[72:75], v[116:119], v[28:31]
    v_add_f32 v87, v87, v39
    v_add_f32 v88, v88, v40
    v_mfma_f32_16x16x32_bf16 v[32:35], a[76:79], v[116:119], v[32:35]
    v_add_f32 v89, v89, v41
    s_waitcnt vmcnt(5)
    v_mfma_f32_16x16x32_bf16 v[20:23], a[80:83], v[120:123], v[20:23]
    s_add_u32 s86, s6, 73728
    buffer_load_dwordx4 v[72:75], v143, s[32:35], s86 offen sc1
    v_mfma_f32_16x16x32_bf16 v[24:27], a[84:87], v[120:123], v[24:27]
    v_add_f32 v90, v90, v42
    v_add_f32 v91, v91, v43
    v_mfma_f32_16x16x32_bf16 v[28:31], a[88:91], v[120:123], v[28:31]
    v_fmac_f32 v92, v84, v100
    v_fmac_f32 v93, v85, v100
    v_mfma_f32_16x16x32_bf16 v[32:35], a[92:95], v[120:123], v[32:35]
    v_fmac_f32 v94, v86, v100
    s_waitcnt vmcnt(5)
    v_mfma_f32_16x16x32_bf16 v[20:23], a[96:99], v[124:127], v[20:23]
    s_add_u32 s86, s6, 81920
    buffer_load_dwordx4 v[76:79], v143, s[32:35], s86 offen sc1
    v_mfma_f32_16x16x32_bf16 v[24:27], a[100:103], v[124:127], v[24:27]
    v_fmac_f32 v95, v87, v100
    v_fmac_f32 v96, v88, v100
    v_mfma_f32_16x16x32_bf16 v[28:31], a[104:107], v[124:127], v[28:31]
    v_fmac_f32 v97, v89, v100
    v_fmac_f32 v98, v90, v100
    v_mfma_f32_16x16x32_bf16 v[32:35], a[108:111], v[124:127], v[32:35]
    v_fmac_f32 v99, v91, v100
    s_waitcnt vmcnt(5)
    v_mfma_f32_16x16x32_bf16 v[20:23], a[112:115], v[128:131], v[20:23]
    s_add_u32 s86, s6, 90112
    buffer_load_dwordx4 v[80:83], v143, s[32:35], s86 offen sc1
    v_mfma_f32_16x16x32_bf16 v[24:27], a[116:119], v[128:131], v[24:27]
    v_cvt_pk_bf16_f32 v84, v92, v93
    v_cvt_pk_bf16_f32 v85, v94, v95
    v_mfma_f32_16x16x32_bf16 v[28:31], a[120:123], v[128:131], v[28:31]
    v_cvt_pk_bf16_f32 v86, v96, v97
    v_cvt_pk_bf16_f32 v87, v98, v99
    v_mfma_f32_16x16x32_bf16 v[32:35], a[124:127], v[128:131], v[32:35]
    v_permlane16_swap_b32 v84, v86
    s_waitcnt vmcnt(4)
    v_mfma_f32_16x16x32_bf16 v[20:23], a[128:131], v[62:65], v[20:23]
    s_add_u32 s86, s101, 131072
    buffer_load_dwordx4 v[132:135], v143, s[32:35], s86 offen sc1
    v_mfma_f32_16x16x32_bf16 v[24:27], a[132:135], v[62:65], v[24:27]
    v_permlane16_swap_b32 v85, v87
    s_add_u32 s76, s22, 0
    buffer_store_dwordx4 v[84:87], v140, s[44:47], s76 offen
    v_mfma_f32_16x16x32_bf16 v[28:31], a[136:139], v[62:65], v[28:31]
    v_mfma_f32_16x16x32_bf16 v[32:35], a[140:143], v[62:65], v[32:35]
    v_mov_b32 v62, v66
    s_waitcnt vmcnt(4)
    v_mfma_f32_16x16x32_bf16 v[20:23], a[144:147], v[70:73], v[20:23]
    s_add_u32 s86, s101, 139264
    buffer_load_dwordx4 v[144:147], v143, s[32:35], s86 offen sc1
    v_mfma_f32_16x16x32_bf16 v[24:27], a[148:151], v[70:73], v[24:27]
    v_mov_b32 v63, v67
    ds_read_b32 v136, v54 offset:25984
    v_mfma_f32_16x16x32_bf16 v[28:31], a[152:155], v[70:73], v[28:31]
    ds_read_b32 v56, v54 offset:26240
    v_mfma_f32_16x16x32_bf16 v[32:35], a[156:159], v[70:73], v[32:35]
    v_mov_b32 v70, v74
    v_mov_b32 v71, v75
    v_mfma_f32_16x16x32_bf16 v[36:39], a[128:131], v[60:63], 0
    s_add_u32 s86, s18, 131072
    buffer_load_dwordx4 v[148:151], v143, s[32:35], s86 offen sc1
    v_mfma_f32_16x16x32_bf16 v[40:43], a[132:135], v[60:63], 0
    s_waitcnt lgkmcnt(0)
    v_mul_f32 v136, 0x3b000000, v136
    v_mfma_f32_16x16x32_bf16 v[44:47], a[136:139], v[60:63], 0
    v_fmamk_f32 v56, v56, 0x3b000000, v19
    v_fma_f32 v56, -v136, v136, v56
    v_mfma_f32_16x16x32_bf16 v[48:51], a[140:143], v[60:63], 0
    v_max_f32 v56, v56, v19
    s_waitcnt vmcnt(4)
    v_mfma_f32_16x16x32_bf16 v[20:23], a[160:163], v[78:81], v[20:23]
    s_add_u32 s86, s18, 139264
    buffer_load_dwordx4 v[152:155], v143, s[32:35], s86 offen sc1
    v_mfma_f32_16x16x32_bf16 v[24:27], a[164:167], v[78:81], v[24:27]
    v_rsq_f32 v56, v56
    v_mfma_f32_16x16x32_bf16 v[28:31], a[168:171], v[78:81], v[28:31]
    v_mfma_f32_16x16x32_bf16 v[32:35], a[172:175], v[78:81], v[32:35]
    v_mov_b32 v78, v82
    v_mov_b32 v79, v83
    v_mfma_f32_16x16x32_bf16 v[36:39], a[144:147], v[68:71], v[36:39]
    s_add_u32 s86, s54, 131072
    buffer_load_dwordx4 v[156:159], v143, s[32:35], s86 offen sc1
    v_mfma_f32_16x16x32_bf16 v[40:43], a[148:151], v[68:71], v[40:43]
    v_add_u32 v52, s7, v143
    v_mfma_f32_16x16x32_bf16 v[44:47], a[152:155], v[68:71], v[44:47]
    ds_write_b128 v52, v[20:23] offset:6144
    v_mfma_f32_16x16x32_bf16 v[48:51], a[156:159], v[68:71], v[48:51]
    ds_write_b128 v52, v[24:27] offset:7168
    s_waitcnt vmcnt(5)
    v_mfma_f32_16x16x32_bf16 v[36:39], a[0:3], v[132:135], v[36:39]
    s_add_u32 s86, s54, 139264
    buffer_load_dwordx4 v[160:163], v143, s[32:35], s86 offen sc1
    v_mfma_f32_16x16x32_bf16 v[40:43], a[4:7], v[132:135], v[40:43]
    v_add_u32 v52, s8, v143
    ds_read_b64_tr_b16 v[70:71], v53 offset:32768
    v_mfma_f32_16x16x32_bf16 v[44:47], a[8:11], v[132:135], v[44:47]
    ds_read_b64_tr_b16 v[74:75], v53 offset:33792
    v_mfma_f32_16x16x32_bf16 v[48:51], a[12:15], v[132:135], v[48:51]
    ds_write_b128 v52, v[28:31] offset:6144
    v_mfma_f32_16x16x32_bf16 v[36:39], a[160:163], v[76:79], v[36:39]
    s_add_u32 s86, s5, 131072
    buffer_load_dwordx4 v[164:167], v143, s[32:35], s86 offen sc1
    v_mfma_f32_16x16x32_bf16 v[40:43], a[164:167], v[76:79], v[40:43]
    ds_write_b128 v52, v[32:35] offset:7168
    s_waitcnt lgkmcnt(2)
    v_mfma_f32_16x16x32_bf16 v[44:47], a[168:171], v[76:79], v[44:47]
    v_lshlrev_b32 v68, 16, v70
    v_mfma_f32_16x16x32_bf16 v[48:51], a[172:175], v[76:79], v[48:51]
    s_waitcnt lgkmcnt(0)
    s_barrier
    s_waitcnt vmcnt(5)
    v_mfma_f32_16x16x32_bf16 v[36:39], a[16:19], v[144:147], v[36:39]
    s_add_u32 s86, s5, 139264
    buffer_load_dwordx4 v[168:171], v143, s[32:35], s86 offen sc1
    v_mfma_f32_16x16x32_bf16 v[40:43], a[20:23], v[144:147], v[40:43]
    v_and_b32 v69, 0xffff0000, v70
    s_waitcnt vmcnt(5)
    v_mfma_f32_16x16x32_bf16 v[36:39], a[32:35], v[148:151], v[36:39]
    v_lshlrev_b32 v70, 16, v71
    ds_read_b128 v[60:63], v142 offset:6144
    v_mfma_f32_16x16x32_bf16 v[40:43], a[36:39], v[148:151], v[40:43]
    v_and_b32 v71, 0xffff0000, v71
    s_waitcnt vmcnt(4)
    v_mfma_f32_16x16x32_bf16 v[36:39], a[48:51], v[152:155], v[36:39]
    v_lshlrev_b32 v72, 16, v74
    ds_read_b128 v[64:67], v142 offset:7168
    v_mfma_f32_16x16x32_bf16 v[40:43], a[52:55], v[152:155], v[40:43]
    v_and_b32 v73, 0xffff0000, v74
    s_waitcnt vmcnt(3)
    v_mfma_f32_16x16x32_bf16 v[36:39], a[64:67], v[156:159], v[36:39]
    v_lshlrev_b32 v74, 16, v75
    ds_read_b128 v[20:23], v142 offset:8192
    v_mfma_f32_16x16x32_bf16 v[40:43], a[68:71], v[156:159], v[40:43]
    v_and_b32 v75, 0xffff0000, v75
    s_waitcnt vmcnt(2)
    v_mfma_f32_16x16x32_bf16 v[36:39], a[80:83], v[160:163], v[36:39]
    ds_read_b128 v[24:27], v142 offset:9216
    s_waitcnt lgkmcnt(0)
    v_mfma_f32_16x16x32_bf16 v[40:43], a[84:87], v[160:163], v[40:43]
    v_add_f32 v60, v60, v20
    s_waitcnt vmcnt(1)
    v_mfma_f32_16x16x32_bf16 v[36:39], a[96:99], v[164:167], v[36:39]
    v_add_f32 v61, v61, v21
    v_mfma_f32_16x16x32_bf16 v[40:43], a[100:103], v[164:167], v[40:43]
    v_add_f32 v62, v62, v22
    s_waitcnt vmcnt(0)
    v_mfma_f32_16x16x32_bf16 v[36:39], a[112:115], v[168:171], v[36:39]
    v_add_f32 v63, v63, v23
    v_mfma_f32_16x16x32_bf16 v[40:43], a[116:119], v[168:171], v[40:43]
    v_add_f32 v64, v64, v24
    v_mfma_f32_16x16x32_bf16 v[44:47], a[24:27], v[144:147], v[44:47]
    v_add_f32 v65, v65, v25
    v_mfma_f32_16x16x32_bf16 v[48:51], a[28:31], v[144:147], v[48:51]
    v_add_f32 v66, v66, v26
    v_add_u32 v52, s9, v143
    v_mfma_f32_16x16x32_bf16 v[44:47], a[40:43], v[148:151], v[44:47]
    v_add_f32 v67, v67, v27
    ds_write_b128 v52, v[36:39] offset:6144
    v_mfma_f32_16x16x32_bf16 v[48:51], a[44:47], v[148:151], v[48:51]
    ds_write_b128 v52, v[40:43] offset:7168
    v_mfma_f32_16x16x32_bf16 v[44:47], a[56:59], v[152:155], v[44:47]
    v_mfma_f32_16x16x32_bf16 v[48:51], a[60:63], v[152:155], v[48:51]
    v_mfma_f32_16x16x32_bf16 v[44:47], a[72:75], v[156:159], v[44:47]
    v_mfma_f32_16x16x32_bf16 v[48:51], a[76:79], v[156:159], v[48:51]
    s_waitcnt lgkmcnt(0)
    s_barrier
    v_mfma_f32_16x16x32_bf16 v[44:47], a[88:91], v[160:163], v[44:47]
    ds_read_b128 v[28:31], v142 offset:10240
    v_mfma_f32_16x16x32_bf16 v[48:51], a[92:95], v[160:163], v[48:51]
    ds_read_b128 v[32:35], v142 offset:11264
    v_mfma_f32_16x16x32_bf16 v[44:47], a[104:107], v[164:167], v[44:47]
    v_mfma_f32_16x16x32_bf16 v[48:51], a[108:111], v[164:167], v[48:51]
    v_mfma_f32_16x16x32_bf16 v[44:47], a[120:123], v[168:171], v[44:47]
    v_mfma_f32_16x16x32_bf16 v[48:51], a[124:127], v[168:171], v[48:51]
    s_nop 6
    v_pk_add_f32 v[60:61], v[60:61], v[44:45]
    v_pk_add_f32 v[62:63], v[62:63], v[46:47]
    v_pk_add_f32 v[64:65], v[64:65], v[48:49]
    v_pk_add_f32 v[66:67], v[66:67], v[50:51]
    s_waitcnt lgkmcnt(0)
    v_pk_add_f32 v[60:61], v[60:61], v[28:29]
    v_pk_add_f32 v[62:63], v[62:63], v[30:31]
    v_pk_add_f32 v[64:65], v[64:65], v[32:33]
    v_pk_add_f32 v[66:67], v[66:67], v[34:35]
    v_fmac_f32 v68, v60, v56
    v_fmac_f32 v69, v61, v56
    v_fmac_f32 v70, v62, v56
    v_fmac_f32 v71, v63, v56
    v_fmac_f32 v72, v64, v56
    v_fmac_f32 v73, v65, v56
    v_fmac_f32 v74, v66, v56
    v_fmac_f32 v75, v67, v56
    v_cvt_pk_bf16_f32 v60, v68, v69
    v_cvt_pk_bf16_f32 v61, v70, v71
    v_cvt_pk_bf16_f32 v62, v72, v73
    v_cvt_pk_bf16_f32 v63, v74, v75
    s_nop 0
    v_permlane16_swap_b32 v60, v62
    v_permlane16_swap_b32 v61, v63
    s_add_u32 s76, s22, 1048576
    buffer_store_dwordx4 v[60:63], v140, s[44:47], s76 offen
L_end:
    s_endpgm
L_cold:
L_re_25:
    s_sub_u32 s56, s56, 1
    s_cbranch_scc1 L_bail
    s_mov_b32 s60, m0
    s_mov_b32 s61, s76
    s_add_u32 m0, s20, 0
    s_add_u32 s76, s15, 0
    buffer_load_dwordx4 v100, s[32:35], s76 offen offset:0 sc1 lds
    s_add_u32 s76, s15, 64512
    buffer_load_dwordx4 v100, s[32:35], s76 offen offset:1024 sc1 lds
    s_add_u32 s76, s15, 129024
    buffer_load_dwordx4 v100, s[32:35], s76 offen offset:2048 sc1 lds
    s_add_u32 s76, s15, 193536
    buffer_load_dwordx4 v100, s[32:35], s76 offen offset:3072 sc1 lds
    s_waitcnt vmcnt(0)
    s_mov_b32 m0, s60
    s_mov_b32 s76, s61
    ds_read2st64_b32 v[104:105], v101 offset0:0 offset1:4
    ds_read2st64_b32 v[106:107], v101 offset0:8 offset1:12
    s_waitcnt lgkmcnt(0)
    v_or3_b32 v104, v104, v105, -2
    v_or3_b32 v102, v104, v106, v107
    v_cmp_eq_u32 vcc, -1, v102
    s_cbranch_vccnz L_re_25
    s_branch L_bk_26
L_re_29:
    s_sub_u32 s56, s56, 1
    s_cbranch_scc1 L_bail
    s_mov_b32 s60, m0
    s_mov_b32 s61, s76
    s_add_u32 m0, s20, 16384
    s_add_u32 s76, s52, 0
    buffer_load_dwordx4 v100, s[32:35], s76 offen offset:0 sc1 lds
    s_add_u32 s76, s52, 64512
    buffer_load_dwordx4 v100, s[32:35], s76 offen offset:1024 sc1 lds
    s_add_u32 s76, s52, 129024
    buffer_load_dwordx4 v100, s[32:35], s76 offen offset:2048 sc1 lds
    s_add_u32 s76, s52, 193536
    buffer_load_dwordx4 v100, s[32:35], s76 offen offset:3072 sc1 lds
    s_waitcnt vmcnt(0)
    s_mov_b32 m0, s60
    s_mov_b32 s76, s61
    ds_read2st64_b32 v[104:105], v101 offset0:64 offset1:68
    ds_read2st64_b32 v[106:107], v101 offset0:72 offset1:76
    s_waitcnt lgkmcnt(0)
    v_or3_b32 v104, v104, v105, -2
    v_or3_b32 v102, v104, v106, v107
    v_cmp_eq_u32 vcc, -1, v102
    s_cbranch_vccnz L_re_29
    s_branch L_bk_30
L_re_31:
    s_sub_u32 s56, s56, 1
    s_cbranch_scc1 L_bail
    s_mov_b32 s60, m0
    s_mov_b32 s61, s76
    s_add_u32 m0, s20, 32768
    s_add_u32 s76, s15, 2048
    buffer_load_dwordx4 v100, s[32:35], s76 offen offset:0 sc1 lds
    s_add_u32 s76, s15, 66560
    buffer_load_dwordx4 v100, s[32:35], s76 offen offset:1024 sc1 lds
    s_add_u32 s76, s15, 131072
    buffer_load_dwordx4 v100, s[32:35], s76 offen offset:2048 sc1 lds
    s_add_u32 s76, s15, 195584
    buffer_load_dwordx4 v100, s[32:35], s76 offen offset:3072 sc1 lds
    s_waitcnt vmcnt(0)
    s_mov_b32 m0, s60
    s_mov_b32 s76, s61
    ds_read2st64_b32 v[104:105], v101 offset0:128 offset1:132
    ds_read2st64_b32 v[106:107], v101 offset0:136 offset1:140
    s_waitcnt lgkmcnt(0)
    v_or3_b32 v104, v104, v105, -2
    v_or3_b32 v102, v104, v106, v107
    v_cmp_eq_u32 vcc, -1, v102
    s_cbranch_vccnz L_re_31
    s_branch L_bk_32
L_re_33:
    s_sub_u32 s56, s56, 1
    s_cbranch_scc1 L_bail
    s_mov_b32 s60, m0
    s_mov_b32 s61, s76
    s_add_u32 m0, s20, 49152
    s_add_u32 s76, s52, 2048
    buffer_load_dwordx4 v100, s[32:35], s76 offen offset:0 sc1 lds
    s_add_u32 s76, s52, 66560
    buffer_load_dwordx4 v100, s[32:35], s76 offen offset:1024 sc1 lds
    s_add_u32 s76, s52, 131072
    buffer_load_dwordx4 v100, s[32:35], s76 offen offset:2048 sc1 lds
    s_add_u32 s76, s52, 195584
    buffer_load_dwordx4 v100, s[32:35], s76 offen offset:3072 sc1 lds
    s_waitcnt vmcnt(0)
    s_mov_b32 m0, s60
    s_mov_b32 s76, s61
    ds_read2st64_b32 v[104:105], v101 offset0:192 offset1:196
    ds_read2st64_b32 v[106:107], v101 offset0:200 offset1:204
    s_waitcnt lgkmcnt(0)
    v_or3_b32 v104, v104, v105, -2
    v_or3_b32 v102, v104, v106, v107
    v_cmp_eq_u32 vcc, -1, v102
    s_cbranch_vccnz L_re_33
    s_branch L_bk_34
L_hr_36:
    s_sub_u32 s56, s56, 1
    s_cbranch_scc1 L_bail
    buffer_load_dword v102, v101, s[32:35], s11 offen sc1
    s_waitcnt vmcnt(0)
    v_cmp_gt_u32 vcc, 1, v102
    s_cbranch_vccnz L_hr_36
    s_branch L_hb_37
L_hs_44:
    buffer_store_dwordx4 v[20:23], v143, s[32:35], s80 offen sc1
    s_branch L_he_45
L_hs_46:
    buffer_store_dwordx4 v[24:27], v143, s[32:35], s80 offen sc1
    s_branch L_he_47
L_hs_48:
    buffer_store_dwordx4 v[52:55], v143, s[32:35], s80 offen sc1
    s_branch L_he_49
L_hs_56:
    buffer_store_dword v102, v143, s[32:35], s19 offen sc1
    s_branch L_he_57
L_hs_59:
    buffer_store_dwordx4 v[28:31], v143, s[32:35], s80 offen sc1
    s_branch L_he_60
L_hs_61:
    buffer_store_dwordx4 v[32:35], v143, s[32:35], s80 offen sc1
    s_branch L_he_62
L_hs_63:
    buffer_store_dwordx4 v[60:63], v143, s[32:35], s80 offen sc1
    s_branch L_he_64
L_re_65:
    s_sub_u32 s56, s56, 1
    s_cbranch_scc1 L_bail
    s_mov_b32 s60, m0
    s_mov_b32 s61, s76
    s_add_u32 m0, s20, 16384
    s_add_u32 s76, s52, 0
    buffer_load_dwordx4 v100, s[32:35], s76 offen offset:0 sc1 lds
    s_add_u32 s76, s52, 64512
    buffer_load_dwordx4 v100, s[32:35], s76 offen offset:1024 sc1 lds
    s_add_u32 s76, s52, 129024
    buffer_load_dwordx4 v100, s[32:35], s76 offen offset:2048 sc1 lds
    s_add_u32 s76, s52, 193536
    buffer_load_dwordx4 v100, s[32:35], s76 offen offset:3072 sc1 lds
    s_waitcnt vmcnt(0)
    s_mov_b32 m0, s60
    s_mov_b32 s76, s61
    ds_read2st64_b32 v[104:105], v101 offset0:64 offset1:68
    ds_read2st64_b32 v[106:107], v101 offset0:72 offset1:76
    s_waitcnt lgkmcnt(0)
    v_or3_b32 v104, v104, v105, -2
    v_or3_b32 v102, v104, v106, v107
    v_cmp_eq_u32 vcc, -1, v102
    s_cbranch_vccnz L_re_65
    s_branch L_bk_66
L_re_67:
    s_sub_u32 s56, s56, 1
    s_cbranch_scc1 L_bail
    s_mov_b32 s60, m0
    s_mov_b32 s61, s76
    s_add_u32 m0, s20, 32768
    s_add_u32 s76, s15, 2048
    buffer_load_dwordx4 v100, s[32:35], s76 offen offset:0 sc1 lds
    s_add_u32 s76, s15, 66560
    buffer_load_dwordx4 v100, s[32:35], s76 offen offset:1024 sc1 lds
    s_add_u32 s76, s15, 131072
    buffer_load_dwordx4 v100, s[32:35], s76 offen offset:2048 sc1 lds
    s_add_u32 s76, s15, 195584
    buffer_load_dwordx4 v100, s[32:35], s76 offen offset:3072 sc1 lds
    s_waitcnt vmcnt(0)
    s_mov_b32 m0, s60
    s_mov_b32 s76, s61
    ds_read2st64_b32 v[104:105], v101 offset0:128 offset1:132
    ds_read2st64_b32 v[106:107], v101 offset0:136 offset1:140
    s_waitcnt lgkmcnt(0)
    v_or3_b32 v104, v104, v105, -2
    v_or3_b32 v102, v104, v106, v107
    v_cmp_eq_u32 vcc, -1, v102
    s_cbranch_vccnz L_re_67
    s_branch L_bk_68
L_re_69:
    s_sub_u32 s56, s56, 1
    s_cbranch_scc1 L_bail
    s_mov_b32 s60, m0
    s_mov_b32 s61, s76
    s_add_u32 m0, s20, 49152
    s_add_u32 s76, s52, 2048
    buffer_load_dwordx4 v100, s[32:35], s76 offen offset:0 sc1 lds
    s_add_u32 s76, s52, 66560
    buffer_load_dwordx4 v100, s[32:35], s76 offen offset:1024 sc1 lds
    s_add_u32 s76, s52, 131072
    buffer_load_dwordx4 v100, s[32:35], s76 offen offset:2048 sc1 lds
    s_add_u32 s76, s52, 195584
    buffer_load_dwordx4 v100, s[32:35], s76 offen offset:3072 sc1 lds
    s_waitcnt vmcnt(0)
    s_mov_b32 m0, s60
    s_mov_b32 s76, s61
    ds_read2st64_b32 v[104:105], v101 offset0:192 offset1:196
    ds_read2st64_b32 v[106:107], v101 offset0:200 offset1:204
    s_waitcnt lgkmcnt(0)
    v_or3_b32 v104, v104, v105, -2
    v_or3_b32 v102, v104, v106, v107
    v_cmp_eq_u32 vcc, -1, v102
    s_cbranch_vccnz L_re_69
    s_branch L_bk_70
L_hr_71:
    s_sub_u32 s56, s56, 1
    s_cbranch_scc1 L_bail
    buffer_load_dword v102, v101, s[32:35], s11 offen sc1
    s_waitcnt vmcnt(0)
    v_cmp_gt_u32 vcc, 1, v102
    s_cbranch_vccnz L_hr_71
    s_branch L_hb_72
L_hs_79:
    buffer_store_dwordx4 v[20:23], v143, s[32:35], s80 offen sc1
    s_branch L_he_80
L_hs_81:
    buffer_store_dwordx4 v[24:27], v143, s[32:35], s80 offen sc1
    s_branch L_he_82
L_hs_97:
    buffer_store_dword v102, v143, s[32:35], s19 offen sc1
    s_branch L_he_98
L_hs_99:
    buffer_store_dwordx4 v[28:31], v143, s[32:35], s80 offen sc1
    s_branch L_he_100
L_hs_101:
    buffer_store_dwordx4 v[32:35], v143, s[32:35], s80 offen sc1
    s_branch L_he_102
L_hr_103:
    s_sub_u32 s56, s56, 1
    s_cbranch_scc1 L_bail
    buffer_load_dword v137, v136, s[32:35], s11 offen sc1
    s_waitcnt vmcnt(0)
    v_cmp_gt_u32 vcc, 2, v137
    s_cbranch_vccnz L_hr_103
    s_branch L_hb_104
L_re_105:
    s_sub_u32 s56, s56, 1
    s_cbranch_scc1 L_bail
    s_mov_b32 s60, m0
    s_mov_b32 s61, s76
    s_add_u32 s76, s23, 0
    buffer_load_dwordx4 v[84:87], v141, s[32:35], s76 offen offset:0 sc1
    s_add_u32 s76, s23, 0
    buffer_load_dwordx4 v[88:91], v141, s[32:35], s76 offen offset:1024 sc1
    s_waitcnt vmcnt(0)
    s_mov_b32 m0, s60
    s_mov_b32 s76, s61
    v_max3_u32 v136, v84, v85, v86
    v_max3_u32 v136, v136, v87, v88
    v_max3_u32 v136, v136, v89, v90
    v_max_u32 v136, v136, v91
    v_cmp_eq_u32 vcc, -1, v136
    s_cbranch_vccnz L_re_105
    s_branch L_bk_106
L_hs_109:
    buffer_store_dword v52, v143, s[32:35], s19 offen sc1
    s_branch L_he_110
L_hs_111:
    buffer_store_dwordx2 v[100:101], v55, s[32:35], s76 offen sc1
    s_branch L_he_112
L_hs_114:
    buffer_store_dwordx2 v[56:57], v55, s[32:35], s76 offen sc1
    s_branch L_he_115
L_re_119:
    s_sub_u32 s56, s56, 1
    s_cbranch_scc1 L_bail
    s_mov_b32 s60, m0
    s_mov_b32 s61, s76
    s_add_u32 s76, s23, 4096
    buffer_load_dwordx4 v[60:63], v141, s[32:35], s76 offen offset:0 sc1
    s_add_u32 s76, s23, 4096
    buffer_load_dwordx4 v[64:67], v141, s[32:35], s76 offen offset:1024 sc1
    s_waitcnt vmcnt(0)
    s_mov_b32 m0, s60
    s_mov_b32 s76, s61
    v_max3_u32 v80, v60, v61, v62
    v_max3_u32 v80, v80, v63, v64
    v_max3_u32 v80, v80, v65, v66
    v_max_u32 v80, v80, v67
    v_cmp_eq_u32 vcc, -1, v80
    s_cbranch_vccnz L_re_119
    s_branch L_bk_120
L_re_121:
    s_sub_u32 s56, s56, 1
    s_cbranch_scc1 L_bail
    s_mov_b32 s60, m0
    s_mov_b32 s61, s76
    s_add_u32 m0, s91, 0
    s_add_u32 s93, s92, 0
    buffer_load_dwordx4 v124, s[32:35], s93 offen sc1 lds
    s_waitcnt vmcnt(0)
    s_mov_b32 m0, s60
    s_mov_b32 s76, s61
    ds_read_b128 v[104:107], v126 offset:0
    s_waitcnt lgkmcnt(0)
    v_max3_u32 v125, v104, v105, v106
    v_max_u32 v125, v125, v107
    v_cmp_eq_u32 vcc, -1, v125
    s_cbranch_vccnz L_re_121
    s_branch L_bk_122
L_re_125:
    s_sub_u32 s56, s56, 1
    s_cbranch_scc1 L_bail
    s_mov_b32 s60, m0
    s_mov_b32 s61, s76
    s_add_u32 s93, s90, 0
    buffer_load_dwordx4 v[136:139], v59, s[32:35], s93 offen sc1
    s_waitcnt vmcnt(0)
    s_mov_b32 m0, s60
    s_mov_b32 s76, s61
    v_max3_u32 v125, v136, v137, v138
    v_max_u32 v125, v125, v139
    v_cmp_eq_u32 vcc, -1, v125
    s_cbranch_vccnz L_re_125
    s_branch L_bk_126
L_re_127:
    s_sub_u32 s56, s56, 1
    s_cbranch_scc1 L_bail
    s_mov_b32 s60, m0
    s_mov_b32 s61, s76
    s_add_u32 s93, s90, 2097152
    buffer_load_dwordx4 v[140:143], v59, s[32:35], s93 offen sc1
    s_waitcnt vmcnt(0)
    s_mov_b32 m0, s60
    s_mov_b32 s76, s61
    v_max3_u32 v125, v140, v141, v142
    v_max_u32 v125, v125, v143
    v_cmp_eq_u32 vcc, -1, v125
    s_cbranch_vccnz L_re_127
    s_branch L_bk_128
L_re_129:
    s_sub_u32 s56, s56, 1
    s_cbranch_scc1 L_bail
    s_mov_b32 s60, m0
    s_mov_b32 s61, s76
    s_add_u32 m0, s91, 2048
    s_add_u32 s93, s92, 2097152
    buffer_load_dwordx4 v124, s[32:35], s93 offen sc1 lds
    s_waitcnt vmcnt(0)
    s_mov_b32 m0, s60
    s_mov_b32 s76, s61
    ds_read_b128 v[136:139], v126 offset:2048
    s_waitcnt lgkmcnt(0)
    v_max3_u32 v125, v136, v137, v138
    v_max_u32 v125, v125, v139
    v_cmp_eq_u32 vcc, -1, v125
    s_cbranch_vccnz L_re_129
    s_branch L_bk_130
L_re_131:
    s_sub_u32 s56, s56, 1
    s_cbranch_scc1 L_bail
    s_mov_b32 s60, m0
    s_mov_b32 s61, s76
    s_add_u32 s93, s90, 0
    buffer_load_dwordx4 v[136:139], v59, s[32:35], s93 offen sc1
    s_waitcnt vmcnt(0)
    s_mov_b32 m0, s60
    s_mov_b32 s76, s61
    v_max3_u32 v125, v136, v137, v138
    v_max_u32 v125, v125, v139
    v_cmp_eq_u32 vcc, -1, v125
    s_cbranch_vccnz L_re_131
    s_branch L_bk_132
L_re_133:
    s_sub_u32 s56, s56, 1
    s_cbranch_scc1 L_bail
    s_mov_b32 s60, m0
    s_mov_b32 s61, s76
    s_add_u32 s93, s90, 2097152
    buffer_load_dwordx4 v[140:143], v59, s[32:35], s93 offen sc1
    s_waitcnt vmcnt(0)
    s_mov_b32 m0, s60
    s_mov_b32 s76, s61
    v_max3_u32 v125, v140, v141, v142
    v_max_u32 v125, v125, v143
    v_cmp_eq_u32 vcc, -1, v125
    s_cbranch_vccnz L_re_133
    s_branch L_bk_134
L_re_135:
    s_sub_u32 s56, s56, 1
    s_cbranch_scc1 L_bail
    s_mov_b32 s60, m0
    s_mov_b32 s61, s76
    s_add_u32 m0, s91, 2048
    s_add_u32 s93, s92, 2097152
    buffer_load_dwordx4 v124, s[32:35], s93 offen sc1 lds
    s_waitcnt vmcnt(0)
    s_mov_b32 m0, s60
    s_mov_b32 s76, s61
    ds_read_b128 v[136:139], v126 offset:2048
    s_waitcnt lgkmcnt(0)
    v_max3_u32 v125, v136, v137, v138
    v_max_u32 v125, v125, v139
    v_cmp_eq_u32 vcc, -1, v125
    s_cbranch_vccnz L_re_135
    s_branch L_bk_136
L_re_137:
    s_sub_u32 s56, s56, 1
    s_cbranch_scc1 L_bail
    s_mov_b32 s60, m0
    s_mov_b32 s61, s76
    s_add_u32 m0, s20, 0
    s_add_u32 s76, s15, 0
    buffer_load_dwordx4 v100, s[32:35], s76 offen offset:0 sc1 lds
    s_add_u32 s76, s15, 64512
    buffer_load_dwordx4 v100, s[32:35], s76 offen offset:1024 sc1 lds
    s_add_u32 s76, s15, 129024
    buffer_load_dwordx4 v100, s[32:35], s76 offen offset:2048 sc1 lds
    s_add_u32 s76, s15, 193536
    buffer_load_dwordx4 v100, s[32:35], s76 offen offset:3072 sc1 lds
    s_waitcnt vmcnt(0)
    s_mov_b32 m0, s60
    s_mov_b32 s76, s61
    ds_read2st64_b32 v[104:105], v101 offset0:0 offset1:4
    ds_read2st64_b32 v[106:107], v101 offset0:8 offset1:12
    s_waitcnt lgkmcnt(0)
    v_and_b32 v104, v104, v105
    v_bitop3_b32 v102, v104, v106, v107 bitop3:0x7f
    v_or_b32 v102, -2, v102
    v_cmp_eq_u32 vcc, -1, v102
    s_cbranch_vccnz L_re_137
    s_branch L_bk_138
L_re_141:
    s_sub_u32 s56, s56, 1
    s_cbranch_scc1 L_bail
    s_mov_b32 s60, m0
    s_mov_b32 s61, s76
    s_add_u32 m0, s20, 16384
    s_add_u32 s76, s52, 0
    buffer_load_dwordx4 v100, s[32:35], s76 offen offset:0 sc1 lds
    s_add_u32 s76, s52, 64512
    buffer_load_dwordx4 v100, s[32:35], s76 offen offset:1024 sc1 lds
    s_add_u32 s76, s52, 129024
    buffer_load_dwordx4 v100, s[32:35], s76 offen offset:2048 sc1 lds
    s_add_u32 s76, s52, 193536
    buffer_load_dwordx4 v100, s[32:35], s76 offen offset:3072 sc1 lds
    s_waitcnt vmcnt(0)
    s_mov_b32 m0, s60
    s_mov_b32 s76, s61
    ds_read2st64_b32 v[104:105], v101 offset0:64 offset1:68
    ds_read2st64_b32 v[106:107], v101 offset0:72 offset1:76
    s_waitcnt lgkmcnt(0)
    v_and_b32 v104, v104, v105
    v_bitop3_b32 v102, v104, v106, v107 bitop3:0x7f
    v_or_b32 v102, -2, v102
    v_cmp_eq_u32 vcc, -1, v102
    s_cbranch_vccnz L_re_141
    s_branch L_bk_142
L_re_143:
    s_sub_u32 s56, s56, 1
    s_cbranch_scc1 L_bail
    s_mov_b32 s60, m0
    s_mov_b32 s61, s76
    s_add_u32 m0, s20, 32768
    s_add_u32 s76, s15, 2048
    buffer_load_dwordx4 v100, s[32:35], s76 offen offset:0 sc1 lds
    s_add_u32 s76, s15, 66560
    buffer_load_dwordx4 v100, s[32:35], s76 offen offset:1024 sc1 lds
    s_add_u32 s76, s15, 131072
    buffer_load_dwordx4 v100, s[32:35], s76 offen offset:2048 sc1 lds
    s_add_u32 s76, s15, 195584
    buffer_load_dwordx4 v100, s[32:35], s76 offen offset:3072 sc1 lds
    s_waitcnt vmcnt(0)
    s_mov_b32 m0, s60
    s_mov_b32 s76, s61
    ds_read2st64_b32 v[104:105], v101 offset0:128 offset1:132
    ds_read2st64_b32 v[106:107], v101 offset0:136 offset1:140
    s_waitcnt lgkmcnt(0)
    v_and_b32 v104, v104, v105
    v_bitop3_b32 v102, v104, v106, v107 bitop3:0x7f
    v_or_b32 v102, -2, v102
    v_cmp_eq_u32 vcc, -1, v102
    s_cbranch_vccnz L_re_143
    s_branch L_bk_144
L_re_145:
    s_sub_u32 s56, s56, 1
    s_cbranch_scc1 L_bail
    s_mov_b32 s60, m0
    s_mov_b32 s61, s76
    s_add_u32 m0, s20, 49152
    s_add_u32 s76, s52, 2048
    buffer_load_dwordx4 v100, s[32:35], s76 offen offset:0 sc1 lds
    s_add_u32 s76, s52, 66560
    buffer_load_dwordx4 v100, s[32:35], s76 offen offset:1024 sc1 lds
    s_add_u32 s76, s52, 131072
    buffer_load_dwordx4 v100, s[32:35], s76 offen offset:2048 sc1 lds
    s_add_u32 s76, s52, 195584
    buffer_load_dwordx4 v100, s[32:35], s76 offen offset:3072 sc1 lds
    s_waitcnt vmcnt(0)
    s_mov_b32 m0, s60
    s_mov_b32 s76, s61
    ds_read2st64_b32 v[104:105], v101 offset0:192 offset1:196
    ds_read2st64_b32 v[106:107], v101 offset0:200 offset1:204
    s_waitcnt lgkmcnt(0)
    v_and_b32 v104, v104, v105
    v_bitop3_b32 v102, v104, v106, v107 bitop3:0x7f
    v_or_b32 v102, -2, v102
    v_cmp_eq_u32 vcc, -1, v102
    s_cbranch_vccnz L_re_145
    s_branch L_bk_146
L_hr_148:
    s_sub_u32 s56, s56, 1
    s_cbranch_scc1 L_bail
    buffer_load_dword v102, v101, s[32:35], s11 offen sc1
    s_waitcnt vmcnt(0)
    v_cmp_gt_u32 vcc, 3, v102
    s_cbranch_vccnz L_hr_148
    s_branch L_hb_149
L_hs_156:
    buffer_store_dwordx4 v[20:23], v143, s[32:35], s80 offen sc1
    s_branch L_he_157
L_hs_160:
    buffer_store_dwordx4 v[24:27], v143, s[32:35], s80 offen sc1
    s_branch L_he_161
L_hs_162:
    buffer_store_dwordx4 v[52:55], v143, s[32:35], s80 offen sc1
    s_branch L_he_163
L_hs_170:
    buffer_store_dword v102, v143, s[32:35], s19 offen sc1
    s_branch L_he_171
L_hs_173:
    buffer_store_dwordx4 v[28:31], v143, s[32:35], s80 offen sc1
    s_branch L_he_174
L_hs_175:
    buffer_store_dwordx4 v[32:35], v143, s[32:35], s80 offen sc1
    s_branch L_he_176
L_hs_177:
    buffer_store_dwordx4 v[60:63], v143, s[32:35], s80 offen sc1
    s_branch L_he_178
L_re_179:
    s_sub_u32 s56, s56, 1
    s_cbranch_scc1 L_bail
    s_mov_b32 s60, m0
    s_mov_b32 s61, s76
    s_add_u32 m0, s20, 16384
    s_add_u32 s76, s52, 0
    buffer_load_dwordx4 v100, s[32:35], s76 offen offset:0 sc1 lds
    s_add_u32 s76, s52, 64512
    buffer_load_dwordx4 v100, s[32:35], s76 offen offset:1024 sc1 lds
    s_add_u32 s76, s52, 129024
    buffer_load_dwordx4 v100, s[32:35], s76 offen offset:2048 sc1 lds
    s_add_u32 s76, s52, 193536
    buffer_load_dwordx4 v100, s[32:35], s76 offen offset:3072 sc1 lds
    s_waitcnt vmcnt(0)
    s_mov_b32 m0, s60
    s_mov_b32 s76, s61
    ds_read2st64_b32 v[104:105], v101 offset0:64 offset1:68
    ds_read2st64_b32 v[106:107], v101 offset0:72 offset1:76
    s_waitcnt lgkmcnt(0)
    v_and_b32 v104, v104, v105
    v_bitop3_b32 v102, v104, v106, v107 bitop3:0x7f
    v_or_b32 v102, -2, v102
    v_cmp_eq_u32 vcc, -1, v102
    s_cbranch_vccnz L_re_179
    s_branch L_bk_180
L_re_181:
    s_sub_u32 s56, s56, 1
    s_cbranch_scc1 L_bail
    s_mov_b32 s60, m0
    s_mov_b32 s61, s76
    s_add_u32 m0, s20, 32768
    s_add_u32 s76, s15, 2048
    buffer_load_dwordx4 v100, s[32:35], s76 offen offset:0 sc1 lds
    s_add_u32 s76, s15, 66560
    buffer_load_dwordx4 v100, s[32:35], s76 offen offset:1024 sc1 lds
    s_add_u32 s76, s15, 131072
    buffer_load_dwordx4 v100, s[32:35], s76 offen offset:2048 sc1 lds
    s_add_u32 s76, s15, 195584
    buffer_load_dwordx4 v100, s[32:35], s76 offen offset:3072 sc1 lds
    s_waitcnt vmcnt(0)
    s_mov_b32 m0, s60
    s_mov_b32 s76, s61
    ds_read2st64_b32 v[104:105], v101 offset0:128 offset1:132
    ds_read2st64_b32 v[106:107], v101 offset0:136 offset1:140
    s_waitcnt lgkmcnt(0)
    v_and_b32 v104, v104, v105
    v_bitop3_b32 v102, v104, v106, v107 bitop3:0x7f
    v_or_b32 v102, -2, v102
    v_cmp_eq_u32 vcc, -1, v102
    s_cbranch_vccnz L_re_181
    s_branch L_bk_182
L_re_183:
    s_sub_u32 s56, s56, 1
    s_cbranch_scc1 L_bail
    s_mov_b32 s60, m0
    s_mov_b32 s61, s76
    s_add_u32 m0, s20, 49152
    s_add_u32 s76, s52, 2048
    buffer_load_dwordx4 v100, s[32:35], s76 offen offset:0 sc1 lds
    s_add_u32 s76, s52, 66560
    buffer_load_dwordx4 v100, s[32:35], s76 offen offset:1024 sc1 lds
    s_add_u32 s76, s52, 131072
    buffer_load_dwordx4 v100, s[32:35], s76 offen offset:2048 sc1 lds
    s_add_u32 s76, s52, 195584
    buffer_load_dwordx4 v100, s[32:35], s76 offen offset:3072 sc1 lds
    s_waitcnt vmcnt(0)
    s_mov_b32 m0, s60
    s_mov_b32 s76, s61
    ds_read2st64_b32 v[104:105], v101 offset0:192 offset1:196
    ds_read2st64_b32 v[106:107], v101 offset0:200 offset1:204
    s_waitcnt lgkmcnt(0)
    v_and_b32 v104, v104, v105
    v_bitop3_b32 v102, v104, v106, v107 bitop3:0x7f
    v_or_b32 v102, -2, v102
    v_cmp_eq_u32 vcc, -1, v102
    s_cbranch_vccnz L_re_183
    s_branch L_bk_184
L_hr_185:
    s_sub_u32 s56, s56, 1
    s_cbranch_scc1 L_bail
    buffer_load_dword v102, v101, s[32:35], s11 offen sc1
    s_waitcnt vmcnt(0)
    v_cmp_gt_u32 vcc, 3, v102
    s_cbranch_vccnz L_hr_185
    s_branch L_hb_186
L_hs_193:
    buffer_store_dwordx4 v[20:23], v143, s[32:35], s80 offen sc1
    s_branch L_he_194
L_hs_195:
    buffer_store_dwordx4 v[24:27], v143, s[32:35], s80 offen sc1
    s_branch L_he_196
L_hs_227:
    buffer_store_dword v102, v143, s[32:35], s19 offen sc1
    s_branch L_he_228
L_hs_229:
    buffer_store_dwordx4 v[28:31], v143, s[32:35], s80 offen sc1
    s_branch L_he_230
L_hs_231:
    buffer_store_dwordx4 v[32:35], v143, s[32:35], s80 offen sc1
    s_branch L_he_232
L_hr_233:
    s_sub_u32 s56, s56, 1
    s_cbranch_scc1 L_bail
    buffer_load_dword v137, v136, s[32:35], s11 offen sc1
    s_waitcnt vmcnt(0)
    v_cmp_gt_u32 vcc, 4, v137
    s_cbranch_vccnz L_hr_233
    s_branch L_hb_234
L_hs_241:
    buffer_store_dword v52, v143, s[32:35], s19 offen sc1
    s_branch L_he_242
L_bail:
    s_mov_b64 exec, -1
    v_mov_b32 v20, 32
    v_mov_b32 v21, 1
    global_atomic_add v20, v21, s[26:27] sc1
    s_endpgm
.section .rodata,"a"
.p2align 6
.amdhsa_kernel interleave_layers__ssm_conv_s4d__dense_activation_relu__prompt_kernel
  .amdhsa_next_free_vgpr 512
  .amdhsa_next_free_sgpr 102
  .amdhsa_accum_offset 256
  .amdhsa_group_segment_fixed_size 0
  .amdhsa_kernarg_size 104
  .amdhsa_user_sgpr_count 2
  .amdhsa_user_sgpr_kernarg_segment_ptr 1
  .amdhsa_system_sgpr_workgroup_id_x 1
  .amdhsa_float_denorm_mode_32 3
  .amdhsa_ieee_mode 0
.end_amdhsa_kernel
```
